```python
import torch

def _softmax(x, axis=-1):
    return torch.softmax(x, dim=axis)
def _gelu(x):
    return torch.nn.functional.gelu(x, approximate="tanh")
def _silu(x):
    return torch.nn.functional.silu(x)
def _sigmoid(x):
    return torch.sigmoid(x)
def _layernorm(x, axis=-1, eps=1e-5):
    m = x.mean(dim=axis, keepdim=True)
    v = x.var(dim=axis, keepdim=True, unbiased=False)
    return (x - m) / torch.sqrt(v + eps)
def _scatter_add(tgt, idx, src, axis=0):
    return tgt.clone().index_add_(axis, idx, src)
def _segment_sum(src, seg, n):
    out = torch.zeros((n,) + src.shape[1:], dtype=src.dtype)
    return out.index_add_(0, seg, src)
def _pad(x, pw):
    flat = tuple(v for pair in reversed(pw) for v in pair)
    return torch.nn.functional.pad(x, flat)

kernel_name = 'standalone__gqa_softmax__near_ridge'

def setup_inputs():

    _w = (lambda a: (lambda t: t.to(torch.bfloat16) if t.is_floating_point() else t)(torch.as_tensor(a)))
    B, Hq, Hkv, Sq, Sk, D = 8, 16, 8, 512, 512, 256
    return {
        "q": _w((lambda *s: torch.randn(*s, dtype=torch.bfloat16) * 0.8)(B, Hq, Sq, D)),
        "k": _w((lambda *s: torch.randn(*s, dtype=torch.bfloat16) * 0.8)(B, Hkv, Sk, D)),
        "v": _w((lambda *s: torch.randn(*s, dtype=torch.bfloat16) * 0.05)(B, Hkv, Sk, D)),
    }

def reference(q, k, v):
    B, Hq, Sq, D = q.shape
    Hkv = k.shape[1]
    rep = Hq // Hkv
    k = (lambda x, n, axis: torch.repeat_interleave(x, n, dim=axis))(k, rep, axis=1)
    v = (lambda x, n, axis: torch.repeat_interleave(x, n, dim=axis))(v, rep, axis=1)
    scale = D ** -0.5
    scores = torch.einsum("bhqd,bhkd->bhqk", q, k) * scale
    p = _softmax(scores, axis=-1)
    return torch.einsum("bhqk,bhkd->bhqd", p, v)
```

```asm
; @launch grid=(256,1,1) block=(256,1,1) lds=152128
.amdgcn_target "amdgcn-amd-amdhsa--gfx950"
.text
.globl standalone__gqa_softmax__near_ridge_kernel
.p2align 8
.type standalone__gqa_softmax__near_ridge_kernel,@function
standalone__gqa_softmax__near_ridge_kernel:
    s_load_dwordx4 s[4:7], s[0:1], 0
    s_load_dwordx4 s[24:27], s[0:1], 16
    s_cmpk_ge_u32 s2, 256
    s_cbranch_scc1 L_end
    v_lshrrev_b32 v9, 6, v0
    v_and_b32 v0, 63, v0
    v_readfirstlane_b32 s3, v9
    s_getpc_b64 s[96:97]
    L_pc:
    s_lshr_b32 s63, s2, 3
    s_lshl2_add_u32 s63, s63, s3
    s_lshl_b32 s63, s63, 9
    v_and_b32 v96, 3, v0
    v_lshl_add_u32 v96, v96, 7, s63
    v_min_u32 v96, L_codeend - L_pc - 64, v96
    global_load_dword v97, v96, s[96:97]
    v_lshrrev_b32 v1, 5, v0
    v_lshlrev_b32 v1, 12, v1
    v_and_b32 v96, 31, v0
    v_lshl_add_u32 v1, v96, 4, v1
    v_lshrrev_b32 v2, 4, v0
    v_lshlrev_b32 v2, 12, v2
    v_and_b32 v96, 8, v0
    v_lshl_add_u32 v2, v96, 6, v2
    v_and_b32 v96, 7, v0
    v_lshl_add_u32 v2, v96, 4, v2
    s_and_b32 s29, s2, 7
    s_lshr_b32 s63, s2, 5
    s_lshl3_add_u32 s29, s29, s63
    s_lshr_b32 s28, s2, 3
    s_and_b32 s28, s28, 3
    s_lshl2_add_u32 s52, s28, s3
    s_lshl4_add_u32 s62, s29, s52
    s_lshl_b32 s62, s62, 15
    s_lshl_b32 s61, s29, 18
    s_mul_i32 s30, s3, 4224
    s_and_b32 s63, s3, 2
    s_add_u32 s63, s63, s3
    s_lshl_b32 s63, s63, 11
    s_and_b32 s32, s29, 15
    s_lshl_b32 s32, s32, 14
    s_or_b32 s32, s32, s63
    s_add_u32 s33, s32, 16384
    s_and_b32 s33, s33, 0x3ffff
    s_and_b32 s53, s3, 1
    s_lshl_b32 s53, s53, 14
    s_mov_b32 s59, 0
    s_mov_b32 s10, 0x8000
    s_mov_b32 s11, 0x20000
    s_mov_b32 s14, 0x40000
    s_mov_b32 s15, 0x20000
    s_waitcnt lgkmcnt(0)
    s_add_u32 s12, s6, s61
    s_addc_u32 s13, s7, 0
    s_add_u32 s8, s4, s62
    s_addc_u32 s9, s5, 0
L_restart:
    s_add_u32 m0, s30, 0
    s_nop 0
    buffer_load_dwordx4 v1, s[12:15], s32 offen offset:0 nt lds
    s_add_u32 m0, s30, 544
    s_nop 0
    buffer_load_dwordx4 v1, s[12:15], s32 offen offset:512 nt lds
    s_add_u32 m0, s30, 1088
    s_nop 0
    buffer_load_dwordx4 v1, s[12:15], s32 offen offset:1024 nt lds
    s_add_u32 m0, s30, 1632
    s_nop 0
    buffer_load_dwordx4 v1, s[12:15], s32 offen offset:1536 nt lds
    s_add_u32 m0, s30, 84480
    s_nop 0
    buffer_load_dwordx4 v2, s[8:11], s53 offen offset:0 nt lds
    s_add_u32 m0, s30, 16896
    s_nop 0
    buffer_load_dwordx4 v1, s[12:15], s33 offen offset:0 nt lds
    s_add_u32 m0, s30, 84512
    s_nop 0
    buffer_load_dwordx4 v2, s[8:11], s53 offen offset:1024 nt lds
    s_add_u32 m0, s30, 17440
    s_nop 0
    buffer_load_dwordx4 v1, s[12:15], s33 offen offset:512 nt lds
    s_add_u32 m0, s30, 84544
    s_nop 0
    buffer_load_dwordx4 v2, s[8:11], s53 offen offset:2048 nt lds
    s_add_u32 m0, s30, 17984
    s_nop 0
    buffer_load_dwordx4 v1, s[12:15], s33 offen offset:1024 nt lds
    s_add_u32 m0, s30, 84576
    s_nop 0
    buffer_load_dwordx4 v2, s[8:11], s53 offen offset:3072 nt lds
    s_add_u32 m0, s30, 18528
    s_nop 0
    buffer_load_dwordx4 v1, s[12:15], s33 offen offset:1536 nt lds
    s_cmp_lg_u32 s59, 0
    s_cbranch_scc1 L_setup_done
    s_add_u32 s34, s32, 32768
    s_and_b32 s34, s34, 0x3ffff
    s_add_u32 s35, s32, 49152
    s_and_b32 s35, s35, 0x3ffff
    s_add_u32 s36, s32, 65536
    s_and_b32 s36, s36, 0x3ffff
    s_add_u32 s37, s32, 81920
    s_and_b32 s37, s37, 0x3ffff
    s_add_u32 s38, s32, 98304
    s_and_b32 s38, s38, 0x3ffff
    s_add_u32 s39, s32, 114688
    s_and_b32 s39, s39, 0x3ffff
    s_add_u32 s40, s32, 131072
    s_and_b32 s40, s40, 0x3ffff
    s_add_u32 s41, s32, 147456
    s_and_b32 s41, s41, 0x3ffff
    s_add_u32 s42, s32, 163840
    s_and_b32 s42, s42, 0x3ffff
    s_add_u32 s43, s32, 180224
    s_and_b32 s43, s43, 0x3ffff
    s_add_u32 s44, s32, 196608
    s_and_b32 s44, s44, 0x3ffff
    s_add_u32 s45, s32, 212992
    s_and_b32 s45, s45, 0x3ffff
    s_add_u32 s46, s32, 229376
    s_and_b32 s46, s46, 0x3ffff
    s_add_u32 s47, s32, 245760
    s_and_b32 s47, s47, 0x3ffff
    s_add_u32 s54, s53, 8192
    s_and_b32 s54, s54, 0x7fff
    s_add_u32 s55, s53, 16384
    s_and_b32 s55, s55, 0x7fff
    s_add_u32 s56, s53, 24576
    s_and_b32 s56, s56, 0x7fff
    s_lshr_b32 s63, s32, 14
    s_add_u32 s63, s63, s3
    s_add_u32 s48, s63, 0
    s_and_b32 s48, s48, 15
    s_lshl_b32 s48, s48, 14
    s_add_u32 s98, s29, 0
    s_and_b32 s98, s98, 3
    s_lshl_b32 s98, s98, 7
    s_add_u32 s49, s63, 4
    s_and_b32 s49, s49, 15
    s_lshl_b32 s49, s49, 14
    s_add_u32 s99, s29, 1
    s_and_b32 s99, s99, 3
    s_lshl_b32 s99, s99, 7
    s_add_u32 s50, s63, 8
    s_and_b32 s50, s50, 15
    s_lshl_b32 s50, s50, 14
    s_add_u32 s100, s29, 2
    s_and_b32 s100, s100, 3
    s_lshl_b32 s100, s100, 7
    s_add_u32 s51, s63, 12
    s_and_b32 s51, s51, 15
    s_lshl_b32 s51, s51, 14
    s_add_u32 s101, s29, 3
    s_and_b32 s101, s101, 3
    s_lshl_b32 s101, s101, 7
    s_mov_b32 s31, 0x3db8aa3b
    s_mov_b32 s60, 0xbdb8aa3b
    s_add_u32 s16, s24, s61
    s_addc_u32 s17, s25, 0
    s_mov_b32 s18, 0x40000
    s_mov_b32 s19, 0x20000
    s_add_u32 s20, s26, s62
    s_addc_u32 s21, s27, 0
    s_mov_b32 s22, 0x8000
    s_mov_b32 s23, 0x20000
    s_andn2_b32 s57, s40, 0x3fff
    s_lshl_b32 s63, s52, 13
    s_add_u32 s57, s57, s63
    s_and_b32 s57, s57, 0x3ffff
    s_add_u32 s57, s57, s99
    s_lshl_b32 s52, s52, 14
    v_and_b32 v9, 15, v0
    v_lshrrev_b32 v10, 4, v0
    v_bfe_u32 v96, v0, 1, 2
    v_mul_u32_u24 v3, 1056, v96
    v_lshrrev_b32 v96, 3, v9
    v_lshl_add_u32 v3, v96, 8, v3
    v_and_b32 v96, 1, v0
    v_lshl_add_u32 v3, v96, 7, v3
    v_lshl_add_u32 v3, v10, 4, v3
    v_add_u32 v3, s30, v3
    v_add_u32 v3, 84480, v3
    v_and_b32 v96, 7, v0
    v_mul_u32_u24 v5, 1056, v96
    v_lshrrev_b32 v96, 3, v9
    v_lshl_add_u32 v5, v96, 9, v5
    v_lshl_add_u32 v5, v10, 4, v5
    v_add_u32 v6, 67584, v5
    v_add_u32 v7, 135168, v5
    v_lshlrev_b32 v4, 9, v9
    v_bfe_u32 v96, v0, 4, 1
    v_lshl_add_u32 v4, v96, 5, v4
    v_lshrrev_b32 v96, 5, v0
    v_lshl_add_u32 v4, v96, 4, v4
    v_bfe_u32 v96, v0, 3, 2
    v_mul_u32_u24 v8, 1056, v96
    v_lshrrev_b32 v96, 5, v0
    v_lshl_add_u32 v8, v96, 8, v8
    v_bfe_u32 v96, v0, 2, 1
    v_lshl_add_u32 v8, v96, 7, v8
    v_and_b32 v96, 3, v0
    v_lshl_add_u32 v8, v96, 3, v8
    v_add_u32 v11, 67584, v8
    v_add_u32 v0, 135168, v8
    v_cmp_ge_u32 vcc, 1, v96
    v_mov_b32 v96, 0x3f803f80
    s_nop 0
    v_cndmask_b32 v96, 0, v96, vcc
    v_mov_b32 v12, 0x7f800000
    v_accvgpr_write_b32 a252, v96
    v_mov_b32 v13, 0x7f800000
    v_accvgpr_write_b32 a253, v96
    v_mov_b32 v14, 0x7f800000
    v_accvgpr_write_b32 a254, v96
    v_mov_b32 v15, 0x7f800000
    v_accvgpr_write_b32 a255, v96
    L_setup_done:
    s_branch L_main
    .p2align 12
    L_main:
    s_add_u32 m0, s30, 101248
    s_nop 0
    buffer_load_dwordx4 v2, s[8:11], s53 offen offset:128 nt lds
    s_add_u32 m0, s30, 33792
    s_nop 0
    buffer_load_dwordx4 v1, s[12:15], s34 offen offset:0 nt lds
    s_add_u32 m0, s30, 101280
    s_nop 0
    buffer_load_dwordx4 v2, s[8:11], s53 offen offset:1152 nt lds
    s_add_u32 m0, s30, 34336
    s_nop 0
    buffer_load_dwordx4 v1, s[12:15], s34 offen offset:512 nt lds
    s_add_u32 m0, s30, 101312
    s_nop 0
    buffer_load_dwordx4 v2, s[8:11], s53 offen offset:2176 nt lds
    s_add_u32 m0, s30, 34880
    s_nop 0
    buffer_load_dwordx4 v1, s[12:15], s34 offen offset:1024 nt lds
    s_add_u32 m0, s30, 101344
    s_nop 0
    buffer_load_dwordx4 v2, s[8:11], s53 offen offset:3200 nt lds
    s_add_u32 m0, s30, 35424
    s_nop 0
    buffer_load_dwordx4 v1, s[12:15], s34 offen offset:1536 nt lds
    v_mov_b32 v252, 0x44400000
    v_mov_b32 v253, 0x44400000
    v_mov_b32 v254, 0x44400000
    v_mov_b32 v255, 0x44400000
    v_bfe_u32 v10, v1, 4, 1
    v_mul_u32_u24 v10, 0xaaaa, v10
    v_or_b32 v10, 0x4444, v10
    v_lshl_or_b32 v10, v10, 16, v10
    v_accvgpr_write_b32 a208, 0
    v_accvgpr_write_b32 a209, 0
    v_accvgpr_write_b32 a210, 0
    v_accvgpr_write_b32 a211, 0
    v_accvgpr_write_b32 a212, 0
    v_accvgpr_write_b32 a213, 0
    v_accvgpr_write_b32 a214, 0
    v_accvgpr_write_b32 a215, 0
    v_accvgpr_write_b32 a216, 0
    v_accvgpr_write_b32 a217, 0
    v_accvgpr_write_b32 a218, 0
    v_accvgpr_write_b32 a219, 0
    v_accvgpr_write_b32 a220, 0
    v_accvgpr_write_b32 a221, 0
    v_accvgpr_write_b32 a222, 0
    v_accvgpr_write_b32 a223, 0
    v_mbcnt_lo_u32_b32 v96, -1, 0
    v_mbcnt_hi_u32_b32 v96, -1, v96
    v_lshrrev_b32 v248, 3, v96
    v_lshlrev_b32 v248, 9, v248
    v_bfe_u32 v98, v96, 2, 1
    v_lshl_add_u32 v98, v98, 7, s100
    v_and_b32 v98, 0x180, v98
    v_lshrrev_b32 v249, 2, v96
    v_and_b32 v96, 3, v96
    v_lshlrev_b32 v96, 2, v96
    v_or3_b32 v248, v248, v96, v98
    v_and_b32 v96, 12, v96
    v_lshl_or_b32 v249, v249, 9, v96
    s_mov_b64 exec, 0
    s_cmp_eq_u32 s3, 1
    s_cbranch_scc1 L_pg2
    s_cmp_eq_u32 s3, 2
    s_cbranch_scc1 L_pg3
    s_cmp_eq_u32 s3, 3
    s_cbranch_scc1 L_pg4
    s_branch L_pg1
    L_warm_done:
    s_mov_b64 exec, -1
    s_add_u32 m0, s30, 118016
    s_nop 0
    buffer_load_dwordx4 v2, s[8:11], s53 offen offset:256 nt lds
    s_add_u32 m0, s30, 118048
    s_nop 0
    buffer_load_dwordx4 v2, s[8:11], s53 offen offset:1280 nt lds
    s_add_u32 m0, s30, 118080
    s_nop 0
    buffer_load_dwordx4 v2, s[8:11], s53 offen offset:2304 nt lds
    s_add_u32 m0, s30, 118112
    s_nop 0
    buffer_load_dwordx4 v2, s[8:11], s53 offen offset:3328 nt lds
    s_add_u32 m0, s30, 134784
    s_nop 0
    buffer_load_dwordx4 v2, s[8:11], s53 offen offset:384 nt lds
    s_add_u32 m0, s30, 134816
    s_nop 0
    buffer_load_dwordx4 v2, s[8:11], s53 offen offset:1408 nt lds
    s_add_u32 m0, s30, 134848
    s_nop 0
    buffer_load_dwordx4 v2, s[8:11], s53 offen offset:2432 nt lds
    s_add_u32 m0, s30, 134880
    s_nop 0
    buffer_load_dwordx4 v2, s[8:11], s53 offen offset:3456 nt lds
    s_waitcnt vmcnt(16)
    s_barrier
    ds_read_b128 v[224:227], v5 offset:0
    ds_read_b128 a[0:3], v3 offset:0
    ds_read_b128 a[32:35], v3 offset:512
    ds_read_b128 v[232:235], v5 offset:64
    ds_read_b128 a[4:7], v3 offset:64
    ds_read_b128 a[36:39], v3 offset:576
    ds_read_b128 v[240:243], v5 offset:8448
    ds_read_b128 v[104:107], v5 offset:8512
    ds_read_b128 v[112:115], v5 offset:16896
    ds_read_b128 v[120:123], v5 offset:16960
    ds_read_b128 v[108:111], v5 offset:25344
    s_waitcnt lgkmcnt(9)
    v_mfma_f32_16x16x32_bf16 v[16:19], v[224:227], a[0:3], v[252:255]
    s_waitcnt lgkmcnt(6)
    ds_read_b128 v[116:119], v5 offset:25408
    v_mfma_f32_16x16x32_bf16 v[16:19], v[232:235], a[4:7], v[16:19]
    s_waitcnt lgkmcnt(6)
    ds_read_b128 v[124:127], v5 offset:128
    v_mfma_f32_16x16x32_bf16 v[20:23], v[232:235], a[36:39], v[252:255]
    s_waitcnt vmcnt(9)
    ds_read_b128 a[8:11], v3 offset:16896
    v_mfma_f32_16x16x32_bf16 v[20:23], v[224:227], a[32:35], v[20:23]
    s_waitcnt lgkmcnt(7)
    ds_read_b128 a[40:43], v3 offset:17408
    v_mfma_f32_16x16x32_bf16 v[24:27], v[240:243], a[0:3], v[252:255]
    s_waitcnt lgkmcnt(7)
    ds_read_b128 v[80:83], v5 offset:192
    v_mfma_f32_16x16x32_bf16 v[24:27], v[104:107], a[4:7], v[24:27]
    ds_read_b128 a[12:15], v3 offset:16960
    v_mfma_f32_16x16x32_bf16 v[28:31], v[104:107], a[36:39], v[252:255]
    ds_read_b128 a[44:47], v3 offset:17472
    v_mfma_f32_16x16x32_bf16 v[28:31], v[240:243], a[32:35], v[28:31]
    s_waitcnt lgkmcnt(9)
    ds_read_b128 v[84:87], v5 offset:8576
    v_mfma_f32_16x16x32_bf16 v[32:35], v[112:115], a[0:3], v[252:255]
    s_waitcnt lgkmcnt(9)
    ds_read_b128 v[88:91], v5 offset:8640
    v_mfma_f32_16x16x32_bf16 v[32:35], v[120:123], a[4:7], v[32:35]
    ds_read_b128 v[92:95], v5 offset:17024
    v_mfma_f32_16x16x32_bf16 v[36:39], v[120:123], a[36:39], v[252:255]
    ds_read_b128 v[224:227], v5 offset:17088
    v_mfma_f32_16x16x32_bf16 v[36:39], v[112:115], a[32:35], v[36:39]
    s_waitcnt lgkmcnt(11)
    ds_read_b128 v[232:235], v5 offset:25472
    v_mfma_f32_16x16x32_bf16 v[40:43], v[108:111], a[0:3], v[252:255]
    s_waitcnt lgkmcnt(11)
    v_mfma_f32_16x16x32_bf16 v[40:43], v[116:119], a[4:7], v[40:43]
    ds_read_b128 v[240:243], v5 offset:25536
    v_mfma_f32_16x16x32_bf16 v[44:47], v[116:119], a[36:39], v[252:255]
    v_mfma_f32_16x16x32_bf16 v[44:47], v[108:111], a[32:35], v[44:47]
    s_waitcnt lgkmcnt(10)
    v_mfma_f32_16x16x32_bf16 v[16:19], v[124:127], a[8:11], v[16:19]
    s_waitcnt lgkmcnt(7)
    v_mfma_f32_16x16x32_bf16 v[16:19], v[80:83], a[12:15], v[16:19]
    s_waitcnt lgkmcnt(6)
    v_mfma_f32_16x16x32_bf16 v[20:23], v[80:83], a[44:47], v[20:23]
    s_add_u32 m0, s30, 84480
    s_waitcnt vmcnt(8)
    s_barrier
    v_mfma_f32_16x16x32_bf16 v[20:23], v[124:127], a[40:43], v[20:23]
    s_waitcnt lgkmcnt(5)
    buffer_load_dwordx4 v2, s[8:11], s55 offen offset:0 nt lds
    v_mfma_f32_16x16x32_bf16 v[24:27], v[84:87], a[8:11], v[24:27]
    s_waitcnt lgkmcnt(4)
    ds_read_b128 v[104:107], v5 offset:33792
    v_mfma_f32_16x16x32_bf16 v[24:27], v[88:91], a[12:15], v[24:27]
    s_add_u32 m0, s30, 50688
    ds_read_b128 v[112:115], v5 offset:33856
    v_mfma_f32_16x16x32_bf16 v[28:31], v[88:91], a[44:47], v[28:31]
    buffer_load_dwordx4 v1, s[12:15], s35 offen offset:0 nt lds
    v_mfma_f32_16x16x32_bf16 v[28:31], v[84:87], a[40:43], v[28:31]
    s_waitcnt lgkmcnt(5)
    ds_read_b128 v[120:123], v5 offset:42240
    v_mfma_f32_16x16x32_bf16 v[32:35], v[92:95], a[8:11], v[32:35]
    s_waitcnt lgkmcnt(5)
    ds_read_b128 v[108:111], v5 offset:42304
    v_mfma_f32_16x16x32_bf16 v[32:35], v[224:227], a[12:15], v[32:35]
    s_add_u32 m0, s30, 84512
    ds_read_b128 v[116:119], v5 offset:33920
    v_mfma_f32_16x16x32_bf16 v[36:39], v[224:227], a[44:47], v[36:39]
    ds_read_b128 v[124:127], v5 offset:33984
    v_mfma_f32_16x16x32_bf16 v[36:39], v[92:95], a[40:43], v[36:39]
    s_waitcnt lgkmcnt(7)
    buffer_load_dwordx4 v2, s[8:11], s55 offen offset:1024 nt lds
    v_mfma_f32_16x16x32_bf16 v[40:43], v[232:235], a[8:11], v[40:43]
    s_waitcnt lgkmcnt(6)
    ds_read_b128 v[80:83], v5 offset:42368
    v_mfma_f32_16x16x32_bf16 v[40:43], v[240:243], a[12:15], v[40:43]
    ds_read_b128 v[84:87], v5 offset:42432
    v_mfma_f32_16x16x32_bf16 v[44:47], v[240:243], a[44:47], v[44:47]
    v_mfma_f32_16x16x32_bf16 v[44:47], v[232:235], a[40:43], v[44:47]
    s_waitcnt lgkmcnt(7)
    ds_read_b128 v[88:91], v5 offset:256
    v_mfma_f32_16x16x32_bf16 v[48:51], v[104:107], a[0:3], v[252:255]
    s_waitcnt lgkmcnt(7)
    s_waitcnt vmcnt(7)
    ds_read_b128 a[16:19], v3 offset:33792
    v_mfma_f32_16x16x32_bf16 v[48:51], v[112:115], a[4:7], v[48:51]
    s_add_u32 m0, s30, 51232
    ds_read_b128 a[48:51], v3 offset:34304
    v_mfma_f32_16x16x32_bf16 v[52:55], v[112:115], a[36:39], v[252:255]
    buffer_load_dwordx4 v1, s[12:15], s35 offen offset:512 nt lds
    v_mfma_f32_16x16x32_bf16 v[52:55], v[104:107], a[32:35], v[52:55]
    s_waitcnt lgkmcnt(8)
    ds_read_b128 v[92:95], v5 offset:320
    v_mfma_f32_16x16x32_bf16 v[56:59], v[120:123], a[0:3], v[252:255]
    s_waitcnt lgkmcnt(8)
    ds_read_b128 a[20:23], v3 offset:33856
    v_mfma_f32_16x16x32_bf16 v[56:59], v[108:111], a[4:7], v[56:59]
    s_add_u32 m0, s30, 84544
    ds_read_b128 a[52:55], v3 offset:34368
    v_mfma_f32_16x16x32_bf16 v[60:63], v[108:111], a[36:39], v[252:255]
    buffer_load_dwordx4 v2, s[8:11], s55 offen offset:2048 nt lds
    v_mfma_f32_16x16x32_bf16 v[60:63], v[120:123], a[32:35], v[60:63]
    s_waitcnt lgkmcnt(9)
    ds_read_b128 v[224:227], v5 offset:8704
    v_mfma_f32_16x16x32_bf16 v[48:51], v[116:119], a[8:11], v[48:51]
    s_waitcnt lgkmcnt(9)
    ds_read_b128 v[232:235], v5 offset:8768
    v_mfma_f32_16x16x32_bf16 v[48:51], v[124:127], a[12:15], v[48:51]
    s_add_u32 m0, s30, 51776
    ds_read_b128 v[240:243], v5 offset:17152
    v_mfma_f32_16x16x32_bf16 v[52:55], v[124:127], a[44:47], v[52:55]
    ds_read_b128 v[104:107], v5 offset:17216
    v_mfma_f32_16x16x32_bf16 v[52:55], v[116:119], a[40:43], v[52:55]
    s_waitcnt lgkmcnt(11)
    buffer_load_dwordx4 v1, s[12:15], s35 offen offset:1024 nt lds
    v_mfma_f32_16x16x32_bf16 v[56:59], v[80:83], a[8:11], v[56:59]
    s_waitcnt lgkmcnt(10)
    ds_read_b128 v[112:115], v5 offset:25600
    v_mfma_f32_16x16x32_bf16 v[56:59], v[84:87], a[12:15], v[56:59]
    ds_read_b128 v[120:123], v5 offset:25664
    v_mfma_f32_16x16x32_bf16 v[60:63], v[84:87], a[44:47], v[60:63]
    s_add_u32 m0, s30, 84576
    v_mfma_f32_16x16x32_bf16 v[60:63], v[80:83], a[40:43], v[60:63]
    s_waitcnt lgkmcnt(10)
    ds_read_b128 v[108:111], v5 offset:34048
    v_mfma_f32_16x16x32_bf16 v[16:19], v[88:91], a[16:19], v[16:19]
    s_waitcnt lgkmcnt(8)
    buffer_load_dwordx4 v2, s[8:11], s55 offen offset:3072 nt lds
    v_mfma_f32_16x16x32_bf16 v[16:19], v[92:95], a[20:23], v[16:19]
    s_waitcnt lgkmcnt(7)
    ds_read_b128 v[116:119], v5 offset:34112
    v_mfma_f32_16x16x32_bf16 v[20:23], v[92:95], a[52:55], v[20:23]
    v_mfma_f32_16x16x32_bf16 v[20:23], v[88:91], a[48:51], v[20:23]
    s_waitcnt lgkmcnt(7)
    ds_read_b128 v[124:127], v5 offset:42496
    v_mfma_f32_16x16x32_bf16 v[24:27], v[224:227], a[16:19], v[24:27]
    s_waitcnt lgkmcnt(7)
    v_mfma_f32_16x16x32_bf16 v[24:27], v[232:235], a[20:23], v[24:27]
    s_add_u32 m0, s30, 52320
    ds_read_b128 v[80:83], v5 offset:42560
    v_mfma_f32_16x16x32_bf16 v[28:31], v[232:235], a[52:55], v[28:31]
    buffer_load_dwordx4 v1, s[12:15], s35 offen offset:1536 nt lds
    v_mfma_f32_16x16x32_bf16 v[28:31], v[224:227], a[48:51], v[28:31]
    s_waitcnt lgkmcnt(7)
    ds_read_b128 v[84:87], v5 offset:384
    v_mfma_f32_16x16x32_bf16 v[32:35], v[240:243], a[16:19], v[32:35]
    s_waitcnt lgkmcnt(7)
    s_waitcnt vmcnt(8)
    ds_read_b128 a[24:27], v3 offset:50688
    v_mfma_f32_16x16x32_bf16 v[32:35], v[104:107], a[20:23], v[32:35]
    s_add_u32 m0, s30, 101248
    ds_read_b128 a[56:59], v3 offset:51200
    v_mfma_f32_16x16x32_bf16 v[36:39], v[104:107], a[52:55], v[36:39]
    buffer_load_dwordx4 v2, s[8:11], s55 offen offset:128 nt lds
    v_mfma_f32_16x16x32_bf16 v[36:39], v[240:243], a[48:51], v[36:39]
    s_waitcnt lgkmcnt(8)
    ds_read_b128 v[88:91], v5 offset:448
    v_mfma_f32_16x16x32_bf16 v[40:43], v[112:115], a[16:19], v[40:43]
    s_waitcnt lgkmcnt(8)
    ds_read_b128 a[28:31], v3 offset:50752
    v_mfma_f32_16x16x32_bf16 v[40:43], v[120:123], a[20:23], v[40:43]
    ds_read_b128 a[60:63], v3 offset:51264
    v_mfma_f32_16x16x32_bf16 v[44:47], v[120:123], a[52:55], v[44:47]
    ds_read_b128 v[92:95], v5 offset:8832
    v_mfma_f32_16x16x32_bf16 v[44:47], v[112:115], a[48:51], v[44:47]
    s_waitcnt lgkmcnt(10)
    ds_read_b128 v[224:227], v5 offset:8896
    v_mfma_f32_16x16x32_bf16 v[48:51], v[108:111], a[16:19], v[48:51]
    s_waitcnt lgkmcnt(10)
    ds_read_b128 v[232:235], v5 offset:17280
    v_mfma_f32_16x16x32_bf16 v[48:51], v[116:119], a[20:23], v[48:51]
    s_add_u32 m0, s30, 101280
    ds_read_b128 v[240:243], v5 offset:17344
    v_mfma_f32_16x16x32_bf16 v[52:55], v[116:119], a[52:55], v[52:55]
    buffer_load_dwordx4 v2, s[8:11], s55 offen offset:1152 nt lds
    v_mfma_f32_16x16x32_bf16 v[52:55], v[108:111], a[48:51], v[52:55]
    s_waitcnt lgkmcnt(11)
    ds_read_b128 v[104:107], v5 offset:25728
    v_mfma_f32_16x16x32_bf16 v[56:59], v[124:127], a[16:19], v[56:59]
    s_waitcnt lgkmcnt(11)
    v_mfma_f32_16x16x32_bf16 v[56:59], v[80:83], a[20:23], v[56:59]
    ds_read_b128 v[112:115], v5 offset:25792
    v_mfma_f32_16x16x32_bf16 v[60:63], v[80:83], a[52:55], v[60:63]
    v_mfma_f32_16x16x32_bf16 v[60:63], v[124:127], a[48:51], v[60:63]
    s_waitcnt lgkmcnt(10)
    ds_read_b128 v[120:123], v5 offset:34176
    v_mfma_f32_16x16x32_bf16 v[16:19], v[84:87], a[24:27], v[16:19]
    s_waitcnt lgkmcnt(8)
    v_mfma_f32_16x16x32_bf16 v[16:19], v[88:91], a[28:31], v[16:19]
    s_waitcnt lgkmcnt(7)
    ds_read_b128 v[108:111], v5 offset:34240
    v_mfma_f32_16x16x32_bf16 v[20:23], v[88:91], a[60:63], v[20:23]
    s_add_u32 m0, s30, 101312
    v_mfma_f32_16x16x32_bf16 v[20:23], v[84:87], a[56:59], v[20:23]
    s_waitcnt lgkmcnt(7)
    buffer_load_dwordx4 v2, s[8:11], s55 offen offset:2176 nt lds
    v_mfma_f32_16x16x32_bf16 v[24:27], v[92:95], a[24:27], v[24:27]
    s_waitcnt lgkmcnt(6)
    ds_read_b128 v[116:119], v5 offset:42624
    v_mfma_f32_16x16x32_bf16 v[24:27], v[224:227], a[28:31], v[24:27]
    ds_read_b128 v[124:127], v5 offset:42688
    v_max3_f32 v102, v16, v17, v18
    v_mfma_f32_16x16x32_bf16 v[28:31], v[224:227], a[60:63], v[28:31]
    v_max_f32 v102, v102, v19
    v_mov_b32 v103, v102
    v_mfma_f32_16x16x32_bf16 v[28:31], v[92:95], a[56:59], v[28:31]
    s_waitcnt lgkmcnt(7)
    v_permlane16_swap_b32 v102, v103
    v_mfma_f32_16x16x32_bf16 v[32:35], v[232:235], a[24:27], v[32:35]
    s_waitcnt lgkmcnt(6)
    ds_read_b128 v[80:83], v5 offset:0
    v_max_f32 v102, v102, v103
    v_mfma_f32_16x16x32_bf16 v[32:35], v[240:243], a[28:31], v[32:35]
    s_add_u32 m0, s30, 101344
    s_waitcnt vmcnt(4)
    ds_read_b128 a[64:67], v3 offset:0
    v_mfma_f32_16x16x32_bf16 v[36:39], v[240:243], a[60:63], v[36:39]
    buffer_load_dwordx4 v2, s[8:11], s55 offen offset:3200 nt lds
    v_mfma_f32_16x16x32_bf16 v[36:39], v[232:235], a[56:59], v[36:39]
    s_waitcnt lgkmcnt(7)
    ds_read_b128 a[96:99], v3 offset:512
    v_mov_b32 v103, v102
    v_mfma_f32_16x16x32_bf16 v[40:43], v[104:107], a[24:27], v[40:43]
    s_waitcnt lgkmcnt(7)
    v_permlane32_swap_b32 v102, v103
    v_max_f32 v102, v102, v103
    v_mfma_f32_16x16x32_bf16 v[40:43], v[112:115], a[28:31], v[40:43]
    ds_read_b128 v[84:87], v5 offset:64
    v_mul_f32 v102, s60, v102
    v_mfma_f32_16x16x32_bf16 v[44:47], v[112:115], a[60:63], v[44:47]
    ds_read_b128 a[68:71], v3 offset:64
    ds_read_b128 a[100:103], v3 offset:576
    v_min_f32 v12, v12, v102
    v_fma_f32 v16, v16, s31, v12
    v_mfma_f32_16x16x32_bf16 v[44:47], v[104:107], a[56:59], v[44:47]
    s_waitcnt lgkmcnt(9)
    v_exp_f32 v16, v16
    v_fma_f32 v17, v17, s31, v12
    v_mfma_f32_16x16x32_bf16 v[48:51], v[120:123], a[24:27], v[48:51]
    s_waitcnt lgkmcnt(8)
    ds_read_b128 v[88:91], v5 offset:8448
    v_fma_f32 v18, v18, s31, v12
    v_exp_f32 v17, v17
    v_mfma_f32_16x16x32_bf16 v[48:51], v[108:111], a[28:31], v[48:51]
    s_add_u32 m0, s30, 118016
    ds_read_b128 v[92:95], v5 offset:8512
    v_cvt_pk_bf16_f32 v16, v16, v17
    v_mfma_f32_16x16x32_bf16 v[52:55], v[108:111], a[60:63], v[52:55]
    buffer_load_dwordx4 v2, s[8:11], s55 offen offset:256 nt lds
    v_exp_f32 v18, v18
    v_mfma_f32_16x16x32_bf16 v[52:55], v[120:123], a[56:59], v[52:55]
    s_waitcnt lgkmcnt(9)
    ds_read_b128 v[224:227], v5 offset:16896
    v_fma_f32 v19, v19, s31, v12
    v_mfma_f32_16x16x32_bf16 v[56:59], v[116:119], a[24:27], v[56:59]
    s_waitcnt lgkmcnt(9)
    v_exp_f32 v19, v19
    v_mfma_f32_16x16x32_bf16 v[56:59], v[124:127], a[28:31], v[56:59]
    ds_read_b128 v[232:235], v5 offset:16960
    v_accvgpr_write_b32 a128, v16
    v_max3_f32 v102, v20, v21, v22
    v_mfma_f32_16x16x32_bf16 v[60:63], v[124:127], a[60:63], v[60:63]
    ds_read_b128 v[240:243], v5 offset:25344
    v_max_f32 v102, v102, v23
    v_cvt_pk_bf16_f32 v18, v18, v19
    v_mfma_f32_16x16x32_bf16 v[60:63], v[116:119], a[56:59], v[60:63]
    s_waitcnt lgkmcnt(9)
    ds_read_b128 v[104:107], v5 offset:25408
    v_mov_b32 v103, v102
    v_accvgpr_write_b32 a129, v18
    v_mfma_f32_16x16x32_bf16 v[128:131], v[80:83], a[64:67], v[252:255]
    s_waitcnt lgkmcnt(7)
    v_permlane16_swap_b32 v102, v103
    v_max_f32 v102, v102, v103
    v_mov_b32 v103, v102
    v_mfma_f32_16x16x32_bf16 v[128:131], v[84:87], a[68:71], v[128:131]
    s_waitcnt lgkmcnt(6)
    v_permlane32_swap_b32 v102, v103
    v_mfma_f32_16x16x32_bf16 v[136:139], v[84:87], a[100:103], v[252:255]
    ds_read_b128 v[112:115], v5 offset:33792
    v_max_f32 v102, v102, v103
    v_mul_f32 v102, s60, v102
    v_min_f32 v13, v13, v102
    v_mfma_f32_16x16x32_bf16 v[136:139], v[80:83], a[96:99], v[136:139]
    s_waitcnt lgkmcnt(6)
    ds_read_b128 v[120:123], v5 offset:33856
    v_fma_f32 v20, v20, s31, v13
    v_exp_f32 v20, v20
    v_mfma_f32_16x16x32_bf16 v[144:147], v[88:91], a[64:67], v[252:255]
    s_waitcnt lgkmcnt(6)
    ds_read_b128 v[108:111], v5 offset:42240
    v_fma_f32 v21, v21, s31, v13
    v_mfma_f32_16x16x32_bf16 v[144:147], v[92:95], a[68:71], v[144:147]
    s_add_u32 m0, s30, 118048
    v_exp_f32 v21, v21
    v_mfma_f32_16x16x32_bf16 v[152:155], v[92:95], a[100:103], v[252:255]
    ds_read_b128 v[116:119], v5 offset:42304
    v_fma_f32 v22, v22, s31, v13
    v_exp_f32 v22, v22
    v_mfma_f32_16x16x32_bf16 v[152:155], v[88:91], a[96:99], v[152:155]
    s_waitcnt lgkmcnt(7)
    v_cvt_pk_bf16_f32 v20, v20, v21
    v_fma_f32 v23, v23, s31, v13
    v_exp_f32 v23, v23
    v_mfma_f32_16x16x32_bf16 v[132:135], v[224:227], a[64:67], v[252:255]
    s_waitcnt lgkmcnt(6)
    s_waitcnt vmcnt(5)
    s_barrier
    buffer_load_dwordx4 v2, s[8:11], s55 offen offset:1280 nt lds
    v_mfma_f32_16x16x32_bf16 v[132:135], v[232:235], a[68:71], v[132:135]
    ds_read_b128 v[124:127], v5 offset:50688
    v_accvgpr_write_b32 a136, v20
    v_fma_f32 v24, v24, s31, v12
    v_mfma_f32_16x16x32_bf16 v[140:143], v[232:235], a[100:103], v[252:255]
    v_exp_f32 v24, v24
    v_cvt_pk_bf16_f32 v22, v22, v23
    v_mfma_f32_16x16x32_bf16 v[140:143], v[224:227], a[96:99], v[140:143]
    s_waitcnt lgkmcnt(6)
    ds_read_b128 v[80:83], v5 offset:50752
    v_fma_f32 v25, v25, s31, v12
    v_mfma_f32_16x16x32_bf16 v[148:151], v[240:243], a[64:67], v[252:255]
    s_waitcnt lgkmcnt(6)
    v_exp_f32 v25, v25
    v_mfma_f32_16x16x32_bf16 v[148:151], v[104:107], a[68:71], v[148:151]
    ds_read_b128 v[84:87], v5 offset:59136
    v_accvgpr_write_b32 a137, v22
    v_fma_f32 v26, v26, s31, v12
    v_exp_f32 v26, v26
    v_mfma_f32_16x16x32_bf16 v[156:159], v[104:107], a[100:103], v[252:255]
    v_cvt_pk_bf16_f32 v24, v24, v25
    v_fma_f32 v27, v27, s31, v12
    v_mfma_f32_16x16x32_bf16 v[156:159], v[240:243], a[96:99], v[156:159]
    s_waitcnt lgkmcnt(6)
    v_exp_f32 v27, v27
    v_mfma_f32_16x16x32_bf16 v[160:163], v[112:115], a[64:67], v[252:255]
    s_waitcnt lgkmcnt(5)
    v_accvgpr_write_b32 a130, v24
    v_fma_f32 v28, v28, s31, v13
    v_mfma_f32_16x16x32_bf16 v[160:163], v[120:123], a[68:71], v[160:163]
    v_exp_f32 v28, v28
    v_cvt_pk_bf16_f32 v26, v26, v27
    v_mfma_f32_16x16x32_bf16 v[168:171], v[120:123], a[100:103], v[252:255]
    s_add_u32 m0, s30, 118080
    ds_read_b128 v[88:91], v5 offset:59200
    v_fma_f32 v29, v29, s31, v13
    v_mfma_f32_16x16x32_bf16 v[168:171], v[112:115], a[96:99], v[168:171]
    s_waitcnt lgkmcnt(5)
    v_exp_f32 v29, v29
    v_accvgpr_write_b32 a131, v26
    v_fma_f32 v30, v30, s31, v13
    v_exp_f32 v30, v30
    v_mfma_f32_16x16x32_bf16 v[176:179], v[108:111], a[64:67], v[252:255]
    s_waitcnt lgkmcnt(4)
    buffer_load_dwordx4 v2, s[8:11], s55 offen offset:2304 nt lds
    v_mfma_f32_16x16x32_bf16 v[176:179], v[116:119], a[68:71], v[176:179]
    v_cvt_pk_bf16_f32 v28, v28, v29
    v_fma_f32 v31, v31, s31, v13
    v_mfma_f32_16x16x32_bf16 v[184:187], v[116:119], a[100:103], v[252:255]
    v_exp_f32 v31, v31
    v_mfma_f32_16x16x32_bf16 v[184:187], v[108:111], a[96:99], v[184:187]
    s_waitcnt lgkmcnt(3)
    ds_read_b128 v[92:95], v5 offset:50816
    v_accvgpr_write_b32 a138, v28
    v_fma_f32 v32, v32, s31, v12
    v_mfma_f32_16x16x32_bf16 v[64:67], v[124:127], a[0:3], v[252:255]
    s_waitcnt lgkmcnt(3)
    v_exp_f32 v32, v32
    v_mfma_f32_16x16x32_bf16 v[64:67], v[80:83], a[4:7], v[64:67]
    ds_read_b128 v[224:227], v5 offset:50880
    v_cvt_pk_bf16_f32 v30, v30, v31
    v_fma_f32 v33, v33, s31, v12
    v_mfma_f32_16x16x32_bf16 v[68:71], v[80:83], a[36:39], v[252:255]
    v_accvgpr_write_b32 a139, v30
    v_fma_f32 v34, v34, s31, v12
    v_mfma_f32_16x16x32_bf16 v[68:71], v[124:127], a[32:35], v[68:71]
    v_exp_f32 v33, v33
    v_mfma_f32_16x16x32_bf16 v[164:167], v[124:127], a[64:67], v[252:255]
    ds_read_b128 v[232:235], v5 offset:59264
    v_cvt_pk_bf16_f32 v32, v32, v33
    v_mfma_f32_16x16x32_bf16 v[164:167], v[80:83], a[68:71], v[164:167]
    v_exp_f32 v34, v34
    v_mfma_f32_16x16x32_bf16 v[172:175], v[80:83], a[100:103], v[252:255]
    ds_read_b128 v[240:243], v5 offset:59328
    v_fma_f32 v35, v35, s31, v12
    v_mfma_f32_16x16x32_bf16 v[172:175], v[124:127], a[96:99], v[172:175]
    s_waitcnt lgkmcnt(5)
    ds_read_b128 v[104:107], v5 offset:50944
    v_accvgpr_write_b32 a132, v32
    v_mfma_f32_16x16x32_bf16 v[72:75], v[84:87], a[0:3], v[252:255]
    s_waitcnt lgkmcnt(5)
    v_exp_f32 v35, v35
    v_mfma_f32_16x16x32_bf16 v[72:75], v[88:91], a[4:7], v[72:75]
    s_add_u32 m0, s30, 118112
    ds_read_b128 v[112:115], v5 offset:51008
    v_fma_f32 v36, v36, s31, v13
    v_cvt_pk_bf16_f32 v34, v34, v35
    v_exp_f32 v36, v36
    v_mfma_f32_16x16x32_bf16 v[76:79], v[88:91], a[36:39], v[252:255]
    buffer_load_dwordx4 v2, s[8:11], s55 offen offset:3328 nt lds
    v_fma_f32 v37, v37, s31, v13
    v_mfma_f32_16x16x32_bf16 v[76:79], v[84:87], a[32:35], v[76:79]
    ds_read_b128 v[120:123], v5 offset:59392
    v_accvgpr_write_b32 a133, v34
    v_mfma_f32_16x16x32_bf16 v[180:183], v[84:87], a[64:67], v[252:255]
    v_exp_f32 v37, v37
    v_mfma_f32_16x16x32_bf16 v[180:183], v[88:91], a[68:71], v[180:183]
    ds_read_b128 v[108:111], v5 offset:59456
    v_fma_f32 v38, v38, s31, v13
    v_mfma_f32_16x16x32_bf16 v[188:191], v[88:91], a[100:103], v[252:255]
    v_cvt_pk_bf16_f32 v36, v36, v37
    v_fma_f32 v39, v39, s31, v13
    v_mfma_f32_16x16x32_bf16 v[188:191], v[84:87], a[96:99], v[188:191]
    s_waitcnt lgkmcnt(7)
    v_exp_f32 v38, v38
    v_mfma_f32_16x16x32_bf16 v[64:67], v[92:95], a[8:11], v[64:67]
    s_waitcnt lgkmcnt(6)
    ds_read_b128 v[116:119], v5 offset:51072
    v_accvgpr_write_b32 a140, v36
    v_mfma_f32_16x16x32_bf16 v[64:67], v[224:227], a[12:15], v[64:67]
    v_exp_f32 v39, v39
    v_mfma_f32_16x16x32_bf16 v[68:71], v[224:227], a[44:47], v[68:71]
    ds_read_b128 v[124:127], v5 offset:51136
    v_fma_f32 v40, v40, s31, v12
    v_mfma_f32_16x16x32_bf16 v[68:71], v[92:95], a[40:43], v[68:71]
    s_waitcnt lgkmcnt(7)
    ds_read_b128 v[80:83], v5 offset:59520
    v_cvt_pk_bf16_f32 v38, v38, v39
    v_exp_f32 v40, v40
    v_mfma_f32_16x16x32_bf16 v[72:75], v[232:235], a[8:11], v[72:75]
    s_waitcnt lgkmcnt(7)
    v_fma_f32 v41, v41, s31, v12
    v_accvgpr_write_b32 a141, v38
    v_mfma_f32_16x16x32_bf16 v[72:75], v[240:243], a[12:15], v[72:75]
    s_add_u32 m0, s30, 134784
    v_exp_f32 v41, v41
    v_mfma_f32_16x16x32_bf16 v[76:79], v[240:243], a[44:47], v[76:79]
    ds_read_b128 v[84:87], v5 offset:59584
    v_fma_f32 v42, v42, s31, v12
    v_mfma_f32_16x16x32_bf16 v[76:79], v[232:235], a[40:43], v[76:79]
    s_waitcnt lgkmcnt(7)
    buffer_load_dwordx4 v2, s[8:11], s55 offen offset:384 nt lds
    v_mfma_f32_16x16x32_bf16 v[64:67], v[104:107], a[16:19], v[64:67]
    s_waitcnt lgkmcnt(6)
    ds_read_b128 v[88:91], v5 offset:128
    v_cvt_pk_bf16_f32 v40, v40, v41
    v_exp_f32 v42, v42
    v_mfma_f32_16x16x32_bf16 v[64:67], v[112:115], a[20:23], v[64:67]
    s_waitcnt vmcnt(5)
    ds_read_b128 a[72:75], v3 offset:16896
    v_fma_f32 v43, v43, s31, v12
    v_mfma_f32_16x16x32_bf16 v[68:71], v[112:115], a[52:55], v[68:71]
    ds_read_b128 a[104:107], v3 offset:17408
    v_accvgpr_write_b32 a134, v40
    v_mfma_f32_16x16x32_bf16 v[68:71], v[104:107], a[48:51], v[68:71]
    s_waitcnt lgkmcnt(8)
    v_exp_f32 v43, v43
    v_mfma_f32_16x16x32_bf16 v[72:75], v[120:123], a[16:19], v[72:75]
    s_waitcnt lgkmcnt(7)
    ds_read_b128 v[92:95], v5 offset:192
    v_fma_f32 v44, v44, s31, v13
    v_cvt_pk_bf16_f32 v42, v42, v43
    v_exp_f32 v44, v44
    v_mfma_f32_16x16x32_bf16 v[72:75], v[108:111], a[20:23], v[72:75]
    s_add_u32 m0, s30, 134816
    ds_read_b128 a[76:79], v3 offset:16960
    v_fma_f32 v45, v45, s31, v13
    v_accvgpr_write_b32 a135, v42
    v_mfma_f32_16x16x32_bf16 v[76:79], v[108:111], a[52:55], v[76:79]
    ds_read_b128 a[108:111], v3 offset:17472
    v_fma_f32 v46, v46, s31, v13
    v_exp_f32 v45, v45
    v_mfma_f32_16x16x32_bf16 v[76:79], v[120:123], a[48:51], v[76:79]
    s_waitcnt lgkmcnt(9)
    buffer_load_dwordx4 v2, s[8:11], s55 offen offset:1408 nt lds
    v_mfma_f32_16x16x32_bf16 v[64:67], v[116:119], a[24:27], v[64:67]
    s_waitcnt lgkmcnt(8)
    ds_read_b128 v[224:227], v5 offset:8576
    v_cvt_pk_bf16_f32 v44, v44, v45
    v_mfma_f32_16x16x32_bf16 v[64:67], v[124:127], a[28:31], v[64:67]
    v_exp_f32 v46, v46
    v_mfma_f32_16x16x32_bf16 v[68:71], v[124:127], a[60:63], v[68:71]
    ds_read_b128 v[232:235], v5 offset:8640
    v_fma_f32 v47, v47, s31, v13
    v_accvgpr_write_b32 a142, v44
    v_mfma_f32_16x16x32_bf16 v[68:71], v[116:119], a[56:59], v[68:71]
    s_waitcnt lgkmcnt(9)
    v_exp_f32 v47, v47
    v_mfma_f32_16x16x32_bf16 v[72:75], v[80:83], a[24:27], v[72:75]
    s_waitcnt lgkmcnt(8)
    ds_read_b128 v[240:243], v5 offset:17024
    v_fma_f32 v48, v48, s31, v12
    v_mfma_f32_16x16x32_bf16 v[72:75], v[84:87], a[28:31], v[72:75]
    s_add_u32 m0, s30, 134848
    ds_read_b128 v[104:107], v5 offset:17088
    v_cvt_pk_bf16_f32 v46, v46, v47
    v_exp_f32 v48, v48
    v_mfma_f32_16x16x32_bf16 v[76:79], v[84:87], a[60:63], v[76:79]
L_pg1:
    s_cbranch_execz L_pg5
    buffer_load_dwordx4 v2, s[8:11], s55 offen offset:2432 nt lds
    v_mfma_f32_16x16x32_bf16 v[76:79], v[80:83], a[56:59], v[76:79]
    s_waitcnt lgkmcnt(8)
    ds_read_b128 v[112:115], v5 offset:25472
    v_fma_f32 v49, v49, s31, v12
    v_mfma_f32_16x16x32_bf16 v[128:131], v[88:91], a[72:75], v[128:131]
    s_waitcnt lgkmcnt(6)
    ds_read_b128 v[120:123], v5 offset:25536
    v_accvgpr_write_b32 a143, v46
    v_mfma_f32_16x16x32_bf16 v[128:131], v[92:95], a[76:79], v[128:131]
    s_waitcnt lgkmcnt(6)
    v_exp_f32 v49, v49
    v_mfma_f32_16x16x32_bf16 v[136:139], v[92:95], a[108:111], v[136:139]
    ds_read_b128 v[108:111], v5 offset:33920
    v_fma_f32 v50, v50, s31, v12
    v_mfma_f32_16x16x32_bf16 v[136:139], v[88:91], a[104:107], v[136:139]
    s_waitcnt lgkmcnt(6)
    ds_read_b128 v[116:119], v5 offset:33984
    v_cvt_pk_bf16_f32 v48, v48, v49
    v_exp_f32 v50, v50
    v_mfma_f32_16x16x32_bf16 v[144:147], v[224:227], a[72:75], v[144:147]
    s_waitcnt lgkmcnt(6)
    ds_read_b128 v[124:127], v5 offset:42368
    v_accvgpr_write_b32 a160, v48
    v_mfma_f32_16x16x32_bf16 v[144:147], v[232:235], a[76:79], v[144:147]
    s_add_u32 m0, s30, 134880
    v_fma_f32 v51, v51, s31, v12
    v_fma_f32 v52, v52, s31, v13
    v_exp_f32 v51, v51
    v_mfma_f32_16x16x32_bf16 v[152:155], v[232:235], a[108:111], v[152:155]
    buffer_load_dwordx4 v2, s[8:11], s55 offen offset:3456 nt lds
    v_mfma_f32_16x16x32_bf16 v[152:155], v[224:227], a[104:107], v[152:155]
    s_waitcnt lgkmcnt(6)
    ds_read_b128 v[80:83], v5 offset:42432
    v_cvt_pk_bf16_f32 v50, v50, v51
    v_mfma_f32_16x16x32_bf16 v[132:135], v[240:243], a[72:75], v[132:135]
    s_waitcnt lgkmcnt(6)
    v_exp_f32 v52, v52
    v_mfma_f32_16x16x32_bf16 v[132:135], v[104:107], a[76:79], v[132:135]
    ds_read_b128 v[84:87], v5 offset:50816
    v_accvgpr_write_b32 a161, v50
    v_mfma_f32_16x16x32_bf16 v[140:143], v[104:107], a[108:111], v[140:143]
    v_fma_f32 v53, v53, s31, v13
    v_fma_f32 v54, v54, s31, v13
    v_mfma_f32_16x16x32_bf16 v[140:143], v[240:243], a[104:107], v[140:143]
    s_waitcnt lgkmcnt(6)
    v_exp_f32 v53, v53
    v_mfma_f32_16x16x32_bf16 v[148:151], v[112:115], a[72:75], v[148:151]
    s_waitcnt lgkmcnt(5)
    ds_read_b128 v[88:91], v5 offset:50880
    v_cvt_pk_bf16_f32 v52, v52, v53
    v_exp_f32 v54, v54
    v_mfma_f32_16x16x32_bf16 v[148:151], v[120:123], a[76:79], v[148:151]
    s_add_u32 m0, s30, 67584
    ds_read_b128 v[92:95], v5 offset:59264
    v_accvgpr_write_b32 a168, v52
    v_smfmac_f32_16x16x64_bf16 a[208:211], a[252:255], a[128:135], v10
    v_fma_f32 v55, v55, s31, v13
    v_exp_f32 v55, v55
    v_mfma_f32_16x16x32_bf16 v[156:159], v[120:123], a[108:111], v[156:159]
    buffer_load_dwordx4 v1, s[12:15], s36 offen offset:0 nt lds
    v_mfma_f32_16x16x32_bf16 v[156:159], v[112:115], a[104:107], v[156:159]
    s_waitcnt lgkmcnt(6)
    ds_read_b128 v[224:227], v5 offset:59328
    v_fma_f32 v56, v56, s31, v12
    v_mfma_f32_16x16x32_bf16 v[160:163], v[108:111], a[72:75], v[160:163]
    s_waitcnt lgkmcnt(6)
    ds_read_b128 v[232:235], v5 offset:256
    v_cvt_pk_bf16_f32 v54, v54, v55
    v_mfma_f32_16x16x32_bf16 v[160:163], v[116:119], a[76:79], v[160:163]
    v_exp_f32 v56, v56
    v_mfma_f32_16x16x32_bf16 v[168:171], v[116:119], a[108:111], v[168:171]
    s_add_u32 m0, s30, 68128
    s_waitcnt vmcnt(5)
    ds_read_b128 a[80:83], v3 offset:33792
    v_accvgpr_write_b32 a169, v54
    v_mfma_f32_16x16x32_bf16 v[168:171], v[108:111], a[104:107], v[168:171]
    s_waitcnt lgkmcnt(7)
    ds_read_b128 a[112:115], v3 offset:34304
    v_fma_f32 v57, v57, s31, v12
    v_exp_f32 v57, v57
    v_mfma_f32_16x16x32_bf16 v[176:179], v[124:127], a[72:75], v[176:179]
    s_waitcnt lgkmcnt(7)
    buffer_load_dwordx4 v1, s[12:15], s36 offen offset:512 nt lds
    v_mfma_f32_16x16x32_bf16 v[176:179], v[80:83], a[76:79], v[176:179]
    ds_read_b128 v[240:243], v5 offset:320
    v_fma_f32 v58, v58, s31, v12
    v_cvt_pk_bf16_f32 v56, v56, v57
    v_exp_f32 v58, v58
    v_smfmac_f32_16x16x64_bf16 a[212:215], a[252:255], a[136:143], v10
    ds_read_b128 a[84:87], v3 offset:33856
    v_mfma_f32_16x16x32_bf16 v[184:187], v[80:83], a[108:111], v[184:187]
    ds_read_b128 a[116:119], v3 offset:34368
    v_accvgpr_write_b32 a162, v56
    v_fma_f32 v59, v59, s31, v12
    v_mfma_f32_16x16x32_bf16 v[184:187], v[124:127], a[104:107], v[184:187]
    s_waitcnt lgkmcnt(9)
    v_exp_f32 v59, v59
    v_mfma_f32_16x16x32_bf16 v[164:167], v[84:87], a[72:75], v[164:167]
    s_waitcnt lgkmcnt(8)
    ds_read_b128 v[104:107], v5 offset:8704
    v_fma_f32 v60, v60, s31, v13
    v_mfma_f32_16x16x32_bf16 v[164:167], v[88:91], a[76:79], v[164:167]
    s_add_u32 m0, s30, 68672
    ds_read_b128 v[112:115], v5 offset:8768
    v_cvt_pk_bf16_f32 v58, v58, v59
    v_mfma_f32_16x16x32_bf16 v[172:175], v[88:91], a[108:111], v[172:175]
    v_exp_f32 v60, v60
    v_accvgpr_write_b32 a163, v58
    v_fma_f32 v61, v61, s31, v13
    v_mfma_f32_16x16x32_bf16 v[172:175], v[84:87], a[104:107], v[172:175]
    s_waitcnt lgkmcnt(9)
    buffer_load_dwordx4 v1, s[12:15], s36 offen offset:1024 nt lds
    v_mfma_f32_16x16x32_bf16 v[180:183], v[92:95], a[72:75], v[180:183]
    s_waitcnt lgkmcnt(8)
    ds_read_b128 v[120:123], v5 offset:17152
    v_fma_f32 v62, v62, s31, v13
    v_mfma_f32_16x16x32_bf16 v[180:183], v[224:227], a[76:79], v[180:183]
    v_exp_f32 v61, v61
    v_mfma_f32_16x16x32_bf16 v[188:191], v[224:227], a[108:111], v[188:191]
    ds_read_b128 v[108:111], v5 offset:17216
    v_cvt_pk_bf16_f32 v60, v60, v61
    v_mfma_f32_16x16x32_bf16 v[188:191], v[92:95], a[104:107], v[188:191]
    s_waitcnt lgkmcnt(8)
    v_exp_f32 v62, v62
    v_mfma_f32_16x16x32_bf16 v[128:131], v[232:235], a[80:83], v[128:131]
    s_waitcnt lgkmcnt(5)
    ds_read_b128 v[116:119], v5 offset:25600
    v_accvgpr_write_b32 a170, v60
    v_fma_f32 v63, v63, s31, v13
    v_mfma_f32_16x16x32_bf16 v[128:131], v[240:243], a[84:87], v[128:131]
    s_waitcnt lgkmcnt(5)
    v_exp_f32 v63, v63
    v_mfma_f32_16x16x32_bf16 v[136:139], v[240:243], a[116:119], v[136:139]
    s_add_u32 m0, s30, 69216
    ds_read_b128 v[124:127], v5 offset:25664
    v_fma_f32 v64, v64, s31, v12
    v_mfma_f32_16x16x32_bf16 v[136:139], v[232:235], a[112:115], v[136:139]
    s_waitcnt lgkmcnt(5)
    buffer_load_dwordx4 v1, s[12:15], s36 offen offset:1536 nt lds
    ds_read_b128 v[80:83], v5 offset:34048
    v_mfma_f32_16x16x32_bf16 v[144:147], v[104:107], a[80:83], v[144:147]
    s_waitcnt lgkmcnt(5)
    ds_read_b128 v[84:87], v5 offset:34112
    v_cvt_pk_bf16_f32 v62, v62, v63
    v_exp_f32 v64, v64
    v_mfma_f32_16x16x32_bf16 v[144:147], v[112:115], a[84:87], v[144:147]
    ds_read_b128 v[88:91], v5 offset:42496
    v_fma_f32 v65, v65, s31, v12
    v_mfma_f32_16x16x32_bf16 v[152:155], v[112:115], a[116:119], v[152:155]
    ds_read_b128 v[92:95], v5 offset:42560
    v_accvgpr_write_b32 a171, v62
    v_mfma_f32_16x16x32_bf16 v[152:155], v[104:107], a[112:115], v[152:155]
    s_waitcnt lgkmcnt(7)
    v_exp_f32 v65, v65
    v_mfma_f32_16x16x32_bf16 v[132:135], v[120:123], a[80:83], v[132:135]
    s_waitcnt lgkmcnt(6)
    ds_read_b128 v[224:227], v5 offset:50944
    v_fma_f32 v66, v66, s31, v12
    v_mfma_f32_16x16x32_bf16 v[132:135], v[108:111], a[84:87], v[132:135]
    s_add_u32 m0, s30, 84480
    ds_read_b128 v[232:235], v5 offset:51008
    v_cvt_pk_bf16_f32 v64, v64, v65
    v_exp_f32 v66, v66
    v_mfma_f32_16x16x32_bf16 v[140:143], v[108:111], a[116:119], v[140:143]
    v_fma_f32 v67, v67, s31, v12
    v_accvgpr_write_b32 a164, v64
    v_exp_f32 v67, v67
    v_mfma_f32_16x16x32_bf16 v[140:143], v[120:123], a[112:115], v[140:143]
    s_waitcnt lgkmcnt(7)
    buffer_load_dwordx4 v1, s[12:15], s37 offen offset:0 nt lds
    v_mfma_f32_16x16x32_bf16 v[148:151], v[116:119], a[80:83], v[148:151]
    s_waitcnt lgkmcnt(6)
    ds_read_b128 v[240:243], v5 offset:59392
    v_fma_f32 v68, v68, s31, v13
    v_mfma_f32_16x16x32_bf16 v[148:151], v[124:127], a[84:87], v[148:151]
    ds_read_b128 v[104:107], v5 offset:59456
    v_cvt_pk_bf16_f32 v66, v66, v67
    v_mfma_f32_16x16x32_bf16 v[156:159], v[124:127], a[116:119], v[156:159]
    v_exp_f32 v68, v68
    v_fma_f32 v69, v69, s31, v13
    v_mfma_f32_16x16x32_bf16 v[156:159], v[116:119], a[112:115], v[156:159]
    s_waitcnt lgkmcnt(7)
    ds_read_b128 v[112:115], v5 offset:384
    v_accvgpr_write_b32 a165, v66
    v_mfma_f32_16x16x32_bf16 v[160:163], v[80:83], a[80:83], v[160:163]
    s_waitcnt lgkmcnt(7)
    v_exp_f32 v69, v69
    v_mfma_f32_16x16x32_bf16 v[160:163], v[84:87], a[84:87], v[160:163]
    s_add_u32 m0, s30, 85024
    s_waitcnt vmcnt(5)
    ds_read_b128 a[88:91], v3 offset:50688
    v_fma_f32 v70, v70, s31, v13
    v_mfma_f32_16x16x32_bf16 v[168:171], v[84:87], a[116:119], v[168:171]
    ds_read_b128 a[120:123], v3 offset:51200
    v_cvt_pk_bf16_f32 v68, v68, v69
    v_exp_f32 v70, v70
    v_mfma_f32_16x16x32_bf16 v[168:171], v[80:83], a[112:115], v[168:171]
    s_waitcnt lgkmcnt(8)
    buffer_load_dwordx4 v1, s[12:15], s37 offen offset:512 nt lds
    v_fma_f32 v71, v71, s31, v13
    v_mfma_f32_16x16x32_bf16 v[176:179], v[88:91], a[80:83], v[176:179]
    s_waitcnt lgkmcnt(7)
    ds_read_b128 v[120:123], v5 offset:448
    v_accvgpr_write_b32 a172, v68
    v_exp_f32 v71, v71
    v_mfma_f32_16x16x32_bf16 v[176:179], v[92:95], a[84:87], v[176:179]
    ds_read_b128 a[92:95], v3 offset:50752
    v_fma_f32 v72, v72, s31, v12
    v_mfma_f32_16x16x32_bf16 v[184:187], v[92:95], a[116:119], v[184:187]
    ds_read_b128 a[124:127], v3 offset:51264
    v_cvt_pk_bf16_f32 v70, v70, v71
    v_mfma_f32_16x16x32_bf16 v[184:187], v[88:91], a[112:115], v[184:187]
    s_waitcnt lgkmcnt(9)
    v_exp_f32 v72, v72
    v_mfma_f32_16x16x32_bf16 v[164:167], v[224:227], a[80:83], v[164:167]
    s_waitcnt lgkmcnt(8)
    ds_read_b128 v[108:111], v5 offset:8832
    v_fma_f32 v73, v73, s31, v12
    v_accvgpr_write_b32 a173, v70
    v_mfma_f32_16x16x32_bf16 v[164:167], v[232:235], a[84:87], v[164:167]
    s_add_u32 m0, s30, 85568
    v_exp_f32 v73, v73
    v_mfma_f32_16x16x32_bf16 v[172:175], v[232:235], a[116:119], v[172:175]
    ds_read_b128 v[116:119], v5 offset:8896
    v_fma_f32 v74, v74, s31, v12
    v_mfma_f32_16x16x32_bf16 v[172:175], v[224:227], a[112:115], v[172:175]
    s_waitcnt lgkmcnt(9)
    buffer_load_dwordx4 v1, s[12:15], s37 offen offset:1024 nt lds
    ds_read_b128 v[124:127], v5 offset:17280
    v_mfma_f32_16x16x32_bf16 v[180:183], v[240:243], a[80:83], v[180:183]
    s_waitcnt lgkmcnt(9)
    ds_read_b128 v[80:83], v5 offset:17344
    v_cvt_pk_bf16_f32 v72, v72, v73
    v_exp_f32 v74, v74
    v_mfma_f32_16x16x32_bf16 v[180:183], v[104:107], a[84:87], v[180:183]
    ds_read_b128 v[84:87], v5 offset:25728
    v_fma_f32 v75, v75, s31, v12
    v_mfma_f32_16x16x32_bf16 v[188:191], v[104:107], a[116:119], v[188:191]
    ds_read_b128 v[88:91], v5 offset:25792
    v_accvgpr_write_b32 a166, v72
    v_mfma_f32_16x16x32_bf16 v[188:191], v[240:243], a[112:115], v[188:191]
    s_waitcnt lgkmcnt(10)
    v_exp_f32 v75, v75
    v_mfma_f32_16x16x32_bf16 v[128:131], v[112:115], a[88:91], v[128:131]
    s_waitcnt lgkmcnt(7)
    ds_read_b128 v[92:95], v5 offset:34176
    v_fma_f32 v76, v76, s31, v13
    v_mfma_f32_16x16x32_bf16 v[128:131], v[120:123], a[92:95], v[128:131]
    s_waitcnt lgkmcnt(7)
    ds_read_b128 v[224:227], v5 offset:34240
    v_cvt_pk_bf16_f32 v74, v74, v75
    v_exp_f32 v76, v76
    v_fma_f32 v77, v77, s31, v13
    v_mfma_f32_16x16x32_bf16 v[136:139], v[120:123], a[124:127], v[136:139]
    s_add_u32 m0, s30, 86112
    v_accvgpr_write_b32 a167, v74
    v_fma_f32 v78, v78, s31, v13
    v_exp_f32 v77, v77
    v_mfma_f32_16x16x32_bf16 v[136:139], v[112:115], a[120:123], v[136:139]
    s_waitcnt lgkmcnt(7)
    buffer_load_dwordx4 v1, s[12:15], s37 offen offset:1536 nt lds
    v_mfma_f32_16x16x32_bf16 v[144:147], v[108:111], a[88:91], v[144:147]
    s_waitcnt lgkmcnt(6)
    ds_read_b128 v[232:235], v5 offset:42624
    v_cvt_pk_bf16_f32 v76, v76, v77
    v_mfma_f32_16x16x32_bf16 v[144:147], v[116:119], a[92:95], v[144:147]
    v_exp_f32 v78, v78
    v_mfma_f32_16x16x32_bf16 v[152:155], v[116:119], a[124:127], v[152:155]
    ds_read_b128 v[240:243], v5 offset:42688
    v_fma_f32 v79, v79, s31, v13
    v_mfma_f32_16x16x32_bf16 v[152:155], v[108:111], a[120:123], v[152:155]
    s_waitcnt lgkmcnt(7)
    v_accvgpr_write_b32 a174, v76
    v_max3_f32 v102, v128, v129, v130
    v_mfma_f32_16x16x32_bf16 v[132:135], v[124:127], a[88:91], v[132:135]
    s_waitcnt lgkmcnt(6)
    v_exp_f32 v79, v79
    v_mfma_f32_16x16x32_bf16 v[132:135], v[80:83], a[92:95], v[132:135]
    s_add_u32 m0, s30, 101376
    ds_read_b128 v[104:107], v5 offset:51072
    v_max_f32 v102, v102, v131
    v_cvt_pk_bf16_f32 v78, v78, v79
    v_mfma_f32_16x16x32_bf16 v[140:143], v[80:83], a[124:127], v[140:143]
    v_mov_b32 v103, v102
    v_accvgpr_write_b32 a175, v78
    v_mfma_f32_16x16x32_bf16 v[140:143], v[124:127], a[120:123], v[140:143]
    s_waitcnt lgkmcnt(6)
    v_permlane16_swap_b32 v102, v103
    v_max_f32 v102, v102, v103
    v_mov_b32 v103, v102
    v_mfma_f32_16x16x32_bf16 v[148:151], v[84:87], a[88:91], v[148:151]
    s_waitcnt lgkmcnt(5)
    v_permlane32_swap_b32 v102, v103
    v_max_f32 v102, v102, v103
    v_mul_f32 v102, s60, v102
    v_min_f32 v14, v14, v102
    v_fma_f32 v128, v128, s31, v14
    v_exp_f32 v128, v128
    v_mfma_f32_16x16x32_bf16 v[148:151], v[88:91], a[92:95], v[148:151]
    buffer_load_dwordx4 v1, s[12:15], s38 offen offset:0 nt lds
    v_fma_f32 v129, v129, s31, v14
    v_mfma_f32_16x16x32_bf16 v[156:159], v[88:91], a[124:127], v[156:159]
    v_exp_f32 v129, v129
    v_fma_f32 v130, v130, s31, v14
    v_exp_f32 v130, v130
    v_mfma_f32_16x16x32_bf16 v[156:159], v[84:87], a[120:123], v[156:159]
    s_waitcnt lgkmcnt(4)
    ds_read_b128 v[112:115], v5 offset:51136
    v_fma_f32 v131, v131, s31, v14
    v_cvt_pk_bf16_f32 v128, v128, v129
    v_mfma_f32_16x16x32_bf16 v[160:163], v[92:95], a[88:91], v[160:163]
    s_waitcnt lgkmcnt(4)
    v_exp_f32 v131, v131
    v_max3_f32 v102, v136, v137, v138
    v_accvgpr_write_b32 a144, v128
    v_max_f32 v102, v102, v139
    v_mfma_f32_16x16x32_bf16 v[160:163], v[224:227], a[92:95], v[160:163]
    s_add_u32 m0, s30, 101920
    ds_read_b128 v[120:123], v5 offset:59520
    v_mov_b32 v103, v102
    v_cvt_pk_bf16_f32 v130, v130, v131
    v_mfma_f32_16x16x32_bf16 v[168:171], v[224:227], a[124:127], v[168:171]
    s_waitcnt vmcnt(5)
    s_barrier
    ds_read_b128 v[108:111], v5 offset:59584
    ds_read_b128 a[224:227], v6 offset:0
    ds_read_b128 a[228:231], v6 offset:64
    v_permlane16_swap_b32 v102, v103
    v_max_f32 v102, v102, v103
    v_mov_b32 v103, v102
    v_accvgpr_write_b32 a145, v130
    v_mfma_f32_16x16x32_bf16 v[168:171], v[92:95], a[120:123], v[168:171]
    v_permlane32_swap_b32 v102, v103
    v_max_f32 v102, v102, v103
    v_mul_f32 v102, s60, v102
    v_min_f32 v15, v15, v102
    v_smfmac_f32_16x16x64_bf16 a[208:211], a[252:255], a[160:167], v10
    s_waitcnt lgkmcnt(7)
    ds_read_b128 a[232:235], v6 offset:128
    buffer_load_dwordx4 v1, s[12:15], s38 offen offset:512 nt lds
    v_fma_f32 v136, v136, s31, v15
    v_exp_f32 v136, v136
    v_mfma_f32_16x16x32_bf16 v[176:179], v[232:235], a[88:91], v[176:179]
    s_waitcnt lgkmcnt(7)
    ds_read_b128 a[236:239], v6 offset:192
    v_fma_f32 v137, v137, s31, v15
    v_mfma_f32_16x16x32_bf16 v[176:179], v[240:243], a[92:95], v[176:179]
    v_exp_f32 v137, v137
    v_fma_f32 v138, v138, s31, v15
    v_mfma_f32_16x16x32_bf16 v[184:187], v[240:243], a[124:127], v[184:187]
    v_exp_f32 v138, v138
    v_fma_f32 v139, v139, s31, v15
    v_mfma_f32_16x16x32_bf16 v[184:187], v[232:235], a[120:123], v[184:187]
    v_cvt_pk_bf16_f32 v136, v136, v137
    v_fma_f32 v144, v144, s31, v14
    v_exp_f32 v139, v139
    v_smfmac_f32_16x16x64_bf16 a[212:215], a[252:255], a[168:175], v10
    s_waitcnt lgkmcnt(7)
    ds_read_b128 a[240:243], v6 offset:256
    v_accvgpr_write_b32 a152, v136
    v_exp_f32 v144, v144
    v_fma_f32 v145, v145, s31, v14
    v_mfma_f32_16x16x32_bf16 v[164:167], v[104:107], a[88:91], v[164:167]
    s_waitcnt lgkmcnt(7)
    v_cvt_pk_bf16_f32 v138, v138, v139
    v_fma_f32 v146, v146, s31, v14
    v_exp_f32 v145, v145
    v_accvgpr_write_b32 a153, v138
    v_exp_f32 v146, v146
    v_mfma_f32_16x16x32_bf16 v[164:167], v[112:115], a[92:95], v[164:167]
    s_add_u32 m0, s30, 102464
    v_fma_f32 v147, v147, s31, v14
    v_cvt_pk_bf16_f32 v144, v144, v145
    v_exp_f32 v147, v147
    v_mfma_f32_16x16x32_bf16 v[172:175], v[112:115], a[124:127], v[172:175]
    buffer_load_dwordx4 v1, s[12:15], s38 offen offset:1024 nt lds
    v_fma_f32 v152, v152, s31, v15
    v_mfma_f32_16x16x32_bf16 v[172:175], v[104:107], a[120:123], v[172:175]
    s_waitcnt lgkmcnt(6)
    ds_read_b128 a[244:247], v6 offset:320
    v_accvgpr_write_b32 a146, v144
    v_exp_f32 v152, v152
    v_fma_f32 v153, v153, s31, v15
    v_mfma_f32_16x16x32_bf16 v[180:183], v[120:123], a[88:91], v[180:183]
    s_waitcnt lgkmcnt(6)
    v_cvt_pk_bf16_f32 v146, v146, v147
    v_fma_f32 v154, v154, s31, v15
    v_mfma_f32_16x16x32_bf16 v[180:183], v[108:111], a[92:95], v[180:183]
    v_exp_f32 v153, v153
    v_accvgpr_write_b32 a147, v146
    v_exp_f32 v154, v154
    v_fma_f32 v155, v155, s31, v15
    v_mfma_f32_16x16x32_bf16 v[188:191], v[108:111], a[124:127], v[188:191]
    v_cvt_pk_bf16_f32 v152, v152, v153
    v_fma_f32 v132, v132, s31, v14
    v_mfma_f32_16x16x32_bf16 v[188:191], v[120:123], a[120:123], v[188:191]
    s_waitcnt lgkmcnt(4)
    v_exp_f32 v155, v155
    v_accvgpr_write_b32 a154, v152
    v_mfma_f32_16x16x32_bf16 v[56:59], a[224:227], a[0:3], v[252:255]
    s_add_u32 m0, s30, 103008
    v_exp_f32 v132, v132
    v_cvt_pk_bf16_f32 v154, v154, v155
    v_fma_f32 v133, v133, s31, v14
    v_exp_f32 v133, v133
    v_mfma_f32_16x16x32_bf16 v[56:59], a[228:231], a[4:7], v[56:59]
    s_waitcnt lgkmcnt(2)
    buffer_load_dwordx4 v1, s[12:15], s38 offen offset:1536 nt lds
    v_mfma_f32_16x16x32_bf16 v[56:59], a[232:235], a[8:11], v[56:59]
    ds_read_b128 a[248:251], v6 offset:384
    v_accvgpr_write_b32 a155, v154
    v_fma_f32 v134, v134, s31, v14
    v_exp_f32 v134, v134
    v_mfma_f32_16x16x32_bf16 v[56:59], a[236:239], a[12:15], v[56:59]
    ds_read_b128 v[228:231], v6 offset:448
    v_cvt_pk_bf16_f32 v132, v132, v133
    v_fma_f32 v135, v135, s31, v14
    v_mfma_f32_16x16x32_bf16 v[60:63], a[236:239], a[44:47], v[252:255]
    v_exp_f32 v135, v135
    v_accvgpr_write_b32 a148, v132
    v_mfma_f32_16x16x32_bf16 v[60:63], a[232:235], a[40:43], v[60:63]
    v_fma_f32 v140, v140, s31, v15
    v_cvt_pk_bf16_f32 v134, v134, v135
    v_exp_f32 v140, v140
    v_mfma_f32_16x16x32_bf16 v[60:63], a[228:231], a[36:39], v[60:63]
    v_fma_f32 v141, v141, s31, v15
    v_accvgpr_write_b32 a149, v134
    v_mfma_f32_16x16x32_bf16 v[60:63], a[224:227], a[32:35], v[60:63]
    s_add_u32 m0, s30, 118272
    v_exp_f32 v141, v141
    v_mfma_f32_16x16x32_bf16 v[64:67], a[224:227], a[64:67], v[252:255]
    ds_read_b128 v[236:239], v6 offset:8448
    v_fma_f32 v142, v142, s31, v15
    v_exp_f32 v142, v142
    v_cvt_pk_bf16_f32 v140, v140, v141
    v_fma_f32 v143, v143, s31, v15
    v_exp_f32 v143, v143
    v_mfma_f32_16x16x32_bf16 v[64:67], a[228:231], a[68:71], v[64:67]
    buffer_load_dwordx4 v1, s[12:15], s39 offen offset:0 nt lds
    v_mfma_f32_16x16x32_bf16 v[64:67], a[232:235], a[72:75], v[64:67]
    v_accvgpr_write_b32 a156, v140
    v_fma_f32 v148, v148, s31, v14
    v_mfma_f32_16x16x32_bf16 v[64:67], a[236:239], a[76:79], v[64:67]
    v_exp_f32 v148, v148
    v_cvt_pk_bf16_f32 v142, v142, v143
    v_mfma_f32_16x16x32_bf16 v[68:71], a[236:239], a[108:111], v[252:255]
    ds_read_b128 v[244:247], v6 offset:8512
    v_fma_f32 v149, v149, s31, v14
    v_exp_f32 v149, v149
    v_mfma_f32_16x16x32_bf16 v[68:71], a[232:235], a[104:107], v[68:71]
    v_accvgpr_write_b32 a157, v142
    v_fma_f32 v150, v150, s31, v14
    v_exp_f32 v150, v150
    v_mfma_f32_16x16x32_bf16 v[68:71], a[228:231], a[100:103], v[68:71]
    v_cvt_pk_bf16_f32 v148, v148, v149
    v_fma_f32 v151, v151, s31, v14
    v_mfma_f32_16x16x32_bf16 v[68:71], a[224:227], a[96:99], v[68:71]
    s_waitcnt lgkmcnt(4)
    v_exp_f32 v151, v151
    v_accvgpr_write_b32 a150, v148
    v_mfma_f32_16x16x32_bf16 v[56:59], a[240:243], a[16:19], v[56:59]
    s_add_u32 m0, s30, 118816
    ds_read_b128 v[32:35], v6 offset:8576
    v_fma_f32 v156, v156, s31, v15
    v_exp_f32 v156, v156
    v_cvt_pk_bf16_f32 v150, v150, v151
    v_mfma_f32_16x16x32_bf16 v[56:59], a[244:247], a[20:23], v[56:59]
    s_waitcnt lgkmcnt(3)
    v_fma_f32 v157, v157, s31, v15
    v_accvgpr_write_b32 a151, v150
    v_exp_f32 v157, v157
    v_mfma_f32_16x16x32_bf16 v[56:59], a[248:251], a[24:27], v[56:59]
    buffer_load_dwordx4 v1, s[12:15], s39 offen offset:512 nt lds
    v_mfma_f32_16x16x32_bf16 v[56:59], v[228:231], a[28:31], v[56:59]
    ds_read_b128 v[36:39], v6 offset:8640
    v_fma_f32 v158, v158, s31, v15
    v_exp_f32 v158, v158
    v_cvt_pk_bf16_f32 v156, v156, v157
    v_mfma_f32_16x16x32_bf16 v[60:63], v[228:231], a[60:63], v[60:63]
    v_fma_f32 v159, v159, s31, v15
    v_accvgpr_write_b32 a158, v156
    v_mfma_f32_16x16x32_bf16 v[60:63], a[248:251], a[56:59], v[60:63]
    v_exp_f32 v159, v159
    v_fma_f32 v160, v160, s31, v14
    v_mfma_f32_16x16x32_bf16 v[60:63], a[244:247], a[52:55], v[60:63]
    v_exp_f32 v160, v160
    v_cvt_pk_bf16_f32 v158, v158, v159
    v_mfma_f32_16x16x32_bf16 v[60:63], a[240:243], a[48:51], v[60:63]
    ds_read_b128 a[192:195], v6 offset:8704
    v_fma_f32 v161, v161, s31, v14
    v_exp_f32 v161, v161
    v_mfma_f32_16x16x32_bf16 v[64:67], a[240:243], a[80:83], v[64:67]
    v_accvgpr_write_b32 a159, v158
    v_fma_f32 v162, v162, s31, v14
    v_exp_f32 v162, v162
    v_mfma_f32_16x16x32_bf16 v[64:67], a[244:247], a[84:87], v[64:67]
    s_add_u32 m0, s30, 119360
    v_cvt_pk_bf16_f32 v160, v160, v161
    v_fma_f32 v163, v163, s31, v14
    v_mfma_f32_16x16x32_bf16 v[64:67], a[248:251], a[88:91], v[64:67]
    v_exp_f32 v163, v163
    v_accvgpr_write_b32 a176, v160
    v_fma_f32 v168, v168, s31, v15
    v_exp_f32 v168, v168
    v_mfma_f32_16x16x32_bf16 v[64:67], v[228:231], a[92:95], v[64:67]
    buffer_load_dwordx4 v1, s[12:15], s39 offen offset:1024 nt lds
    v_cvt_pk_bf16_f32 v162, v162, v163
    v_mfma_f32_16x16x32_bf16 v[68:71], v[228:231], a[124:127], v[68:71]
    ds_read_b128 a[196:199], v6 offset:8768
    v_fma_f32 v169, v169, s31, v15
    v_mfma_f32_16x16x32_bf16 v[68:71], a[248:251], a[120:123], v[68:71]
    s_waitcnt vmcnt(7)
    s_barrier
    v_accvgpr_write_b32 a177, v162
    v_exp_f32 v169, v169
    v_mfma_f32_16x16x32_bf16 v[68:71], a[244:247], a[116:119], v[68:71]
    v_fma_f32 v170, v170, s31, v15
    v_cvt_pk_bf16_f32 v168, v168, v169
    v_exp_f32 v170, v170
    v_fma_f32 v171, v171, s31, v15
    v_mfma_f32_16x16x32_bf16 v[68:71], a[240:243], a[112:115], v[68:71]
    s_waitcnt lgkmcnt(4)
    v_exp_f32 v171, v171
    v_mfma_f32_16x16x32_bf16 v[72:75], v[236:239], a[0:3], v[252:255]
    ds_read_b128 a[200:203], v6 offset:8832
    v_accvgpr_write_b32 a184, v168
    v_fma_f32 v176, v176, s31, v14
    v_exp_f32 v176, v176
    v_mfma_f32_16x16x32_bf16 v[72:75], v[244:247], a[4:7], v[72:75]
    s_waitcnt lgkmcnt(3)
    v_cvt_pk_bf16_f32 v170, v170, v171
    v_fma_f32 v177, v177, s31, v14
    v_mfma_f32_16x16x32_bf16 v[72:75], v[32:35], a[8:11], v[72:75]
    s_add_u32 m0, s30, 119904
    v_exp_f32 v177, v177
    v_accvgpr_write_b32 a185, v170
    v_mfma_f32_16x16x32_bf16 v[72:75], v[36:39], a[12:15], v[72:75]
    ds_read_b128 a[204:207], v6 offset:8896
    ds_read_b128 a[224:227], v6 offset:16896
    v_fma_f32 v178, v178, s31, v14
    v_exp_f32 v178, v178
    v_cvt_pk_bf16_f32 v176, v176, v177
    v_fma_f32 v179, v179, s31, v14
    v_mfma_f32_16x16x32_bf16 v[76:79], v[36:39], a[44:47], v[252:255]
    ds_read_b128 a[228:231], v6 offset:16960
    v_accvgpr_write_b32 a178, v176
    v_exp_f32 v179, v179
    v_mfma_f32_16x16x32_bf16 v[76:79], v[32:35], a[40:43], v[76:79]
    buffer_load_dwordx4 v1, s[12:15], s39 offen offset:1536 nt lds
    v_mfma_f32_16x16x32_bf16 v[76:79], v[244:247], a[36:39], v[76:79]
    ds_read_b128 a[232:235], v6 offset:17024
    v_fma_f32 v184, v184, s31, v15
    v_exp_f32 v184, v184
    v_cvt_pk_bf16_f32 v178, v178, v179
    v_mfma_f32_16x16x32_bf16 v[76:79], v[236:239], a[32:35], v[76:79]
    ds_read_b128 a[236:239], v6 offset:17088
    v_fma_f32 v185, v185, s31, v15
    v_mfma_f32_16x16x32_bf16 v[40:43], v[236:239], a[64:67], v[252:255]
    v_exp_f32 v185, v185
    v_accvgpr_write_b32 a179, v178
    v_mfma_f32_16x16x32_bf16 v[40:43], v[244:247], a[68:71], v[40:43]
    v_fma_f32 v186, v186, s31, v15
    v_cvt_pk_bf16_f32 v184, v184, v185
    v_exp_f32 v186, v186
    v_mfma_f32_16x16x32_bf16 v[40:43], v[32:35], a[72:75], v[40:43]
    v_fma_f32 v187, v187, s31, v15
    v_accvgpr_write_b32 a186, v184
    v_mfma_f32_16x16x32_bf16 v[40:43], v[36:39], a[76:79], v[40:43]
    s_add_u32 m0, s30, 135168
    v_exp_f32 v187, v187
    v_fma_f32 v164, v164, s31, v14
    v_mfma_f32_16x16x32_bf16 v[44:47], v[36:39], a[108:111], v[252:255]
    v_exp_f32 v164, v164
    v_cvt_pk_bf16_f32 v186, v186, v187
    v_fma_f32 v165, v165, s31, v14
    v_exp_f32 v165, v165
    v_mfma_f32_16x16x32_bf16 v[44:47], v[32:35], a[104:107], v[44:47]
    buffer_load_dwordx4 v1, s[12:15], s40 offen offset:0 nt lds
    v_mfma_f32_16x16x32_bf16 v[44:47], v[244:247], a[100:103], v[44:47]
    ds_read_b128 a[240:243], v6 offset:17152
    v_accvgpr_write_b32 a187, v186
    v_fma_f32 v166, v166, s31, v14
    v_exp_f32 v166, v166
    v_mfma_f32_16x16x32_bf16 v[44:47], v[236:239], a[96:99], v[44:47]
    s_waitcnt lgkmcnt(7)
    ds_read_b128 a[244:247], v6 offset:17216
    v_cvt_pk_bf16_f32 v164, v164, v165
    v_fma_f32 v167, v167, s31, v14
    v_mfma_f32_16x16x32_bf16 v[72:75], a[192:195], a[16:19], v[72:75]
L_pg2:
    s_cbranch_execz L_pg6
    v_exp_f32 v167, v167
    v_accvgpr_write_b32 a180, v164
    v_mfma_f32_16x16x32_bf16 v[72:75], a[196:199], a[20:23], v[72:75]
    s_waitcnt lgkmcnt(6)
    v_fma_f32 v172, v172, s31, v15
    v_cvt_pk_bf16_f32 v166, v166, v167
    v_exp_f32 v172, v172
    v_mfma_f32_16x16x32_bf16 v[72:75], a[200:203], a[24:27], v[72:75]
    v_fma_f32 v173, v173, s31, v15
    v_accvgpr_write_b32 a181, v166
    v_mfma_f32_16x16x32_bf16 v[72:75], a[204:207], a[28:31], v[72:75]
    v_exp_f32 v173, v173
    v_mfma_f32_16x16x32_bf16 v[76:79], a[204:207], a[60:63], v[76:79]
    ds_read_b128 a[248:251], v6 offset:17280
    v_fma_f32 v174, v174, s31, v15
    v_exp_f32 v174, v174
    v_cvt_pk_bf16_f32 v172, v172, v173
    v_mfma_f32_16x16x32_bf16 v[76:79], a[200:203], a[56:59], v[76:79]
    s_add_u32 m0, s30, 135712
    v_fma_f32 v175, v175, s31, v15
    v_accvgpr_write_b32 a188, v172
    v_mfma_f32_16x16x32_bf16 v[76:79], a[196:199], a[52:55], v[76:79]
    v_exp_f32 v175, v175
    v_fma_f32 v180, v180, s31, v14
    v_exp_f32 v180, v180
    v_mfma_f32_16x16x32_bf16 v[76:79], a[192:195], a[48:51], v[76:79]
    ds_read_b128 v[228:231], v6 offset:17344
    v_cvt_pk_bf16_f32 v174, v174, v175
    v_fma_f32 v181, v181, s31, v14
    v_exp_f32 v181, v181
    v_mfma_f32_16x16x32_bf16 v[40:43], a[192:195], a[80:83], v[40:43]
    buffer_load_dwordx4 v1, s[12:15], s40 offen offset:512 nt lds
    v_mfma_f32_16x16x32_bf16 v[40:43], a[196:199], a[84:87], v[40:43]
    v_accvgpr_write_b32 a189, v174
    v_fma_f32 v182, v182, s31, v14
    v_exp_f32 v182, v182
    v_mfma_f32_16x16x32_bf16 v[40:43], a[200:203], a[88:91], v[40:43]
    v_cvt_pk_bf16_f32 v180, v180, v181
    v_fma_f32 v183, v183, s31, v14
    v_mfma_f32_16x16x32_bf16 v[40:43], a[204:207], a[92:95], v[40:43]
    v_exp_f32 v183, v183
    v_accvgpr_write_b32 a182, v180
    v_mfma_f32_16x16x32_bf16 v[44:47], a[204:207], a[124:127], v[44:47]
    v_fma_f32 v188, v188, s31, v15
    v_cvt_pk_bf16_f32 v182, v182, v183
    v_exp_f32 v188, v188
    v_mfma_f32_16x16x32_bf16 v[44:47], a[200:203], a[120:123], v[44:47]
    ds_read_b128 v[236:239], v6 offset:25344
    v_fma_f32 v189, v189, s31, v15
    v_mfma_f32_16x16x32_bf16 v[44:47], a[196:199], a[116:119], v[44:47]
    v_exp_f32 v189, v189
    v_accvgpr_write_b32 a183, v182
    v_mfma_f32_16x16x32_bf16 v[44:47], a[192:195], a[112:115], v[44:47]
    s_waitcnt lgkmcnt(5)
    v_fma_f32 v190, v190, s31, v15
    v_cvt_pk_bf16_f32 v188, v188, v189
    v_exp_f32 v190, v190
    v_mfma_f32_16x16x32_bf16 v[48:51], a[224:227], a[0:3], v[252:255]
    s_add_u32 m0, s30, 136256
    v_fma_f32 v191, v191, s31, v15
    v_accvgpr_write_b32 a190, v188
    v_exp_f32 v191, v191
    v_mfma_f32_16x16x32_bf16 v[48:51], a[228:231], a[4:7], v[48:51]
    buffer_load_dwordx4 v1, s[12:15], s40 offen offset:1024 nt lds
    v_fma_f32 v56, v56, s31, v12
    v_mfma_f32_16x16x32_bf16 v[48:51], a[232:235], a[8:11], v[48:51]
    v_exp_f32 v56, v56
    v_mfma_f32_16x16x32_bf16 v[48:51], a[236:239], a[12:15], v[48:51]
    s_waitcnt lgkmcnt(1)
    ds_read_b128 v[244:247], v6 offset:25408
    v_cvt_pk_bf16_f32 v190, v190, v191
    v_fma_f32 v57, v57, s31, v12
    v_mfma_f32_16x16x32_bf16 v[48:51], a[240:243], a[16:19], v[48:51]
    v_accvgpr_write_b32 a191, v190
    v_fma_f32 v58, v58, s31, v12
    v_mfma_f32_16x16x32_bf16 v[48:51], a[244:247], a[20:23], v[48:51]
    v_exp_f32 v57, v57
    v_mfma_f32_16x16x32_bf16 v[48:51], a[248:251], a[24:27], v[48:51]
    v_exp_f32 v58, v58
    v_mfma_f32_16x16x32_bf16 v[48:51], v[228:231], a[28:31], v[48:51]
    ds_read_b128 v[32:35], v6 offset:25472
    v_cvt_pk_bf16_f32 v80, v56, v57
    v_mfma_f32_16x16x32_bf16 v[52:55], v[228:231], a[60:63], v[252:255]
    v_fma_f32 v59, v59, s31, v12
    v_fma_f32 v60, v60, s31, v13
    v_mfma_f32_16x16x32_bf16 v[52:55], a[248:251], a[56:59], v[52:55]
    s_add_u32 m0, s30, 136800
    v_exp_f32 v59, v59
    v_mfma_f32_16x16x32_bf16 v[52:55], a[244:247], a[52:55], v[52:55]
    v_exp_f32 v60, v60
    v_mfma_f32_16x16x32_bf16 v[52:55], a[240:243], a[48:51], v[52:55]
    ds_read_b128 v[36:39], v6 offset:25536
    v_cvt_pk_bf16_f32 v81, v58, v59
    v_fma_f32 v61, v61, s31, v13
    v_exp_f32 v61, v61
    v_mfma_f32_16x16x32_bf16 v[52:55], a[236:239], a[44:47], v[52:55]
    buffer_load_dwordx4 v1, s[12:15], s40 offen offset:1536 nt lds
    v_mfma_f32_16x16x32_bf16 v[52:55], a[232:235], a[40:43], v[52:55]
    ds_read_b128 a[192:195], v6 offset:25600
    v_fma_f32 v62, v62, s31, v13
    v_mfma_f32_16x16x32_bf16 v[52:55], a[228:231], a[36:39], v[52:55]
    v_exp_f32 v62, v62
    v_mfma_f32_16x16x32_bf16 v[52:55], a[224:227], a[32:35], v[52:55]
    v_cvt_pk_bf16_f32 v88, v60, v61
    v_fma_f32 v63, v63, s31, v13
    v_smfmac_f32_16x16x64_bf16 a[216:219], a[252:255], a[144:151], v10
    v_fma_f32 v64, v64, s31, v14
    v_mfma_f32_16x16x32_bf16 v[56:59], a[224:227], a[64:67], v[252:255]
    s_add_u32 m0, s30, 0
    v_exp_f32 v63, v63
    v_mfma_f32_16x16x32_bf16 v[56:59], a[228:231], a[68:71], v[56:59]
    v_exp_f32 v64, v64
    v_mfma_f32_16x16x32_bf16 v[56:59], a[232:235], a[72:75], v[56:59]
    ds_read_b128 a[196:199], v6 offset:25664
    v_cvt_pk_bf16_f32 v89, v62, v63
    v_mfma_f32_16x16x32_bf16 v[56:59], a[236:239], a[76:79], v[56:59]
    buffer_load_dwordx4 v1, s[12:15], s41 offen offset:0 nt lds
    v_mfma_f32_16x16x32_bf16 v[56:59], a[240:243], a[80:83], v[56:59]
    ds_read_b128 a[200:203], v6 offset:25728
    v_fma_f32 v65, v65, s31, v14
    v_mfma_f32_16x16x32_bf16 v[56:59], a[244:247], a[84:87], v[56:59]
    v_exp_f32 v65, v65
    v_mfma_f32_16x16x32_bf16 v[56:59], a[248:251], a[88:91], v[56:59]
    v_fma_f32 v66, v66, s31, v14
    v_cvt_pk_bf16_f32 v16, v64, v65
    v_mfma_f32_16x16x32_bf16 v[56:59], v[228:231], a[92:95], v[56:59]
    v_exp_f32 v66, v66
    v_mfma_f32_16x16x32_bf16 v[60:63], v[228:231], a[124:127], v[252:255]
    ds_read_b128 a[204:207], v6 offset:25792
    v_fma_f32 v67, v67, s31, v14
    v_mfma_f32_16x16x32_bf16 v[60:63], a[248:251], a[120:123], v[60:63]
    s_add_u32 m0, s30, 544
    v_exp_f32 v67, v67
    v_mfma_f32_16x16x32_bf16 v[60:63], a[244:247], a[116:119], v[60:63]
    v_fma_f32 v68, v68, s31, v15
    v_cvt_pk_bf16_f32 v17, v66, v67
    v_exp_f32 v68, v68
    v_mfma_f32_16x16x32_bf16 v[60:63], a[240:243], a[112:115], v[60:63]
    buffer_load_dwordx4 v1, s[12:15], s41 offen offset:512 nt lds
    v_mfma_f32_16x16x32_bf16 v[60:63], a[236:239], a[108:111], v[60:63]
    v_fma_f32 v69, v69, s31, v15
    v_fma_f32 v70, v70, s31, v15
    v_mfma_f32_16x16x32_bf16 v[60:63], a[232:235], a[104:107], v[60:63]
    v_exp_f32 v69, v69
    v_mfma_f32_16x16x32_bf16 v[60:63], a[228:231], a[100:103], v[60:63]
    v_exp_f32 v70, v70
    v_mfma_f32_16x16x32_bf16 v[60:63], a[224:227], a[96:99], v[60:63]
    v_cvt_pk_bf16_f32 v24, v68, v69
    v_fma_f32 v71, v71, s31, v15
    v_smfmac_f32_16x16x64_bf16 a[220:223], a[252:255], a[152:159], v10
    s_waitcnt lgkmcnt(4)
    s_waitcnt vmcnt(6)
    s_barrier
    v_mfma_f32_16x16x32_bf16 v[64:67], v[236:239], a[0:3], v[252:255]
    v_exp_f32 v71, v71
    v_mfma_f32_16x16x32_bf16 v[64:67], v[244:247], a[4:7], v[64:67]
    s_add_u32 m0, s30, 1088
    ds_read_b128 a[224:227], v6 offset:33792
    v_fma_f32 v72, v72, s31, v12
    v_mfma_f32_16x16x32_bf16 v[64:67], v[32:35], a[8:11], v[64:67]
    v_exp_f32 v72, v72
    v_cvt_pk_bf16_f32 v25, v70, v71
    v_mfma_f32_16x16x32_bf16 v[64:67], v[36:39], a[12:15], v[64:67]
    s_waitcnt lgkmcnt(1)
    ds_read_b128 a[228:231], v6 offset:33856
    v_fma_f32 v73, v73, s31, v12
    v_exp_f32 v73, v73
    v_mfma_f32_16x16x32_bf16 v[64:67], a[192:195], a[16:19], v[64:67]
    buffer_load_dwordx4 v1, s[12:15], s41 offen offset:1024 nt lds
    v_mfma_f32_16x16x32_bf16 v[64:67], a[196:199], a[20:23], v[64:67]
    ds_read_b128 a[232:235], v6 offset:33920
    v_fma_f32 v74, v74, s31, v12
    v_mfma_f32_16x16x32_bf16 v[64:67], a[200:203], a[24:27], v[64:67]
    v_exp_f32 v74, v74
    v_mfma_f32_16x16x32_bf16 v[64:67], a[204:207], a[28:31], v[64:67]
    v_cvt_pk_bf16_f32 v82, v72, v73
    v_fma_f32 v75, v75, s31, v12
    v_mfma_f32_16x16x32_bf16 v[68:71], a[204:207], a[60:63], v[252:255]
    v_exp_f32 v75, v75
    v_mfma_f32_16x16x32_bf16 v[68:71], a[200:203], a[56:59], v[68:71]
    ds_read_b128 a[236:239], v6 offset:33984
    v_fma_f32 v76, v76, s31, v13
    v_mfma_f32_16x16x32_bf16 v[68:71], a[196:199], a[52:55], v[68:71]
    s_add_u32 m0, s30, 1632
    v_exp_f32 v76, v76
    v_mfma_f32_16x16x32_bf16 v[68:71], a[192:195], a[48:51], v[68:71]
    v_cvt_pk_bf16_f32 v83, v74, v75
    v_fma_f32 v77, v77, s31, v13
    v_exp_f32 v77, v77
    v_mfma_f32_16x16x32_bf16 v[68:71], v[36:39], a[44:47], v[68:71]
    buffer_load_dwordx4 v1, s[12:15], s41 offen offset:1536 nt lds
    v_mfma_f32_16x16x32_bf16 v[68:71], v[32:35], a[40:43], v[68:71]
    ds_read_b128 a[240:243], v6 offset:34048
    v_fma_f32 v78, v78, s31, v13
    v_mfma_f32_16x16x32_bf16 v[68:71], v[244:247], a[36:39], v[68:71]
    v_exp_f32 v78, v78
    v_mfma_f32_16x16x32_bf16 v[68:71], v[236:239], a[32:35], v[68:71]
    v_cvt_pk_bf16_f32 v90, v76, v77
    v_fma_f32 v79, v79, s31, v13
    v_smfmac_f32_16x16x64_bf16 a[216:219], a[252:255], a[176:183], v10
    v_fma_f32 v40, v40, s31, v14
    v_mfma_f32_16x16x32_bf16 v[72:75], v[236:239], a[64:67], v[252:255]
    v_exp_f32 v79, v79
    v_mfma_f32_16x16x32_bf16 v[72:75], v[244:247], a[68:71], v[72:75]
    v_exp_f32 v40, v40
    v_mfma_f32_16x16x32_bf16 v[72:75], v[32:35], a[72:75], v[72:75]
    s_add_u32 m0, s30, 16896
    ds_read_b128 a[244:247], v6 offset:34112
    v_cvt_pk_bf16_f32 v91, v78, v79
    v_mfma_f32_16x16x32_bf16 v[72:75], v[36:39], a[76:79], v[72:75]
    v_fma_f32 v41, v41, s31, v14
    v_fma_f32 v42, v42, s31, v14
    v_exp_f32 v41, v41
    v_mfma_f32_16x16x32_bf16 v[72:75], a[192:195], a[80:83], v[72:75]
    buffer_load_dwordx4 v1, s[12:15], s42 offen offset:0 nt lds
    v_mfma_f32_16x16x32_bf16 v[72:75], a[196:199], a[84:87], v[72:75]
    v_exp_f32 v42, v42
    v_mfma_f32_16x16x32_bf16 v[72:75], a[200:203], a[88:91], v[72:75]
    ds_read_b128 a[248:251], v6 offset:34176
    v_cvt_pk_bf16_f32 v18, v40, v41
    v_mfma_f32_16x16x32_bf16 v[72:75], a[204:207], a[92:95], v[72:75]
    v_fma_f32 v43, v43, s31, v14
    v_fma_f32 v44, v44, s31, v15
    v_mfma_f32_16x16x32_bf16 v[76:79], a[204:207], a[124:127], v[252:255]
    v_exp_f32 v43, v43
    v_mfma_f32_16x16x32_bf16 v[76:79], a[200:203], a[120:123], v[76:79]
    v_exp_f32 v44, v44
    v_mfma_f32_16x16x32_bf16 v[76:79], a[196:199], a[116:119], v[76:79]
    ds_read_b128 v[228:231], v6 offset:34240
    v_cvt_pk_bf16_f32 v19, v42, v43
    v_mfma_f32_16x16x32_bf16 v[76:79], a[192:195], a[112:115], v[76:79]
    s_add_u32 m0, s30, 17440
    v_fma_f32 v45, v45, s31, v15
    v_fma_f32 v46, v46, s31, v15
    v_mfma_f32_16x16x32_bf16 v[76:79], v[36:39], a[108:111], v[76:79]
    v_exp_f32 v45, v45
    v_mfma_f32_16x16x32_bf16 v[76:79], v[32:35], a[104:107], v[76:79]
    buffer_load_dwordx4 v1, s[12:15], s42 offen offset:512 nt lds
    v_mfma_f32_16x16x32_bf16 v[76:79], v[244:247], a[100:103], v[76:79]
    v_exp_f32 v46, v46
    v_mfma_f32_16x16x32_bf16 v[76:79], v[236:239], a[96:99], v[76:79]
    ds_read_b128 v[236:239], v6 offset:42240
    v_cvt_pk_bf16_f32 v26, v44, v45
    v_smfmac_f32_16x16x64_bf16 a[220:223], a[252:255], a[184:191], v10
    s_waitcnt lgkmcnt(5)
    ds_read_b128 v[244:247], v6 offset:42304
    v_mfma_f32_16x16x32_bf16 v[40:43], a[224:227], a[0:3], v[252:255]
    v_fma_f32 v47, v47, s31, v15
    v_fma_f32 v48, v48, s31, v12
    v_mfma_f32_16x16x32_bf16 v[40:43], a[228:231], a[4:7], v[40:43]
    v_exp_f32 v47, v47
    v_mfma_f32_16x16x32_bf16 v[40:43], a[232:235], a[8:11], v[40:43]
    v_exp_f32 v48, v48
    v_mfma_f32_16x16x32_bf16 v[40:43], a[236:239], a[12:15], v[40:43]
    s_waitcnt lgkmcnt(2)
    ds_read_b128 v[32:35], v6 offset:42368
    v_cvt_pk_bf16_f32 v27, v46, v47
    v_mfma_f32_16x16x32_bf16 v[40:43], a[240:243], a[16:19], v[40:43]
    s_add_u32 m0, s30, 17984
    v_fma_f32 v49, v49, s31, v12
    v_fma_f32 v50, v50, s31, v12
    v_exp_f32 v49, v49
    v_mfma_f32_16x16x32_bf16 v[40:43], a[244:247], a[20:23], v[40:43]
    buffer_load_dwordx4 v1, s[12:15], s42 offen offset:1024 nt lds
    v_mfma_f32_16x16x32_bf16 v[40:43], a[248:251], a[24:27], v[40:43]
    v_exp_f32 v50, v50
    v_mfma_f32_16x16x32_bf16 v[40:43], v[228:231], a[28:31], v[40:43]
    ds_read_b128 v[36:39], v6 offset:42432
    v_cvt_pk_bf16_f32 v84, v48, v49
    v_mfma_f32_16x16x32_bf16 v[44:47], v[228:231], a[60:63], v[252:255]
    v_fma_f32 v51, v51, s31, v12
    v_fma_f32 v52, v52, s31, v13
    v_mfma_f32_16x16x32_bf16 v[44:47], a[248:251], a[56:59], v[44:47]
    v_exp_f32 v51, v51
    v_mfma_f32_16x16x32_bf16 v[44:47], a[244:247], a[52:55], v[44:47]
    v_exp_f32 v52, v52
    v_mfma_f32_16x16x32_bf16 v[44:47], a[240:243], a[48:51], v[44:47]
    ds_read_b128 a[192:195], v6 offset:42496
    v_cvt_pk_bf16_f32 v85, v50, v51
    v_mfma_f32_16x16x32_bf16 v[44:47], a[236:239], a[44:47], v[44:47]
    s_add_u32 m0, s30, 18528
    v_fma_f32 v53, v53, s31, v13
    v_fma_f32 v54, v54, s31, v13
    v_mfma_f32_16x16x32_bf16 v[44:47], a[232:235], a[40:43], v[44:47]
    v_exp_f32 v53, v53
    v_exp_f32 v54, v54
    v_mfma_f32_16x16x32_bf16 v[44:47], a[228:231], a[36:39], v[44:47]
    v_cvt_pk_bf16_f32 v92, v52, v53
    v_fma_f32 v55, v55, s31, v13
    v_mfma_f32_16x16x32_bf16 v[44:47], a[224:227], a[32:35], v[44:47]
    buffer_load_dwordx4 v1, s[12:15], s42 offen offset:1536 nt lds
    v_mfma_f32_16x16x32_bf16 v[48:51], a[224:227], a[64:67], v[252:255]
    v_exp_f32 v55, v55
    v_mfma_f32_16x16x32_bf16 v[48:51], a[228:231], a[68:71], v[48:51]
    ds_read_b128 a[196:199], v6 offset:42560
    v_fma_f32 v56, v56, s31, v14
    v_mfma_f32_16x16x32_bf16 v[48:51], a[232:235], a[72:75], v[48:51]
    v_exp_f32 v56, v56
    v_mfma_f32_16x16x32_bf16 v[48:51], a[236:239], a[76:79], v[48:51]
    ds_read_b128 a[200:203], v6 offset:42624
    v_cvt_pk_bf16_f32 v93, v54, v55
    v_mfma_f32_16x16x32_bf16 v[48:51], a[240:243], a[80:83], v[48:51]
    s_add_u32 m0, s30, 33792
    v_fma_f32 v57, v57, s31, v14
    v_fma_f32 v58, v58, s31, v14
    v_mfma_f32_16x16x32_bf16 v[48:51], a[244:247], a[84:87], v[48:51]
    v_exp_f32 v57, v57
    v_exp_f32 v58, v58
    v_mfma_f32_16x16x32_bf16 v[48:51], a[248:251], a[88:91], v[48:51]
    v_cvt_pk_bf16_f32 v20, v56, v57
    v_fma_f32 v59, v59, s31, v14
    v_mfma_f32_16x16x32_bf16 v[48:51], v[228:231], a[92:95], v[48:51]
    buffer_load_dwordx4 v1, s[12:15], s43 offen offset:0 nt lds
    v_mfma_f32_16x16x32_bf16 v[52:55], v[228:231], a[124:127], v[252:255]
    v_exp_f32 v59, v59
    v_mfma_f32_16x16x32_bf16 v[52:55], a[248:251], a[120:123], v[52:55]
    ds_read_b128 a[204:207], v6 offset:42688
    v_fma_f32 v60, v60, s31, v15
    v_mfma_f32_16x16x32_bf16 v[52:55], a[244:247], a[116:119], v[52:55]
    v_exp_f32 v60, v60
    v_mfma_f32_16x16x32_bf16 v[52:55], a[240:243], a[112:115], v[52:55]
    v_cvt_pk_bf16_f32 v21, v58, v59
    v_fma_f32 v61, v61, s31, v15
    v_mfma_f32_16x16x32_bf16 v[52:55], a[236:239], a[108:111], v[52:55]
    v_exp_f32 v61, v61
    v_mfma_f32_16x16x32_bf16 v[52:55], a[232:235], a[104:107], v[52:55]
    s_add_u32 m0, s30, 34336
    v_fma_f32 v62, v62, s31, v15
    v_cvt_pk_bf16_f32 v28, v60, v61
    v_mfma_f32_16x16x32_bf16 v[52:55], a[228:231], a[100:103], v[52:55]
    v_exp_f32 v62, v62
    v_fma_f32 v63, v63, s31, v15
    v_mfma_f32_16x16x32_bf16 v[52:55], a[224:227], a[96:99], v[52:55]
    s_waitcnt lgkmcnt(4)
    buffer_load_dwordx4 v1, s[12:15], s43 offen offset:512 nt lds
    v_mfma_f32_16x16x32_bf16 v[56:59], v[236:239], a[0:3], v[252:255]
    ds_read_b128 a[224:227], v6 offset:50688
    v_fma_f32 v64, v64, s31, v12
    v_mfma_f32_16x16x32_bf16 v[56:59], v[244:247], a[4:7], v[56:59]
    v_exp_f32 v63, v63
    v_mfma_f32_16x16x32_bf16 v[56:59], v[32:35], a[8:11], v[56:59]
    v_exp_f32 v64, v64
    v_mfma_f32_16x16x32_bf16 v[56:59], v[36:39], a[12:15], v[56:59]
    s_waitcnt lgkmcnt(1)
    ds_read_b128 a[228:231], v6 offset:50752
    v_cvt_pk_bf16_f32 v29, v62, v63
    v_mfma_f32_16x16x32_bf16 v[56:59], a[192:195], a[16:19], v[56:59]
    ds_read_b128 a[232:235], v6 offset:50816
    v_fma_f32 v65, v65, s31, v12
    v_mfma_f32_16x16x32_bf16 v[56:59], a[196:199], a[20:23], v[56:59]
    v_exp_f32 v65, v65
    v_fma_f32 v66, v66, s31, v12
    v_mfma_f32_16x16x32_bf16 v[56:59], a[200:203], a[24:27], v[56:59]
    s_add_u32 m0, s30, 34880
    v_exp_f32 v66, v66
    v_mfma_f32_16x16x32_bf16 v[56:59], a[204:207], a[28:31], v[56:59]
    ds_read_b128 a[236:239], v6 offset:50880
    v_cvt_pk_bf16_f32 v86, v64, v65
    v_fma_f32 v67, v67, s31, v12
    v_exp_f32 v67, v67
    v_mfma_f32_16x16x32_bf16 v[60:63], a[204:207], a[60:63], v[252:255]
    buffer_load_dwordx4 v1, s[12:15], s43 offen offset:1024 nt lds
    v_mfma_f32_16x16x32_bf16 v[60:63], a[200:203], a[56:59], v[60:63]
    v_fma_f32 v68, v68, s31, v13
    v_cvt_pk_bf16_f32 v87, v66, v67
    v_mfma_f32_16x16x32_bf16 v[60:63], a[196:199], a[52:55], v[60:63]
    v_exp_f32 v68, v68
    v_mfma_f32_16x16x32_bf16 v[60:63], a[192:195], a[48:51], v[60:63]
    ds_read_b128 a[240:243], v6 offset:50944
    v_fma_f32 v69, v69, s31, v13
    v_mfma_f32_16x16x32_bf16 v[60:63], v[36:39], a[44:47], v[60:63]
    v_exp_f32 v69, v69
    v_mfma_f32_16x16x32_bf16 v[60:63], v[32:35], a[40:43], v[60:63]
    v_fma_f32 v70, v70, s31, v13
    v_cvt_pk_bf16_f32 v94, v68, v69
    v_mfma_f32_16x16x32_bf16 v[60:63], v[244:247], a[36:39], v[60:63]
    v_exp_f32 v70, v70
    v_mfma_f32_16x16x32_bf16 v[60:63], v[236:239], a[32:35], v[60:63]
    s_add_u32 m0, s30, 35424
    ds_read_b128 a[244:247], v6 offset:51008
    v_fma_f32 v71, v71, s31, v13
    v_mfma_f32_16x16x32_bf16 v[64:67], v[236:239], a[64:67], v[252:255]
    v_exp_f32 v71, v71
    v_mfma_f32_16x16x32_bf16 v[64:67], v[244:247], a[68:71], v[64:67]
    buffer_load_dwordx4 v1, s[12:15], s43 offen offset:1536 nt lds
    v_fma_f32 v72, v72, s31, v14
    v_mfma_f32_16x16x32_bf16 v[64:67], v[32:35], a[72:75], v[64:67]
    v_exp_f32 v72, v72
    v_mfma_f32_16x16x32_bf16 v[64:67], v[36:39], a[76:79], v[64:67]
    ds_read_b128 a[248:251], v6 offset:51072
    v_cvt_pk_bf16_f32 v95, v70, v71
    v_mfma_f32_16x16x32_bf16 v[64:67], a[192:195], a[80:83], v[64:67]
    v_fma_f32 v73, v73, s31, v14
    v_fma_f32 v74, v74, s31, v14
    v_mfma_f32_16x16x32_bf16 v[64:67], a[196:199], a[84:87], v[64:67]
    v_exp_f32 v73, v73
    v_mfma_f32_16x16x32_bf16 v[64:67], a[200:203], a[88:91], v[64:67]
    v_exp_f32 v74, v74
    v_mfma_f32_16x16x32_bf16 v[64:67], a[204:207], a[92:95], v[64:67]
    ds_read_b128 v[228:231], v6 offset:51136
    v_cvt_pk_bf16_f32 v22, v72, v73
    v_mfma_f32_16x16x32_bf16 v[68:71], a[204:207], a[124:127], v[252:255]
    s_add_u32 m0, s30, 50688
    v_fma_f32 v75, v75, s31, v14
    v_fma_f32 v76, v76, s31, v15
    v_mfma_f32_16x16x32_bf16 v[68:71], a[200:203], a[120:123], v[68:71]
    v_exp_f32 v75, v75
    v_exp_f32 v76, v76
    v_mfma_f32_16x16x32_bf16 v[68:71], a[196:199], a[116:119], v[68:71]
    v_cvt_pk_bf16_f32 v23, v74, v75
    v_fma_f32 v77, v77, s31, v15
    v_mfma_f32_16x16x32_bf16 v[68:71], a[192:195], a[112:115], v[68:71]
    buffer_load_dwordx4 v1, s[12:15], s44 offen offset:0 nt lds
    v_mfma_f32_16x16x32_bf16 v[68:71], v[36:39], a[108:111], v[68:71]
    v_exp_f32 v77, v77
    v_mfma_f32_16x16x32_bf16 v[68:71], v[32:35], a[104:107], v[68:71]
    v_fma_f32 v78, v78, s31, v15
    v_cvt_pk_bf16_f32 v30, v76, v77
    v_mfma_f32_16x16x32_bf16 v[68:71], v[244:247], a[100:103], v[68:71]
    v_exp_f32 v78, v78
    v_mfma_f32_16x16x32_bf16 v[68:71], v[236:239], a[96:99], v[68:71]
    s_waitcnt lgkmcnt(4)
    ds_read_b128 v[236:239], v6 offset:59136
    v_fma_f32 v79, v79, s31, v15
    v_mfma_f32_16x16x32_bf16 v[72:75], a[224:227], a[0:3], v[252:255]
    v_exp_f32 v79, v79
    v_mfma_f32_16x16x32_bf16 v[72:75], a[228:231], a[4:7], v[72:75]
    s_add_u32 m0, s30, 51232
    ds_read_b128 v[244:247], v6 offset:59200
    v_fma_f32 v40, v40, s31, v12
    v_mfma_f32_16x16x32_bf16 v[72:75], a[232:235], a[8:11], v[72:75]
    v_exp_f32 v40, v40
    v_cvt_pk_bf16_f32 v31, v78, v79
    v_mfma_f32_16x16x32_bf16 v[72:75], a[236:239], a[12:15], v[72:75]
    s_waitcnt lgkmcnt(2)
    v_fma_f32 v41, v41, s31, v12
    v_fma_f32 v42, v42, s31, v12
    v_exp_f32 v41, v41
    v_mfma_f32_16x16x32_bf16 v[72:75], a[240:243], a[16:19], v[72:75]
    buffer_load_dwordx4 v1, s[12:15], s44 offen offset:512 nt lds
    v_mfma_f32_16x16x32_bf16 v[72:75], a[244:247], a[20:23], v[72:75]
    v_exp_f32 v42, v42
    v_mfma_f32_16x16x32_bf16 v[72:75], a[248:251], a[24:27], v[72:75]
    ds_read_b128 v[32:35], v6 offset:59264
    v_cvt_pk_bf16_f32 v96, v40, v41
    v_mfma_f32_16x16x32_bf16 v[72:75], v[228:231], a[28:31], v[72:75]
    v_fma_f32 v43, v43, s31, v12
    v_fma_f32 v44, v44, s31, v13
    v_mfma_f32_16x16x32_bf16 v[76:79], v[228:231], a[60:63], v[252:255]
    v_exp_f32 v43, v43
    v_mfma_f32_16x16x32_bf16 v[76:79], a[248:251], a[56:59], v[76:79]
    v_exp_f32 v44, v44
    v_mfma_f32_16x16x32_bf16 v[76:79], a[244:247], a[52:55], v[76:79]
    s_add_u32 m0, s30, 51776
    ds_read_b128 v[36:39], v6 offset:59328
    v_cvt_pk_bf16_f32 v97, v42, v43
    v_mfma_f32_16x16x32_bf16 v[76:79], a[240:243], a[48:51], v[76:79]
    v_fma_f32 v45, v45, s31, v13
    v_fma_f32 v46, v46, s31, v13
    v_exp_f32 v45, v45
    v_mfma_f32_16x16x32_bf16 v[76:79], a[236:239], a[44:47], v[76:79]
    buffer_load_dwordx4 v1, s[12:15], s44 offen offset:1024 nt lds
    v_mfma_f32_16x16x32_bf16 v[76:79], a[232:235], a[40:43], v[76:79]
    v_exp_f32 v46, v46
    v_mfma_f32_16x16x32_bf16 v[76:79], a[228:231], a[36:39], v[76:79]
    ds_read_b128 a[192:195], v6 offset:59392
    v_cvt_pk_bf16_f32 v104, v44, v45
    v_mfma_f32_16x16x32_bf16 v[76:79], a[224:227], a[32:35], v[76:79]
    v_fma_f32 v47, v47, s31, v13
    v_fma_f32 v48, v48, s31, v14
    v_smfmac_f32_16x16x64_bf16 a[208:211], a[252:255], v[80:87], v10
    v_fma_f32 v49, v49, s31, v14
    v_mfma_f32_16x16x32_bf16 v[40:43], a[224:227], a[64:67], v[252:255]
    v_exp_f32 v47, v47
    v_mfma_f32_16x16x32_bf16 v[40:43], a[228:231], a[68:71], v[40:43]
    v_exp_f32 v48, v48
    v_mfma_f32_16x16x32_bf16 v[40:43], a[232:235], a[72:75], v[40:43]
    s_add_u32 m0, s30, 52320
    ds_read_b128 a[196:199], v6 offset:59456
    v_cvt_pk_bf16_f32 v105, v46, v47
    v_mfma_f32_16x16x32_bf16 v[40:43], a[236:239], a[76:79], v[40:43]
    v_exp_f32 v49, v49
    v_mfma_f32_16x16x32_bf16 v[40:43], a[240:243], a[80:83], v[40:43]
    buffer_load_dwordx4 v1, s[12:15], s44 offen offset:1536 nt lds
    v_mfma_f32_16x16x32_bf16 v[40:43], a[244:247], a[84:87], v[40:43]
    ds_read_b128 a[200:203], v6 offset:59520
    v_fma_f32 v50, v50, s31, v14
    v_mfma_f32_16x16x32_bf16 v[40:43], a[248:251], a[88:91], v[40:43]
    v_exp_f32 v50, v50
    v_mfma_f32_16x16x32_bf16 v[40:43], v[228:231], a[92:95], v[40:43]
    v_cvt_pk_bf16_f32 v112, v48, v49
    v_fma_f32 v51, v51, s31, v14
    v_mfma_f32_16x16x32_bf16 v[44:47], v[228:231], a[124:127], v[252:255]
    v_exp_f32 v51, v51
    v_mfma_f32_16x16x32_bf16 v[44:47], a[248:251], a[120:123], v[44:47]
    ds_read_b128 a[204:207], v6 offset:59584
    v_fma_f32 v52, v52, s31, v15
    v_mfma_f32_16x16x32_bf16 v[44:47], a[244:247], a[116:119], v[44:47]
    s_add_u32 m0, s30, 67584
    v_exp_f32 v52, v52
    v_mfma_f32_16x16x32_bf16 v[44:47], a[240:243], a[112:115], v[44:47]
    v_cvt_pk_bf16_f32 v113, v50, v51
    v_fma_f32 v53, v53, s31, v15
    v_exp_f32 v53, v53
    v_mfma_f32_16x16x32_bf16 v[44:47], a[236:239], a[108:111], v[44:47]
    buffer_load_dwordx4 v1, s[12:15], s45 offen offset:0 nt lds
    v_mfma_f32_16x16x32_bf16 v[44:47], a[232:235], a[104:107], v[44:47]
    v_fma_f32 v54, v54, s31, v15
    v_cvt_pk_bf16_f32 v120, v52, v53
    v_mfma_f32_16x16x32_bf16 v[44:47], a[228:231], a[100:103], v[44:47]
    v_exp_f32 v54, v54
    v_mfma_f32_16x16x32_bf16 v[44:47], a[224:227], a[96:99], v[44:47]
    v_fma_f32 v55, v55, s31, v15
    v_fma_f32 v56, v56, s31, v12
    v_smfmac_f32_16x16x64_bf16 a[212:215], a[252:255], v[88:95], v10
    s_waitcnt lgkmcnt(4)
    s_waitcnt vmcnt(13)
    s_barrier
    v_mfma_f32_16x16x32_bf16 v[48:51], v[236:239], a[0:3], v[252:255]
    v_exp_f32 v55, v55
    v_mfma_f32_16x16x32_bf16 v[48:51], v[244:247], a[4:7], v[48:51]
    ds_read_b128 a[224:227], v7 offset:0
    v_cvt_pk_bf16_f32 v121, v54, v55
    v_mfma_f32_16x16x32_bf16 v[48:51], v[32:35], a[8:11], v[48:51]
    s_add_u32 m0, s30, 68128
    v_exp_f32 v56, v56
    v_mfma_f32_16x16x32_bf16 v[48:51], v[36:39], a[12:15], v[48:51]
    s_waitcnt lgkmcnt(1)
    ds_read_b128 a[228:231], v7 offset:64
    v_fma_f32 v57, v57, s31, v12
    v_exp_f32 v57, v57
    v_mfma_f32_16x16x32_bf16 v[48:51], a[192:195], a[16:19], v[48:51]
    buffer_load_dwordx4 v1, s[12:15], s45 offen offset:512 nt lds
    v_mfma_f32_16x16x32_bf16 v[48:51], a[196:199], a[20:23], v[48:51]
    ds_read_b128 a[232:235], v7 offset:128
    v_fma_f32 v58, v58, s31, v12
    v_mfma_f32_16x16x32_bf16 v[48:51], a[200:203], a[24:27], v[48:51]
    v_exp_f32 v58, v58
    v_mfma_f32_16x16x32_bf16 v[48:51], a[204:207], a[28:31], v[48:51]
    v_cvt_pk_bf16_f32 v98, v56, v57
    v_fma_f32 v59, v59, s31, v12
    v_mfma_f32_16x16x32_bf16 v[52:55], a[204:207], a[60:63], v[252:255]
    v_exp_f32 v59, v59
    v_mfma_f32_16x16x32_bf16 v[52:55], a[200:203], a[56:59], v[52:55]
    ds_read_b128 a[236:239], v7 offset:192
    v_fma_f32 v60, v60, s31, v13
    v_mfma_f32_16x16x32_bf16 v[52:55], a[196:199], a[52:55], v[52:55]
    v_exp_f32 v60, v60
    v_mfma_f32_16x16x32_bf16 v[52:55], a[192:195], a[48:51], v[52:55]
    s_add_u32 m0, s30, 68672
    v_cvt_pk_bf16_f32 v99, v58, v59
    v_fma_f32 v61, v61, s31, v13
    v_mfma_f32_16x16x32_bf16 v[52:55], v[36:39], a[44:47], v[52:55]
    v_exp_f32 v61, v61
    v_mfma_f32_16x16x32_bf16 v[52:55], v[32:35], a[40:43], v[52:55]
    buffer_load_dwordx4 v1, s[12:15], s45 offen offset:1024 nt lds
    v_mfma_f32_16x16x32_bf16 v[52:55], v[244:247], a[36:39], v[52:55]
    ds_read_b128 a[240:243], v7 offset:256
    v_fma_f32 v62, v62, s31, v13
    v_mfma_f32_16x16x32_bf16 v[52:55], v[236:239], a[32:35], v[52:55]
    v_exp_f32 v62, v62
    v_smfmac_f32_16x16x64_bf16 a[216:219], a[252:255], v[16:23], v10
    v_cvt_pk_bf16_f32 v106, v60, v61
    v_mfma_f32_16x16x32_bf16 v[56:59], v[236:239], a[64:67], v[252:255]
    ds_read_b128 a[244:247], v7 offset:320
    v_fma_f32 v63, v63, s31, v13
    v_mfma_f32_16x16x32_bf16 v[56:59], v[244:247], a[68:71], v[56:59]
    v_exp_f32 v63, v63
    v_fma_f32 v64, v64, s31, v14
    v_mfma_f32_16x16x32_bf16 v[56:59], v[32:35], a[72:75], v[56:59]
L_pg3:
    s_cbranch_execz L_pg7
    v_exp_f32 v64, v64
    v_mfma_f32_16x16x32_bf16 v[56:59], v[36:39], a[76:79], v[56:59]
    s_add_u32 m0, s30, 69216
    v_cvt_pk_bf16_f32 v107, v62, v63
    v_fma_f32 v65, v65, s31, v14
    v_mfma_f32_16x16x32_bf16 v[56:59], a[192:195], a[80:83], v[56:59]
    v_exp_f32 v65, v65
    v_mfma_f32_16x16x32_bf16 v[56:59], a[196:199], a[84:87], v[56:59]
    buffer_load_dwordx4 v1, s[12:15], s45 offen offset:1536 nt lds
    v_mfma_f32_16x16x32_bf16 v[56:59], a[200:203], a[88:91], v[56:59]
    ds_read_b128 a[248:251], v7 offset:384
    v_fma_f32 v66, v66, s31, v14
    v_mfma_f32_16x16x32_bf16 v[56:59], a[204:207], a[92:95], v[56:59]
    v_exp_f32 v66, v66
    v_cvt_pk_bf16_f32 v114, v64, v65
    v_mfma_f32_16x16x32_bf16 v[60:63], a[204:207], a[124:127], v[252:255]
    ds_read_b128 v[228:231], v7 offset:448
    v_fma_f32 v67, v67, s31, v14
    v_mfma_f32_16x16x32_bf16 v[60:63], a[200:203], a[120:123], v[60:63]
    v_exp_f32 v67, v67
    v_mfma_f32_16x16x32_bf16 v[60:63], a[196:199], a[116:119], v[60:63]
    v_fma_f32 v68, v68, s31, v15
    v_cvt_pk_bf16_f32 v115, v66, v67
    v_mfma_f32_16x16x32_bf16 v[60:63], a[192:195], a[112:115], v[60:63]
    s_add_u32 m0, s30, 84480
    v_exp_f32 v68, v68
    v_mfma_f32_16x16x32_bf16 v[60:63], v[36:39], a[108:111], v[60:63]
    v_fma_f32 v69, v69, s31, v15
    v_fma_f32 v70, v70, s31, v15
    v_exp_f32 v69, v69
    v_mfma_f32_16x16x32_bf16 v[60:63], v[32:35], a[104:107], v[60:63]
    buffer_load_dwordx4 v1, s[12:15], s46 offen offset:0 nt lds
    v_mfma_f32_16x16x32_bf16 v[60:63], v[244:247], a[100:103], v[60:63]
    v_exp_f32 v70, v70
    v_mfma_f32_16x16x32_bf16 v[60:63], v[236:239], a[96:99], v[60:63]
    ds_read_b128 v[236:239], v7 offset:8448
    v_cvt_pk_bf16_f32 v122, v68, v69
    v_smfmac_f32_16x16x64_bf16 a[220:223], a[252:255], v[24:31], v10
    s_waitcnt lgkmcnt(5)
    ds_read_b128 v[244:247], v7 offset:8512
    v_mfma_f32_16x16x32_bf16 v[64:67], a[224:227], a[0:3], v[252:255]
    v_fma_f32 v71, v71, s31, v15
    v_fma_f32 v72, v72, s31, v12
    v_mfma_f32_16x16x32_bf16 v[64:67], a[228:231], a[4:7], v[64:67]
    v_exp_f32 v71, v71
    v_mfma_f32_16x16x32_bf16 v[64:67], a[232:235], a[8:11], v[64:67]
    v_exp_f32 v72, v72
    v_mfma_f32_16x16x32_bf16 v[64:67], a[236:239], a[12:15], v[64:67]
    s_waitcnt lgkmcnt(2)
    ds_read_b128 v[32:35], v7 offset:8576
    v_cvt_pk_bf16_f32 v123, v70, v71
    v_mfma_f32_16x16x32_bf16 v[64:67], a[240:243], a[16:19], v[64:67]
    s_add_u32 m0, s30, 85024
    v_fma_f32 v73, v73, s31, v12
    v_fma_f32 v74, v74, s31, v12
    v_exp_f32 v73, v73
    v_mfma_f32_16x16x32_bf16 v[64:67], a[244:247], a[20:23], v[64:67]
    buffer_load_dwordx4 v1, s[12:15], s46 offen offset:512 nt lds
    v_mfma_f32_16x16x32_bf16 v[64:67], a[248:251], a[24:27], v[64:67]
    v_exp_f32 v74, v74
    v_mfma_f32_16x16x32_bf16 v[64:67], v[228:231], a[28:31], v[64:67]
    ds_read_b128 v[36:39], v7 offset:8640
    v_cvt_pk_bf16_f32 v100, v72, v73
    v_mfma_f32_16x16x32_bf16 v[68:71], v[228:231], a[60:63], v[252:255]
    v_fma_f32 v75, v75, s31, v12
    v_fma_f32 v76, v76, s31, v13
    v_mfma_f32_16x16x32_bf16 v[68:71], a[248:251], a[56:59], v[68:71]
    v_exp_f32 v75, v75
    v_mfma_f32_16x16x32_bf16 v[68:71], a[244:247], a[52:55], v[68:71]
    v_exp_f32 v76, v76
    v_mfma_f32_16x16x32_bf16 v[68:71], a[240:243], a[48:51], v[68:71]
    ds_read_b128 a[192:195], v7 offset:8704
    v_cvt_pk_bf16_f32 v101, v74, v75
    v_mfma_f32_16x16x32_bf16 v[68:71], a[236:239], a[44:47], v[68:71]
    s_add_u32 m0, s30, 85568
    v_fma_f32 v77, v77, s31, v13
    v_fma_f32 v78, v78, s31, v13
    v_mfma_f32_16x16x32_bf16 v[68:71], a[232:235], a[40:43], v[68:71]
    v_exp_f32 v77, v77
    v_exp_f32 v78, v78
    v_mfma_f32_16x16x32_bf16 v[68:71], a[228:231], a[36:39], v[68:71]
    v_cvt_pk_bf16_f32 v108, v76, v77
    v_fma_f32 v79, v79, s31, v13
    v_mfma_f32_16x16x32_bf16 v[68:71], a[224:227], a[32:35], v[68:71]
    buffer_load_dwordx4 v1, s[12:15], s46 offen offset:1024 nt lds
    v_mfma_f32_16x16x32_bf16 v[72:75], a[224:227], a[64:67], v[252:255]
    v_exp_f32 v79, v79
    v_mfma_f32_16x16x32_bf16 v[72:75], a[228:231], a[68:71], v[72:75]
    ds_read_b128 a[196:199], v7 offset:8768
    v_fma_f32 v40, v40, s31, v14
    v_mfma_f32_16x16x32_bf16 v[72:75], a[232:235], a[72:75], v[72:75]
    v_exp_f32 v40, v40
    v_mfma_f32_16x16x32_bf16 v[72:75], a[236:239], a[76:79], v[72:75]
    ds_read_b128 a[200:203], v7 offset:8832
    v_cvt_pk_bf16_f32 v109, v78, v79
    v_mfma_f32_16x16x32_bf16 v[72:75], a[240:243], a[80:83], v[72:75]
    v_fma_f32 v41, v41, s31, v14
    v_fma_f32 v42, v42, s31, v14
    v_mfma_f32_16x16x32_bf16 v[72:75], a[244:247], a[84:87], v[72:75]
    s_add_u32 m0, s30, 86112
    v_exp_f32 v41, v41
    v_mfma_f32_16x16x32_bf16 v[72:75], a[248:251], a[88:91], v[72:75]
    v_exp_f32 v42, v42
    v_cvt_pk_bf16_f32 v116, v40, v41
    v_mfma_f32_16x16x32_bf16 v[72:75], v[228:231], a[92:95], v[72:75]
    ds_read_b128 a[204:207], v7 offset:8896
    v_fma_f32 v43, v43, s31, v14
    v_exp_f32 v43, v43
    v_mfma_f32_16x16x32_bf16 v[76:79], v[228:231], a[124:127], v[252:255]
    buffer_load_dwordx4 v1, s[12:15], s46 offen offset:1536 nt lds
    v_mfma_f32_16x16x32_bf16 v[76:79], a[248:251], a[120:123], v[76:79]
    v_fma_f32 v44, v44, s31, v15
    v_cvt_pk_bf16_f32 v117, v42, v43
    v_mfma_f32_16x16x32_bf16 v[76:79], a[244:247], a[116:119], v[76:79]
    v_exp_f32 v44, v44
    v_mfma_f32_16x16x32_bf16 v[76:79], a[240:243], a[112:115], v[76:79]
    v_fma_f32 v45, v45, s31, v15
    v_fma_f32 v46, v46, s31, v15
    v_mfma_f32_16x16x32_bf16 v[76:79], a[236:239], a[108:111], v[76:79]
    v_exp_f32 v45, v45
    v_mfma_f32_16x16x32_bf16 v[76:79], a[232:235], a[104:107], v[76:79]
    v_exp_f32 v46, v46
    v_mfma_f32_16x16x32_bf16 v[76:79], a[228:231], a[100:103], v[76:79]
    s_add_u32 m0, s30, 101376
    v_cvt_pk_bf16_f32 v124, v44, v45
    v_fma_f32 v47, v47, s31, v15
    v_mfma_f32_16x16x32_bf16 v[76:79], a[224:227], a[96:99], v[76:79]
    s_waitcnt lgkmcnt(4)
    ds_read_b128 a[224:227], v5 offset:0
    v_fma_f32 v48, v48, s31, v12
    v_exp_f32 v47, v47
    v_mfma_f32_16x16x32_bf16 v[40:43], v[236:239], a[0:3], v[252:255]
    buffer_load_dwordx4 v1, s[12:15], s47 offen offset:0 nt lds
    v_mfma_f32_16x16x32_bf16 v[40:43], v[244:247], a[4:7], v[40:43]
    v_exp_f32 v48, v48
    v_mfma_f32_16x16x32_bf16 v[40:43], v[32:35], a[8:11], v[40:43]
    ds_read_b128 a[228:231], v5 offset:64
    v_cvt_pk_bf16_f32 v125, v46, v47
    v_mfma_f32_16x16x32_bf16 v[40:43], v[36:39], a[12:15], v[40:43]
    s_waitcnt lgkmcnt(2)
    ds_read_b128 a[232:235], v5 offset:128
    v_fma_f32 v49, v49, s31, v12
    v_mfma_f32_16x16x32_bf16 v[40:43], a[192:195], a[16:19], v[40:43]
    v_exp_f32 v49, v49
    v_mfma_f32_16x16x32_bf16 v[40:43], a[196:199], a[20:23], v[40:43]
    v_fma_f32 v50, v50, s31, v12
    v_cvt_pk_bf16_f32 v102, v48, v49
    v_mfma_f32_16x16x32_bf16 v[40:43], a[200:203], a[24:27], v[40:43]
    v_exp_f32 v50, v50
    v_mfma_f32_16x16x32_bf16 v[40:43], a[204:207], a[28:31], v[40:43]
    s_add_u32 m0, s30, 101920
    ds_read_b128 a[236:239], v5 offset:192
    v_fma_f32 v51, v51, s31, v12
    v_mfma_f32_16x16x32_bf16 v[44:47], a[204:207], a[60:63], v[252:255]
    v_exp_f32 v51, v51
    v_mfma_f32_16x16x32_bf16 v[44:47], a[200:203], a[56:59], v[44:47]
    buffer_load_dwordx4 v1, s[12:15], s47 offen offset:512 nt lds
    v_fma_f32 v52, v52, s31, v13
    v_mfma_f32_16x16x32_bf16 v[44:47], a[196:199], a[52:55], v[44:47]
    v_exp_f32 v52, v52
    v_mfma_f32_16x16x32_bf16 v[44:47], a[192:195], a[48:51], v[44:47]
    ds_read_b128 a[240:243], v5 offset:256
    v_cvt_pk_bf16_f32 v103, v50, v51
    v_mfma_f32_16x16x32_bf16 v[44:47], v[36:39], a[44:47], v[44:47]
    v_fma_f32 v53, v53, s31, v13
    v_fma_f32 v54, v54, s31, v13
    v_mfma_f32_16x16x32_bf16 v[44:47], v[32:35], a[40:43], v[44:47]
    v_exp_f32 v53, v53
    v_mfma_f32_16x16x32_bf16 v[44:47], v[244:247], a[36:39], v[44:47]
    v_exp_f32 v54, v54
    v_mfma_f32_16x16x32_bf16 v[44:47], v[236:239], a[32:35], v[44:47]
    ds_read_b128 a[244:247], v5 offset:320
    v_cvt_pk_bf16_f32 v110, v52, v53
    v_mfma_f32_16x16x32_bf16 v[48:51], v[236:239], a[64:67], v[252:255]
    s_add_u32 m0, s30, 102464
    v_fma_f32 v55, v55, s31, v13
    v_fma_f32 v56, v56, s31, v14
    v_mfma_f32_16x16x32_bf16 v[48:51], v[244:247], a[68:71], v[48:51]
    v_exp_f32 v55, v55
    v_exp_f32 v56, v56
    v_mfma_f32_16x16x32_bf16 v[48:51], v[32:35], a[72:75], v[48:51]
    v_cvt_pk_bf16_f32 v111, v54, v55
    v_fma_f32 v57, v57, s31, v14
    v_mfma_f32_16x16x32_bf16 v[48:51], v[36:39], a[76:79], v[48:51]
    buffer_load_dwordx4 v1, s[12:15], s47 offen offset:1024 nt lds
    v_mfma_f32_16x16x32_bf16 v[48:51], a[192:195], a[80:83], v[48:51]
    v_exp_f32 v57, v57
    v_mfma_f32_16x16x32_bf16 v[48:51], a[196:199], a[84:87], v[48:51]
    ds_read_b128 a[248:251], v5 offset:384
    v_fma_f32 v58, v58, s31, v14
    v_mfma_f32_16x16x32_bf16 v[48:51], a[200:203], a[88:91], v[48:51]
    v_exp_f32 v58, v58
    v_cvt_pk_bf16_f32 v118, v56, v57
    v_mfma_f32_16x16x32_bf16 v[48:51], a[204:207], a[92:95], v[48:51]
    ds_read_b128 v[228:231], v5 offset:448
    v_fma_f32 v59, v59, s31, v14
    v_exp_f32 v59, v59
    v_mfma_f32_16x16x32_bf16 v[52:55], a[204:207], a[124:127], v[252:255]
    buffer_load_dword v9, v249, s[16:19], s57 offen nt
    v_mfma_f32_16x16x32_bf16 v[52:55], a[200:203], a[120:123], v[52:55]
    s_add_u32 m0, s30, 103008
    v_fma_f32 v60, v60, s31, v15
    v_cvt_pk_bf16_f32 v119, v58, v59
    v_mfma_f32_16x16x32_bf16 v[52:55], a[196:199], a[116:119], v[52:55]
    v_exp_f32 v60, v60
    v_mfma_f32_16x16x32_bf16 v[52:55], a[192:195], a[112:115], v[52:55]
    v_fma_f32 v61, v61, s31, v15
    v_fma_f32 v62, v62, s31, v15
    v_exp_f32 v61, v61
    v_mfma_f32_16x16x32_bf16 v[52:55], v[36:39], a[108:111], v[52:55]
    buffer_load_dwordx4 v1, s[12:15], s47 offen offset:1536 nt lds
    v_mfma_f32_16x16x32_bf16 v[52:55], v[32:35], a[104:107], v[52:55]
    v_exp_f32 v62, v62
    v_mfma_f32_16x16x32_bf16 v[52:55], v[244:247], a[100:103], v[52:55]
    v_cvt_pk_bf16_f32 v126, v60, v61
    v_fma_f32 v63, v63, s31, v15
    v_mfma_f32_16x16x32_bf16 v[52:55], v[236:239], a[96:99], v[52:55]
    s_waitcnt lgkmcnt(4)
    buffer_load_dword v9, v249, s[16:19], s57 offen sc1
    v_mfma_f32_16x16x32_bf16 v[56:59], a[224:227], a[0:3], v[252:255]
    v_exp_f32 v63, v63
    v_mfma_f32_16x16x32_bf16 v[56:59], a[228:231], a[4:7], v[56:59]
    ds_read_b128 v[236:239], v5 offset:8448
    v_fma_f32 v64, v64, s31, v12
    v_mfma_f32_16x16x32_bf16 v[56:59], a[232:235], a[8:11], v[56:59]
    s_waitcnt vmcnt(18)
    s_barrier
    ds_read_b128 v[244:247], v5 offset:8512
    v_exp_f32 v64, v64
    v_mfma_f32_16x16x32_bf16 v[56:59], a[236:239], a[12:15], v[56:59]
    s_waitcnt lgkmcnt(2)
    v_cvt_pk_bf16_f32 v127, v62, v63
    v_fma_f32 v65, v65, s31, v12
    v_mfma_f32_16x16x32_bf16 v[56:59], a[240:243], a[16:19], v[56:59]
    s_add_u32 s61, s48, s98
    v_exp_f32 v65, v65
    v_mfma_f32_16x16x32_bf16 v[56:59], a[244:247], a[20:23], v[56:59]
    s_add_u32 m0, s30, 118272
    ds_read_b128 v[32:35], v5 offset:8576
    v_fma_f32 v66, v66, s31, v12
    v_exp_f32 v66, v66
    v_mfma_f32_16x16x32_bf16 v[56:59], a[248:251], a[24:27], v[56:59]
    buffer_load_dwordx4 v2, s[16:19], s61 offen offset:0 nt lds
    v_mfma_f32_16x16x32_bf16 v[56:59], v[228:231], a[28:31], v[56:59]
    v_cvt_pk_bf16_f32 v128, v64, v65
    v_fma_f32 v67, v67, s31, v12
    v_mfma_f32_16x16x32_bf16 v[60:63], v[228:231], a[60:63], v[252:255]
    v_exp_f32 v67, v67
    v_mfma_f32_16x16x32_bf16 v[60:63], a[248:251], a[56:59], v[60:63]
    ds_read_b128 v[36:39], v5 offset:8640
    v_fma_f32 v68, v68, s31, v13
    v_mfma_f32_16x16x32_bf16 v[60:63], a[244:247], a[52:55], v[60:63]
    v_exp_f32 v68, v68
    v_mfma_f32_16x16x32_bf16 v[60:63], a[240:243], a[48:51], v[60:63]
    v_cvt_pk_bf16_f32 v129, v66, v67
    v_fma_f32 v69, v69, s31, v13
    v_mfma_f32_16x16x32_bf16 v[60:63], a[236:239], a[44:47], v[60:63]
    v_exp_f32 v69, v69
    v_mfma_f32_16x16x32_bf16 v[60:63], a[232:235], a[40:43], v[60:63]
    ds_read_b128 a[192:195], v5 offset:8704
    v_fma_f32 v70, v70, s31, v13
    v_mfma_f32_16x16x32_bf16 v[60:63], a[228:231], a[36:39], v[60:63]
    v_exp_f32 v70, v70
    v_mfma_f32_16x16x32_bf16 v[60:63], a[224:227], a[32:35], v[60:63]
    v_cvt_pk_bf16_f32 v136, v68, v69
    v_fma_f32 v71, v71, s31, v13
    v_smfmac_f32_16x16x64_bf16 a[208:211], a[252:255], v[96:103], v10
    v_fma_f32 v72, v72, s31, v14
    v_mfma_f32_16x16x32_bf16 v[64:67], a[224:227], a[64:67], v[252:255]
    v_exp_f32 v71, v71
    v_mfma_f32_16x16x32_bf16 v[64:67], a[228:231], a[68:71], v[64:67]
    v_exp_f32 v72, v72
    v_mfma_f32_16x16x32_bf16 v[64:67], a[232:235], a[72:75], v[64:67]
    ds_read_b128 a[196:199], v5 offset:8768
    v_cvt_pk_bf16_f32 v137, v70, v71
    v_mfma_f32_16x16x32_bf16 v[64:67], a[236:239], a[76:79], v[64:67]
    s_add_u32 m0, s30, 118304
    v_fma_f32 v73, v73, s31, v14
    v_fma_f32 v74, v74, s31, v14
    v_mfma_f32_16x16x32_bf16 v[64:67], a[240:243], a[80:83], v[64:67]
    v_exp_f32 v73, v73
    v_mfma_f32_16x16x32_bf16 v[64:67], a[244:247], a[84:87], v[64:67]
    buffer_load_dwordx4 v2, s[16:19], s61 offen offset:1024 nt lds
    v_mfma_f32_16x16x32_bf16 v[64:67], a[248:251], a[88:91], v[64:67]
    v_exp_f32 v74, v74
    v_mfma_f32_16x16x32_bf16 v[64:67], v[228:231], a[92:95], v[64:67]
    ds_read_b128 a[200:203], v5 offset:8832
    v_cvt_pk_bf16_f32 v144, v72, v73
    v_mfma_f32_16x16x32_bf16 v[68:71], v[228:231], a[124:127], v[252:255]
    ds_read_b128 a[204:207], v5 offset:8896
    v_fma_f32 v75, v75, s31, v14
    v_mfma_f32_16x16x32_bf16 v[68:71], a[248:251], a[120:123], v[68:71]
    v_exp_f32 v75, v75
    v_mfma_f32_16x16x32_bf16 v[68:71], a[244:247], a[116:119], v[68:71]
    v_fma_f32 v76, v76, s31, v15
    v_cvt_pk_bf16_f32 v145, v74, v75
    v_mfma_f32_16x16x32_bf16 v[68:71], a[240:243], a[112:115], v[68:71]
    v_exp_f32 v76, v76
    v_mfma_f32_16x16x32_bf16 v[68:71], a[236:239], a[108:111], v[68:71]
    v_fma_f32 v77, v77, s31, v15
    v_fma_f32 v78, v78, s31, v15
    v_mfma_f32_16x16x32_bf16 v[68:71], a[232:235], a[104:107], v[68:71]
    v_exp_f32 v77, v77
    v_mfma_f32_16x16x32_bf16 v[68:71], a[228:231], a[100:103], v[68:71]
    v_exp_f32 v78, v78
    v_mfma_f32_16x16x32_bf16 v[68:71], a[224:227], a[96:99], v[68:71]
    ds_read_b128 a[224:227], v5 offset:16896
    v_cvt_pk_bf16_f32 v152, v76, v77
    v_smfmac_f32_16x16x64_bf16 a[212:215], a[252:255], v[104:111], v10
    s_waitcnt lgkmcnt(5)
    v_fma_f32 v79, v79, s31, v15
    v_mfma_f32_16x16x32_bf16 v[72:75], v[236:239], a[0:3], v[252:255]
    v_exp_f32 v79, v79
    v_mfma_f32_16x16x32_bf16 v[72:75], v[244:247], a[4:7], v[72:75]
    ds_read_b128 a[228:231], v5 offset:16960
    v_fma_f32 v40, v40, s31, v12
    v_mfma_f32_16x16x32_bf16 v[72:75], v[32:35], a[8:11], v[72:75]
    s_add_u32 m0, s30, 118336
    v_exp_f32 v40, v40
    v_mfma_f32_16x16x32_bf16 v[72:75], v[36:39], a[12:15], v[72:75]
    s_waitcnt lgkmcnt(2)
    v_cvt_pk_bf16_f32 v153, v78, v79
    v_fma_f32 v41, v41, s31, v12
    v_exp_f32 v41, v41
    v_mfma_f32_16x16x32_bf16 v[72:75], a[192:195], a[16:19], v[72:75]
    buffer_load_dwordx4 v2, s[16:19], s61 offen offset:2048 nt lds
    v_mfma_f32_16x16x32_bf16 v[72:75], a[196:199], a[20:23], v[72:75]
    ds_read_b128 a[232:235], v5 offset:17024
    v_fma_f32 v42, v42, s31, v12
    v_mfma_f32_16x16x32_bf16 v[72:75], a[200:203], a[24:27], v[72:75]
    v_exp_f32 v42, v42
    v_mfma_f32_16x16x32_bf16 v[72:75], a[204:207], a[28:31], v[72:75]
    v_cvt_pk_bf16_f32 v130, v40, v41
    v_fma_f32 v43, v43, s31, v12
    v_mfma_f32_16x16x32_bf16 v[76:79], a[204:207], a[60:63], v[252:255]
    v_exp_f32 v43, v43
    v_mfma_f32_16x16x32_bf16 v[76:79], a[200:203], a[56:59], v[76:79]
    ds_read_b128 a[236:239], v5 offset:17088
    v_fma_f32 v44, v44, s31, v13
    v_mfma_f32_16x16x32_bf16 v[76:79], a[196:199], a[52:55], v[76:79]
    v_exp_f32 v44, v44
    v_mfma_f32_16x16x32_bf16 v[76:79], a[192:195], a[48:51], v[76:79]
    v_cvt_pk_bf16_f32 v131, v42, v43
    v_fma_f32 v45, v45, s31, v13
    v_mfma_f32_16x16x32_bf16 v[76:79], v[36:39], a[44:47], v[76:79]
    v_exp_f32 v45, v45
    v_mfma_f32_16x16x32_bf16 v[76:79], v[32:35], a[40:43], v[76:79]
    ds_read_b128 a[240:243], v5 offset:17152
    v_fma_f32 v46, v46, s31, v13
    v_mfma_f32_16x16x32_bf16 v[76:79], v[244:247], a[36:39], v[76:79]
    v_exp_f32 v46, v46
    v_mfma_f32_16x16x32_bf16 v[76:79], v[236:239], a[32:35], v[76:79]
    v_cvt_pk_bf16_f32 v138, v44, v45
    v_fma_f32 v47, v47, s31, v13
    v_smfmac_f32_16x16x64_bf16 a[216:219], a[252:255], v[112:119], v10
    v_fma_f32 v48, v48, s31, v14
    v_mfma_f32_16x16x32_bf16 v[40:43], v[236:239], a[64:67], v[252:255]
    v_exp_f32 v47, v47
    v_mfma_f32_16x16x32_bf16 v[40:43], v[244:247], a[68:71], v[40:43]
    s_add_u32 m0, s30, 118368
    v_exp_f32 v48, v48
    v_mfma_f32_16x16x32_bf16 v[40:43], v[32:35], a[72:75], v[40:43]
    ds_read_b128 a[244:247], v5 offset:17216
    v_cvt_pk_bf16_f32 v139, v46, v47
    v_mfma_f32_16x16x32_bf16 v[40:43], v[36:39], a[76:79], v[40:43]
    v_fma_f32 v49, v49, s31, v14
    v_fma_f32 v50, v50, s31, v14
    v_exp_f32 v49, v49
    v_mfma_f32_16x16x32_bf16 v[40:43], a[192:195], a[80:83], v[40:43]
    buffer_load_dwordx4 v2, s[16:19], s61 offen offset:3072 nt lds
    v_mfma_f32_16x16x32_bf16 v[40:43], a[196:199], a[84:87], v[40:43]
    v_exp_f32 v50, v50
    v_mfma_f32_16x16x32_bf16 v[40:43], a[200:203], a[88:91], v[40:43]
    ds_read_b128 a[248:251], v5 offset:17280
    v_cvt_pk_bf16_f32 v146, v48, v49
    v_mfma_f32_16x16x32_bf16 v[40:43], a[204:207], a[92:95], v[40:43]
    v_fma_f32 v51, v51, s31, v14
    v_fma_f32 v52, v52, s31, v15
    v_mfma_f32_16x16x32_bf16 v[44:47], a[204:207], a[124:127], v[252:255]
    v_exp_f32 v51, v51
    v_mfma_f32_16x16x32_bf16 v[44:47], a[200:203], a[120:123], v[44:47]
    buffer_load_dword v9, v248, s[16:19], s52 offen nt
    v_mfma_f32_16x16x32_bf16 v[44:47], a[196:199], a[116:119], v[44:47]
    v_exp_f32 v52, v52
    v_mfma_f32_16x16x32_bf16 v[44:47], a[192:195], a[112:115], v[44:47]
    ds_read_b128 v[228:231], v5 offset:17344
    v_cvt_pk_bf16_f32 v147, v50, v51
    v_mfma_f32_16x16x32_bf16 v[44:47], v[36:39], a[108:111], v[44:47]
    v_fma_f32 v53, v53, s31, v15
    v_fma_f32 v54, v54, s31, v15
    v_mfma_f32_16x16x32_bf16 v[44:47], v[32:35], a[104:107], v[44:47]
    v_exp_f32 v53, v53
    v_mfma_f32_16x16x32_bf16 v[44:47], v[244:247], a[100:103], v[44:47]
    buffer_load_dword v9, v248, s[16:19], s52 offen sc1
    v_mfma_f32_16x16x32_bf16 v[44:47], v[236:239], a[96:99], v[44:47]
    v_exp_f32 v54, v54
    v_smfmac_f32_16x16x64_bf16 a[220:223], a[252:255], v[120:127], v10
    s_waitcnt lgkmcnt(4)
    ds_read_b128 v[236:239], v5 offset:25344
    v_cvt_pk_bf16_f32 v154, v52, v53
    v_mfma_f32_16x16x32_bf16 v[48:51], a[224:227], a[0:3], v[252:255]
    s_add_u32 s61, s49, s98
    ds_read_b128 v[244:247], v5 offset:25408
    v_fma_f32 v55, v55, s31, v15
    v_mfma_f32_16x16x32_bf16 v[48:51], a[228:231], a[4:7], v[48:51]
    s_add_u32 m0, s30, 135168
    v_exp_f32 v55, v55
    v_fma_f32 v56, v56, s31, v12
    v_exp_f32 v56, v56
    v_mfma_f32_16x16x32_bf16 v[48:51], a[232:235], a[8:11], v[48:51]
    v_cvt_pk_bf16_f32 v155, v54, v55
    v_fma_f32 v57, v57, s31, v12
    v_mfma_f32_16x16x32_bf16 v[48:51], a[236:239], a[12:15], v[48:51]
    s_waitcnt lgkmcnt(2)
    buffer_load_dwordx4 v2, s[16:19], s61 offen offset:0 nt lds
    v_mfma_f32_16x16x32_bf16 v[48:51], a[240:243], a[16:19], v[48:51]
    v_exp_f32 v57, v57
    v_mfma_f32_16x16x32_bf16 v[48:51], a[244:247], a[20:23], v[48:51]
    ds_read_b128 v[32:35], v5 offset:25472
    v_fma_f32 v58, v58, s31, v12
    v_mfma_f32_16x16x32_bf16 v[48:51], a[248:251], a[24:27], v[48:51]
    v_exp_f32 v58, v58
    v_mfma_f32_16x16x32_bf16 v[48:51], v[228:231], a[28:31], v[48:51]
    ds_read_b128 v[36:39], v5 offset:25536
    v_cvt_pk_bf16_f32 v132, v56, v57
    v_mfma_f32_16x16x32_bf16 v[52:55], v[228:231], a[60:63], v[252:255]
    v_fma_f32 v59, v59, s31, v12
    v_fma_f32 v60, v60, s31, v13
    v_mfma_f32_16x16x32_bf16 v[52:55], a[248:251], a[56:59], v[52:55]
    v_exp_f32 v59, v59
    v_mfma_f32_16x16x32_bf16 v[52:55], a[244:247], a[52:55], v[52:55]
    v_exp_f32 v60, v60
    v_mfma_f32_16x16x32_bf16 v[52:55], a[240:243], a[48:51], v[52:55]
    ds_read_b128 a[192:195], v5 offset:25600
    v_cvt_pk_bf16_f32 v133, v58, v59
    v_mfma_f32_16x16x32_bf16 v[52:55], a[236:239], a[44:47], v[52:55]
    v_fma_f32 v61, v61, s31, v13
    v_fma_f32 v62, v62, s31, v13
    v_mfma_f32_16x16x32_bf16 v[52:55], a[232:235], a[40:43], v[52:55]
    v_exp_f32 v61, v61
    v_mfma_f32_16x16x32_bf16 v[52:55], a[228:231], a[36:39], v[52:55]
    v_exp_f32 v62, v62
    v_mfma_f32_16x16x32_bf16 v[52:55], a[224:227], a[32:35], v[52:55]
    ds_read_b128 a[196:199], v5 offset:25664
    v_cvt_pk_bf16_f32 v140, v60, v61
    v_mfma_f32_16x16x32_bf16 v[56:59], a[224:227], a[64:67], v[252:255]
    s_add_u32 m0, s30, 135200
    v_fma_f32 v63, v63, s31, v13
    v_fma_f32 v64, v64, s31, v14
    v_mfma_f32_16x16x32_bf16 v[56:59], a[228:231], a[68:71], v[56:59]
    v_exp_f32 v63, v63
    v_exp_f32 v64, v64
    v_mfma_f32_16x16x32_bf16 v[56:59], a[232:235], a[72:75], v[56:59]
    v_cvt_pk_bf16_f32 v141, v62, v63
    v_fma_f32 v65, v65, s31, v14
    v_mfma_f32_16x16x32_bf16 v[56:59], a[236:239], a[76:79], v[56:59]
    buffer_load_dwordx4 v2, s[16:19], s61 offen offset:1024 nt lds
    v_mfma_f32_16x16x32_bf16 v[56:59], a[240:243], a[80:83], v[56:59]
    v_exp_f32 v65, v65
    v_mfma_f32_16x16x32_bf16 v[56:59], a[244:247], a[84:87], v[56:59]
    ds_read_b128 a[200:203], v5 offset:25728
    v_fma_f32 v66, v66, s31, v14
    v_mfma_f32_16x16x32_bf16 v[56:59], a[248:251], a[88:91], v[56:59]
    v_exp_f32 v66, v66
    v_mfma_f32_16x16x32_bf16 v[56:59], v[228:231], a[92:95], v[56:59]
    ds_read_b128 a[204:207], v5 offset:25792
    v_cvt_pk_bf16_f32 v148, v64, v65
    v_mfma_f32_16x16x32_bf16 v[60:63], v[228:231], a[124:127], v[252:255]
    v_fma_f32 v67, v67, s31, v14
    v_fma_f32 v68, v68, s31, v15
    v_mfma_f32_16x16x32_bf16 v[60:63], a[248:251], a[120:123], v[60:63]
    v_exp_f32 v67, v67
    v_mfma_f32_16x16x32_bf16 v[60:63], a[244:247], a[116:119], v[60:63]
    v_exp_f32 v68, v68
    v_mfma_f32_16x16x32_bf16 v[60:63], a[240:243], a[112:115], v[60:63]
    v_cvt_pk_bf16_f32 v149, v66, v67
    v_fma_f32 v69, v69, s31, v15
    v_mfma_f32_16x16x32_bf16 v[60:63], a[236:239], a[108:111], v[60:63]
    v_exp_f32 v69, v69
    v_mfma_f32_16x16x32_bf16 v[60:63], a[232:235], a[104:107], v[60:63]
    v_fma_f32 v70, v70, s31, v15
    v_cvt_pk_bf16_f32 v156, v68, v69
    v_mfma_f32_16x16x32_bf16 v[60:63], a[228:231], a[100:103], v[60:63]
    v_exp_f32 v70, v70
    v_mfma_f32_16x16x32_bf16 v[60:63], a[224:227], a[96:99], v[60:63]
    s_waitcnt lgkmcnt(4)
    ds_read_b128 a[224:227], v5 offset:33792
    v_fma_f32 v71, v71, s31, v15
    v_mfma_f32_16x16x32_bf16 v[64:67], v[236:239], a[0:3], v[252:255]
    s_add_u32 m0, s30, 135232
    v_exp_f32 v71, v71
    v_mfma_f32_16x16x32_bf16 v[64:67], v[244:247], a[4:7], v[64:67]
    ds_read_b128 a[228:231], v5 offset:33856
    v_fma_f32 v72, v72, s31, v12
    v_exp_f32 v72, v72
    v_mfma_f32_16x16x32_bf16 v[64:67], v[32:35], a[8:11], v[64:67]
    v_cvt_pk_bf16_f32 v157, v70, v71
    v_fma_f32 v73, v73, s31, v12
    v_mfma_f32_16x16x32_bf16 v[64:67], v[36:39], a[12:15], v[64:67]
    s_waitcnt lgkmcnt(2)
    buffer_load_dwordx4 v2, s[16:19], s61 offen offset:2048 nt lds
    v_mfma_f32_16x16x32_bf16 v[64:67], a[192:195], a[16:19], v[64:67]
    v_exp_f32 v73, v73
    v_mfma_f32_16x16x32_bf16 v[64:67], a[196:199], a[20:23], v[64:67]
    ds_read_b128 a[232:235], v5 offset:33920
    v_fma_f32 v74, v74, s31, v12
    v_mfma_f32_16x16x32_bf16 v[64:67], a[200:203], a[24:27], v[64:67]
    v_exp_f32 v74, v74
    v_mfma_f32_16x16x32_bf16 v[64:67], a[204:207], a[28:31], v[64:67]
    ds_read_b128 a[236:239], v5 offset:33984
    v_cvt_pk_bf16_f32 v134, v72, v73
    v_mfma_f32_16x16x32_bf16 v[68:71], a[204:207], a[60:63], v[252:255]
    v_fma_f32 v75, v75, s31, v12
    v_fma_f32 v76, v76, s31, v13
    v_mfma_f32_16x16x32_bf16 v[68:71], a[200:203], a[56:59], v[68:71]
    v_exp_f32 v75, v75
    v_mfma_f32_16x16x32_bf16 v[68:71], a[196:199], a[52:55], v[68:71]
    v_exp_f32 v76, v76
    v_mfma_f32_16x16x32_bf16 v[68:71], a[192:195], a[48:51], v[68:71]
    ds_read_b128 a[240:243], v5 offset:34048
    v_cvt_pk_bf16_f32 v135, v74, v75
    v_mfma_f32_16x16x32_bf16 v[68:71], v[36:39], a[44:47], v[68:71]
    v_fma_f32 v77, v77, s31, v13
    v_fma_f32 v78, v78, s31, v13
    v_mfma_f32_16x16x32_bf16 v[68:71], v[32:35], a[40:43], v[68:71]
    v_exp_f32 v77, v77
    v_mfma_f32_16x16x32_bf16 v[68:71], v[244:247], a[36:39], v[68:71]
    v_exp_f32 v78, v78
    v_mfma_f32_16x16x32_bf16 v[68:71], v[236:239], a[32:35], v[68:71]
    ds_read_b128 a[244:247], v5 offset:34112
    v_cvt_pk_bf16_f32 v142, v76, v77
    v_mfma_f32_16x16x32_bf16 v[72:75], v[236:239], a[64:67], v[252:255]
    s_add_u32 m0, s30, 135264
    v_fma_f32 v79, v79, s31, v13
    v_fma_f32 v40, v40, s31, v14
    v_mfma_f32_16x16x32_bf16 v[72:75], v[244:247], a[68:71], v[72:75]
    v_exp_f32 v79, v79
    v_exp_f32 v40, v40
    v_mfma_f32_16x16x32_bf16 v[72:75], v[32:35], a[72:75], v[72:75]
    v_cvt_pk_bf16_f32 v143, v78, v79
    v_fma_f32 v41, v41, s31, v14
    v_mfma_f32_16x16x32_bf16 v[72:75], v[36:39], a[76:79], v[72:75]
    buffer_load_dwordx4 v2, s[16:19], s61 offen offset:3072 nt lds
    v_mfma_f32_16x16x32_bf16 v[72:75], a[192:195], a[80:83], v[72:75]
    v_exp_f32 v41, v41
    v_mfma_f32_16x16x32_bf16 v[72:75], a[196:199], a[84:87], v[72:75]
    ds_read_b128 a[248:251], v5 offset:34176
    v_fma_f32 v42, v42, s31, v14
    v_mfma_f32_16x16x32_bf16 v[72:75], a[200:203], a[88:91], v[72:75]
    v_exp_f32 v42, v42
    v_mfma_f32_16x16x32_bf16 v[72:75], a[204:207], a[92:95], v[72:75]
    ds_read_b128 v[228:231], v5 offset:34240
    v_cvt_pk_bf16_f32 v150, v40, v41
    v_mfma_f32_16x16x32_bf16 v[76:79], a[204:207], a[124:127], v[252:255]
    v_fma_f32 v43, v43, s31, v14
    v_fma_f32 v44, v44, s31, v15
    v_mfma_f32_16x16x32_bf16 v[76:79], a[200:203], a[120:123], v[76:79]
    v_exp_f32 v43, v43
    v_mfma_f32_16x16x32_bf16 v[76:79], a[196:199], a[116:119], v[76:79]
    v_exp_f32 v44, v44
    v_mfma_f32_16x16x32_bf16 v[76:79], a[192:195], a[112:115], v[76:79]
    v_cvt_pk_bf16_f32 v151, v42, v43
    v_fma_f32 v45, v45, s31, v15
    v_mfma_f32_16x16x32_bf16 v[76:79], v[36:39], a[108:111], v[76:79]
    s_add_u32 s62, s52, 4096
    v_exp_f32 v45, v45
    v_mfma_f32_16x16x32_bf16 v[76:79], v[32:35], a[104:107], v[76:79]
    v_fma_f32 v46, v46, s31, v15
    v_cvt_pk_bf16_f32 v158, v44, v45
    v_mfma_f32_16x16x32_bf16 v[76:79], v[244:247], a[100:103], v[76:79]
L_pg4:
    s_cbranch_execz L_pg8
    v_exp_f32 v46, v46
    v_mfma_f32_16x16x32_bf16 v[76:79], v[236:239], a[96:99], v[76:79]
    s_waitcnt lgkmcnt(4)
    ds_read_b128 v[236:239], v5 offset:42240
    v_fma_f32 v47, v47, s31, v15
    v_exp_f32 v47, v47
    v_mfma_f32_16x16x32_bf16 v[40:43], a[224:227], a[0:3], v[252:255]
    buffer_load_dword v9, v248, s[16:19], s62 offen nt
    v_mfma_f32_16x16x32_bf16 v[40:43], a[228:231], a[4:7], v[40:43]
    ds_read_b128 v[244:247], v5 offset:42304
    v_fma_f32 v48, v48, s31, v12
    v_mfma_f32_16x16x32_bf16 v[40:43], a[232:235], a[8:11], v[40:43]
    s_waitcnt vmcnt(21)
    s_barrier
    v_cvt_pk_bf16_f32 v159, v46, v47
    v_mfma_f32_16x16x32_bf16 v[40:43], a[236:239], a[12:15], v[40:43]
    s_waitcnt lgkmcnt(2)
    v_exp_f32 v48, v48
    v_mfma_f32_16x16x32_bf16 v[40:43], a[240:243], a[16:19], v[40:43]
    s_add_u32 s61, s50, s98
    v_fma_f32 v49, v49, s31, v12
    v_fma_f32 v50, v50, s31, v12
    v_mfma_f32_16x16x32_bf16 v[40:43], a[244:247], a[20:23], v[40:43]
    s_add_u32 m0, s30, 0
    v_exp_f32 v49, v49
    v_exp_f32 v50, v50
    v_mfma_f32_16x16x32_bf16 v[40:43], a[248:251], a[24:27], v[40:43]
    buffer_load_dwordx4 v2, s[16:19], s61 offen offset:0 nt lds
    v_mfma_f32_16x16x32_bf16 v[40:43], v[228:231], a[28:31], v[40:43]
    ds_read_b128 v[32:35], v5 offset:42368
    v_cvt_pk_bf16_f32 v160, v48, v49
    v_mfma_f32_16x16x32_bf16 v[44:47], v[228:231], a[60:63], v[252:255]
    v_fma_f32 v51, v51, s31, v12
    v_fma_f32 v52, v52, s31, v13
    v_mfma_f32_16x16x32_bf16 v[44:47], a[248:251], a[56:59], v[44:47]
    v_exp_f32 v51, v51
    v_mfma_f32_16x16x32_bf16 v[44:47], a[244:247], a[52:55], v[44:47]
    buffer_load_dword v9, v248, s[16:19], s62 offen sc1
    v_mfma_f32_16x16x32_bf16 v[44:47], a[240:243], a[48:51], v[44:47]
    v_exp_f32 v52, v52
    v_cvt_pk_bf16_f32 v161, v50, v51
    v_mfma_f32_16x16x32_bf16 v[44:47], a[236:239], a[44:47], v[44:47]
    ds_read_b128 v[36:39], v5 offset:42432
    v_fma_f32 v53, v53, s31, v13
    v_mfma_f32_16x16x32_bf16 v[44:47], a[232:235], a[40:43], v[44:47]
    v_exp_f32 v53, v53
    v_mfma_f32_16x16x32_bf16 v[44:47], a[228:231], a[36:39], v[44:47]
    ds_read_b128 a[192:195], v5 offset:42496
    v_fma_f32 v54, v54, s31, v13
    v_mfma_f32_16x16x32_bf16 v[44:47], a[224:227], a[32:35], v[44:47]
    v_exp_f32 v54, v54
    v_smfmac_f32_16x16x64_bf16 a[208:211], a[252:255], v[128:135], v10
    v_cvt_pk_bf16_f32 v168, v52, v53
    v_mfma_f32_16x16x32_bf16 v[48:51], a[224:227], a[64:67], v[252:255]
    ds_read_b128 a[196:199], v5 offset:42560
    v_fma_f32 v55, v55, s31, v13
    v_mfma_f32_16x16x32_bf16 v[48:51], a[228:231], a[68:71], v[48:51]
    v_exp_f32 v55, v55
    v_fma_f32 v56, v56, s31, v14
    v_mfma_f32_16x16x32_bf16 v[48:51], a[232:235], a[72:75], v[48:51]
    v_exp_f32 v56, v56
    v_mfma_f32_16x16x32_bf16 v[48:51], a[236:239], a[76:79], v[48:51]
    s_add_u32 m0, s30, 32
    v_cvt_pk_bf16_f32 v169, v54, v55
    v_fma_f32 v57, v57, s31, v14
    v_mfma_f32_16x16x32_bf16 v[48:51], a[240:243], a[80:83], v[48:51]
    v_exp_f32 v57, v57
    v_mfma_f32_16x16x32_bf16 v[48:51], a[244:247], a[84:87], v[48:51]
    buffer_load_dwordx4 v2, s[16:19], s61 offen offset:1024 nt lds
    v_mfma_f32_16x16x32_bf16 v[48:51], a[248:251], a[88:91], v[48:51]
    ds_read_b128 a[200:203], v5 offset:42624
    v_fma_f32 v58, v58, s31, v14
    v_mfma_f32_16x16x32_bf16 v[48:51], v[228:231], a[92:95], v[48:51]
    v_exp_f32 v58, v58
    v_cvt_pk_bf16_f32 v176, v56, v57
    v_mfma_f32_16x16x32_bf16 v[52:55], v[228:231], a[124:127], v[252:255]
    ds_read_b128 a[204:207], v5 offset:42688
    v_fma_f32 v59, v59, s31, v14
    v_mfma_f32_16x16x32_bf16 v[52:55], a[248:251], a[120:123], v[52:55]
    v_exp_f32 v59, v59
    v_mfma_f32_16x16x32_bf16 v[52:55], a[244:247], a[116:119], v[52:55]
    v_fma_f32 v60, v60, s31, v15
    v_cvt_pk_bf16_f32 v177, v58, v59
    v_mfma_f32_16x16x32_bf16 v[52:55], a[240:243], a[112:115], v[52:55]
    v_exp_f32 v60, v60
    v_mfma_f32_16x16x32_bf16 v[52:55], a[236:239], a[108:111], v[52:55]
    v_fma_f32 v61, v61, s31, v15
    v_fma_f32 v62, v62, s31, v15
    v_mfma_f32_16x16x32_bf16 v[52:55], a[232:235], a[104:107], v[52:55]
    v_exp_f32 v61, v61
    v_mfma_f32_16x16x32_bf16 v[52:55], a[228:231], a[100:103], v[52:55]
    v_exp_f32 v62, v62
    v_mfma_f32_16x16x32_bf16 v[52:55], a[224:227], a[96:99], v[52:55]
    ds_read_b128 a[224:227], v5 offset:50688
    v_cvt_pk_bf16_f32 v184, v60, v61
    v_smfmac_f32_16x16x64_bf16 a[212:215], a[252:255], v[136:143], v10
    s_waitcnt lgkmcnt(5)
    v_fma_f32 v63, v63, s31, v15
    v_mfma_f32_16x16x32_bf16 v[56:59], v[236:239], a[0:3], v[252:255]
    v_exp_f32 v63, v63
    v_mfma_f32_16x16x32_bf16 v[56:59], v[244:247], a[4:7], v[56:59]
    ds_read_b128 a[228:231], v5 offset:50752
    v_fma_f32 v64, v64, s31, v12
    v_mfma_f32_16x16x32_bf16 v[56:59], v[32:35], a[8:11], v[56:59]
    s_add_u32 m0, s30, 64
    v_exp_f32 v64, v64
    v_mfma_f32_16x16x32_bf16 v[56:59], v[36:39], a[12:15], v[56:59]
    s_waitcnt lgkmcnt(2)
    v_cvt_pk_bf16_f32 v185, v62, v63
    v_fma_f32 v65, v65, s31, v12
    v_exp_f32 v65, v65
    v_mfma_f32_16x16x32_bf16 v[56:59], a[192:195], a[16:19], v[56:59]
    buffer_load_dwordx4 v2, s[16:19], s61 offen offset:2048 nt lds
    v_mfma_f32_16x16x32_bf16 v[56:59], a[196:199], a[20:23], v[56:59]
    ds_read_b128 a[232:235], v5 offset:50816
    v_fma_f32 v66, v66, s31, v12
    v_mfma_f32_16x16x32_bf16 v[56:59], a[200:203], a[24:27], v[56:59]
    v_exp_f32 v66, v66
    v_mfma_f32_16x16x32_bf16 v[56:59], a[204:207], a[28:31], v[56:59]
    v_cvt_pk_bf16_f32 v162, v64, v65
    v_fma_f32 v67, v67, s31, v12
    v_mfma_f32_16x16x32_bf16 v[60:63], a[204:207], a[60:63], v[252:255]
    v_exp_f32 v67, v67
    v_mfma_f32_16x16x32_bf16 v[60:63], a[200:203], a[56:59], v[60:63]
    ds_read_b128 a[236:239], v5 offset:50880
    v_fma_f32 v68, v68, s31, v13
    v_mfma_f32_16x16x32_bf16 v[60:63], a[196:199], a[52:55], v[60:63]
    v_exp_f32 v68, v68
    v_mfma_f32_16x16x32_bf16 v[60:63], a[192:195], a[48:51], v[60:63]
    v_cvt_pk_bf16_f32 v163, v66, v67
    v_fma_f32 v69, v69, s31, v13
    v_mfma_f32_16x16x32_bf16 v[60:63], v[36:39], a[44:47], v[60:63]
    v_exp_f32 v69, v69
    v_mfma_f32_16x16x32_bf16 v[60:63], v[32:35], a[40:43], v[60:63]
    ds_read_b128 a[240:243], v5 offset:50944
    v_fma_f32 v70, v70, s31, v13
    v_mfma_f32_16x16x32_bf16 v[60:63], v[244:247], a[36:39], v[60:63]
    v_exp_f32 v70, v70
    v_mfma_f32_16x16x32_bf16 v[60:63], v[236:239], a[32:35], v[60:63]
    v_cvt_pk_bf16_f32 v170, v68, v69
    v_fma_f32 v71, v71, s31, v13
    v_smfmac_f32_16x16x64_bf16 a[216:219], a[252:255], v[144:151], v10
    v_fma_f32 v72, v72, s31, v14
    v_mfma_f32_16x16x32_bf16 v[64:67], v[236:239], a[64:67], v[252:255]
    v_exp_f32 v71, v71
    v_mfma_f32_16x16x32_bf16 v[64:67], v[244:247], a[68:71], v[64:67]
    s_add_u32 m0, s30, 96
    v_exp_f32 v72, v72
    v_mfma_f32_16x16x32_bf16 v[64:67], v[32:35], a[72:75], v[64:67]
    ds_read_b128 a[244:247], v5 offset:51008
    v_cvt_pk_bf16_f32 v171, v70, v71
    v_mfma_f32_16x16x32_bf16 v[64:67], v[36:39], a[76:79], v[64:67]
    v_fma_f32 v73, v73, s31, v14
    v_fma_f32 v74, v74, s31, v14
    v_exp_f32 v73, v73
    v_mfma_f32_16x16x32_bf16 v[64:67], a[192:195], a[80:83], v[64:67]
    buffer_load_dwordx4 v2, s[16:19], s61 offen offset:3072 nt lds
    v_mfma_f32_16x16x32_bf16 v[64:67], a[196:199], a[84:87], v[64:67]
    v_exp_f32 v74, v74
    v_mfma_f32_16x16x32_bf16 v[64:67], a[200:203], a[88:91], v[64:67]
    ds_read_b128 a[248:251], v5 offset:51072
    v_cvt_pk_bf16_f32 v178, v72, v73
    v_mfma_f32_16x16x32_bf16 v[64:67], a[204:207], a[92:95], v[64:67]
    v_fma_f32 v75, v75, s31, v14
    v_fma_f32 v76, v76, s31, v15
    v_mfma_f32_16x16x32_bf16 v[68:71], a[204:207], a[124:127], v[252:255]
    v_exp_f32 v75, v75
    v_mfma_f32_16x16x32_bf16 v[68:71], a[200:203], a[120:123], v[68:71]
    v_exp_f32 v76, v76
    v_mfma_f32_16x16x32_bf16 v[68:71], a[196:199], a[116:119], v[68:71]
    ds_read_b128 v[228:231], v5 offset:51136
    v_cvt_pk_bf16_f32 v179, v74, v75
    v_mfma_f32_16x16x32_bf16 v[68:71], a[192:195], a[112:115], v[68:71]
    v_fma_f32 v77, v77, s31, v15
    v_fma_f32 v78, v78, s31, v15
    v_mfma_f32_16x16x32_bf16 v[68:71], v[36:39], a[108:111], v[68:71]
    v_exp_f32 v77, v77
    v_mfma_f32_16x16x32_bf16 v[68:71], v[32:35], a[104:107], v[68:71]
    v_exp_f32 v78, v78
    v_mfma_f32_16x16x32_bf16 v[68:71], v[244:247], a[100:103], v[68:71]
    v_cvt_pk_bf16_f32 v186, v76, v77
    v_fma_f32 v79, v79, s31, v15
    v_mfma_f32_16x16x32_bf16 v[68:71], v[236:239], a[96:99], v[68:71]
    s_add_u32 s62, s52, 8192
    ds_read_b128 v[236:239], v5 offset:59136
    v_fma_f32 v40, v40, s31, v12
    v_smfmac_f32_16x16x64_bf16 a[220:223], a[252:255], v[152:159], v10
    s_waitcnt lgkmcnt(5)
    ds_read_b128 v[244:247], v5 offset:59200
    v_mfma_f32_16x16x32_bf16 v[72:75], a[224:227], a[0:3], v[252:255]
    s_add_u32 s61, s51, s98
    v_exp_f32 v79, v79
    v_mfma_f32_16x16x32_bf16 v[72:75], a[228:231], a[4:7], v[72:75]
    s_add_u32 m0, s30, 16896
    v_exp_f32 v40, v40
    v_mfma_f32_16x16x32_bf16 v[72:75], a[232:235], a[8:11], v[72:75]
    v_cvt_pk_bf16_f32 v187, v78, v79
    v_fma_f32 v41, v41, s31, v12
    v_mfma_f32_16x16x32_bf16 v[72:75], a[236:239], a[12:15], v[72:75]
    s_waitcnt lgkmcnt(2)
    buffer_load_dwordx4 v2, s[16:19], s61 offen offset:0 nt lds
    v_mfma_f32_16x16x32_bf16 v[72:75], a[240:243], a[16:19], v[72:75]
    v_exp_f32 v41, v41
    v_mfma_f32_16x16x32_bf16 v[72:75], a[244:247], a[20:23], v[72:75]
    ds_read_b128 v[32:35], v5 offset:59264
    v_fma_f32 v42, v42, s31, v12
    v_exp_f32 v42, v42
    v_mfma_f32_16x16x32_bf16 v[72:75], a[248:251], a[24:27], v[72:75]
    v_cvt_pk_bf16_f32 v164, v40, v41
    v_fma_f32 v43, v43, s31, v12
    v_mfma_f32_16x16x32_bf16 v[72:75], v[228:231], a[28:31], v[72:75]
    buffer_load_dword v9, v248, s[16:19], s62 offen nt
    v_mfma_f32_16x16x32_bf16 v[76:79], v[228:231], a[60:63], v[252:255]
    v_exp_f32 v43, v43
    v_mfma_f32_16x16x32_bf16 v[76:79], a[248:251], a[56:59], v[76:79]
    ds_read_b128 v[36:39], v5 offset:59328
    v_fma_f32 v44, v44, s31, v13
    v_exp_f32 v44, v44
    v_mfma_f32_16x16x32_bf16 v[76:79], a[244:247], a[52:55], v[76:79]
    v_cvt_pk_bf16_f32 v165, v42, v43
    v_fma_f32 v45, v45, s31, v13
    v_mfma_f32_16x16x32_bf16 v[76:79], a[240:243], a[48:51], v[76:79]
    buffer_load_dword v9, v248, s[16:19], s62 offen sc1
    v_mfma_f32_16x16x32_bf16 v[76:79], a[236:239], a[44:47], v[76:79]
    v_exp_f32 v45, v45
    v_mfma_f32_16x16x32_bf16 v[76:79], a[232:235], a[40:43], v[76:79]
    ds_read_b128 a[192:195], v5 offset:59392
    v_fma_f32 v46, v46, s31, v13
    v_mfma_f32_16x16x32_bf16 v[76:79], a[228:231], a[36:39], v[76:79]
    v_exp_f32 v46, v46
    v_mfma_f32_16x16x32_bf16 v[76:79], a[224:227], a[32:35], v[76:79]
    ds_read_b128 a[196:199], v5 offset:59456
    v_cvt_pk_bf16_f32 v172, v44, v45
    v_mfma_f32_16x16x32_bf16 v[40:43], a[224:227], a[64:67], v[252:255]
    s_add_u32 m0, s30, 16928
    v_fma_f32 v47, v47, s31, v13
    v_fma_f32 v48, v48, s31, v14
    v_mfma_f32_16x16x32_bf16 v[40:43], a[228:231], a[68:71], v[40:43]
    v_exp_f32 v47, v47
    v_exp_f32 v48, v48
    v_mfma_f32_16x16x32_bf16 v[40:43], a[232:235], a[72:75], v[40:43]
    v_cvt_pk_bf16_f32 v173, v46, v47
    v_fma_f32 v49, v49, s31, v14
    v_mfma_f32_16x16x32_bf16 v[40:43], a[236:239], a[76:79], v[40:43]
    buffer_load_dwordx4 v2, s[16:19], s61 offen offset:1024 nt lds
    v_mfma_f32_16x16x32_bf16 v[40:43], a[240:243], a[80:83], v[40:43]
    v_exp_f32 v49, v49
    v_mfma_f32_16x16x32_bf16 v[40:43], a[244:247], a[84:87], v[40:43]
    ds_read_b128 a[200:203], v5 offset:59520
    v_fma_f32 v50, v50, s31, v14
    v_mfma_f32_16x16x32_bf16 v[40:43], a[248:251], a[88:91], v[40:43]
    v_exp_f32 v50, v50
    v_mfma_f32_16x16x32_bf16 v[40:43], v[228:231], a[92:95], v[40:43]
    ds_read_b128 a[204:207], v5 offset:59584
    v_cvt_pk_bf16_f32 v180, v48, v49
    v_mfma_f32_16x16x32_bf16 v[44:47], v[228:231], a[124:127], v[252:255]
    v_fma_f32 v51, v51, s31, v14
    v_fma_f32 v52, v52, s31, v15
    v_mfma_f32_16x16x32_bf16 v[44:47], a[248:251], a[120:123], v[44:47]
    v_exp_f32 v51, v51
    v_mfma_f32_16x16x32_bf16 v[44:47], a[244:247], a[116:119], v[44:47]
    v_exp_f32 v52, v52
    v_mfma_f32_16x16x32_bf16 v[44:47], a[240:243], a[112:115], v[44:47]
    v_cvt_pk_bf16_f32 v181, v50, v51
    v_fma_f32 v53, v53, s31, v15
    v_mfma_f32_16x16x32_bf16 v[44:47], a[236:239], a[108:111], v[44:47]
    v_exp_f32 v53, v53
    v_mfma_f32_16x16x32_bf16 v[44:47], a[232:235], a[104:107], v[44:47]
    v_fma_f32 v54, v54, s31, v15
    v_cvt_pk_bf16_f32 v188, v52, v53
    v_mfma_f32_16x16x32_bf16 v[44:47], a[228:231], a[100:103], v[44:47]
    v_exp_f32 v54, v54
    v_mfma_f32_16x16x32_bf16 v[44:47], a[224:227], a[96:99], v[44:47]
    s_waitcnt lgkmcnt(4)
    ds_read_b128 a[224:227], v6 offset:0
    v_fma_f32 v55, v55, s31, v15
    v_mfma_f32_16x16x32_bf16 v[48:51], v[236:239], a[0:3], v[252:255]
    s_add_u32 m0, s30, 16960
    v_exp_f32 v55, v55
    v_mfma_f32_16x16x32_bf16 v[48:51], v[244:247], a[4:7], v[48:51]
    ds_read_b128 a[228:231], v6 offset:64
    v_fma_f32 v56, v56, s31, v12
    v_exp_f32 v56, v56
    v_mfma_f32_16x16x32_bf16 v[48:51], v[32:35], a[8:11], v[48:51]
    v_cvt_pk_bf16_f32 v189, v54, v55
    v_fma_f32 v57, v57, s31, v12
    v_mfma_f32_16x16x32_bf16 v[48:51], v[36:39], a[12:15], v[48:51]
    s_waitcnt lgkmcnt(2)
    buffer_load_dwordx4 v2, s[16:19], s61 offen offset:2048 nt lds
    v_mfma_f32_16x16x32_bf16 v[48:51], a[192:195], a[16:19], v[48:51]
    v_exp_f32 v57, v57
    v_mfma_f32_16x16x32_bf16 v[48:51], a[196:199], a[20:23], v[48:51]
    ds_read_b128 a[232:235], v6 offset:128
    v_fma_f32 v58, v58, s31, v12
    v_mfma_f32_16x16x32_bf16 v[48:51], a[200:203], a[24:27], v[48:51]
    v_exp_f32 v58, v58
    v_mfma_f32_16x16x32_bf16 v[48:51], a[204:207], a[28:31], v[48:51]
    ds_read_b128 a[236:239], v6 offset:192
    v_cvt_pk_bf16_f32 v166, v56, v57
    v_mfma_f32_16x16x32_bf16 v[52:55], a[204:207], a[60:63], v[252:255]
    v_fma_f32 v59, v59, s31, v12
    v_fma_f32 v60, v60, s31, v13
    v_mfma_f32_16x16x32_bf16 v[52:55], a[200:203], a[56:59], v[52:55]
    v_exp_f32 v59, v59
    v_mfma_f32_16x16x32_bf16 v[52:55], a[196:199], a[52:55], v[52:55]
    v_exp_f32 v60, v60
    v_mfma_f32_16x16x32_bf16 v[52:55], a[192:195], a[48:51], v[52:55]
    ds_read_b128 a[240:243], v6 offset:256
    v_cvt_pk_bf16_f32 v167, v58, v59
    v_mfma_f32_16x16x32_bf16 v[52:55], v[36:39], a[44:47], v[52:55]
    v_fma_f32 v61, v61, s31, v13
    v_fma_f32 v62, v62, s31, v13
    v_mfma_f32_16x16x32_bf16 v[52:55], v[32:35], a[40:43], v[52:55]
    v_exp_f32 v61, v61
    v_mfma_f32_16x16x32_bf16 v[52:55], v[244:247], a[36:39], v[52:55]
    v_exp_f32 v62, v62
    v_mfma_f32_16x16x32_bf16 v[52:55], v[236:239], a[32:35], v[52:55]
    ds_read_b128 a[244:247], v6 offset:320
    v_cvt_pk_bf16_f32 v174, v60, v61
    v_mfma_f32_16x16x32_bf16 v[56:59], v[236:239], a[64:67], v[252:255]
    s_add_u32 m0, s30, 16992
    v_fma_f32 v63, v63, s31, v13
    v_fma_f32 v64, v64, s31, v14
    v_mfma_f32_16x16x32_bf16 v[56:59], v[244:247], a[68:71], v[56:59]
    v_exp_f32 v63, v63
    v_exp_f32 v64, v64
    v_mfma_f32_16x16x32_bf16 v[56:59], v[32:35], a[72:75], v[56:59]
    v_cvt_pk_bf16_f32 v175, v62, v63
    v_fma_f32 v65, v65, s31, v14
    v_mfma_f32_16x16x32_bf16 v[56:59], v[36:39], a[76:79], v[56:59]
    buffer_load_dwordx4 v2, s[16:19], s61 offen offset:3072 nt lds
    v_mfma_f32_16x16x32_bf16 v[56:59], a[192:195], a[80:83], v[56:59]
    v_exp_f32 v65, v65
    v_mfma_f32_16x16x32_bf16 v[56:59], a[196:199], a[84:87], v[56:59]
    ds_read_b128 a[248:251], v6 offset:384
    v_fma_f32 v66, v66, s31, v14
    v_mfma_f32_16x16x32_bf16 v[56:59], a[200:203], a[88:91], v[56:59]
    v_exp_f32 v66, v66
    v_mfma_f32_16x16x32_bf16 v[56:59], a[204:207], a[92:95], v[56:59]
    ds_read_b128 v[228:231], v6 offset:448
    v_cvt_pk_bf16_f32 v182, v64, v65
    v_mfma_f32_16x16x32_bf16 v[60:63], a[204:207], a[124:127], v[252:255]
    v_fma_f32 v67, v67, s31, v14
    v_fma_f32 v68, v68, s31, v15
    v_mfma_f32_16x16x32_bf16 v[60:63], a[200:203], a[120:123], v[60:63]
    v_exp_f32 v67, v67
    v_mfma_f32_16x16x32_bf16 v[60:63], a[196:199], a[116:119], v[60:63]
    v_exp_f32 v68, v68
    v_mfma_f32_16x16x32_bf16 v[60:63], a[192:195], a[112:115], v[60:63]
    v_cvt_pk_bf16_f32 v183, v66, v67
    v_fma_f32 v69, v69, s31, v15
    v_mfma_f32_16x16x32_bf16 v[60:63], v[36:39], a[108:111], v[60:63]
    v_exp_f32 v69, v69
    v_mfma_f32_16x16x32_bf16 v[60:63], v[32:35], a[104:107], v[60:63]
    v_fma_f32 v70, v70, s31, v15
    v_cvt_pk_bf16_f32 v190, v68, v69
    v_mfma_f32_16x16x32_bf16 v[60:63], v[244:247], a[100:103], v[60:63]
    v_exp_f32 v70, v70
    v_mfma_f32_16x16x32_bf16 v[60:63], v[236:239], a[96:99], v[60:63]
    s_waitcnt lgkmcnt(4)
    ds_read_b128 v[236:239], v6 offset:8448
    v_fma_f32 v71, v71, s31, v15
    v_mfma_f32_16x16x32_bf16 v[64:67], a[224:227], a[0:3], v[252:255]
    v_exp_f32 v71, v71
    v_mfma_f32_16x16x32_bf16 v[64:67], a[228:231], a[4:7], v[64:67]
    ds_read_b128 v[244:247], v6 offset:8512
    v_fma_f32 v72, v72, s31, v12
    v_mfma_f32_16x16x32_bf16 v[64:67], a[232:235], a[8:11], v[64:67]
    s_waitcnt vmcnt(23)
    s_barrier
    v_cvt_pk_bf16_f32 v191, v70, v71
    v_mfma_f32_16x16x32_bf16 v[64:67], a[236:239], a[12:15], v[64:67]
    s_waitcnt lgkmcnt(2)
    v_exp_f32 v72, v72
    v_mfma_f32_16x16x32_bf16 v[64:67], a[240:243], a[16:19], v[64:67]
    s_add_u32 s61, s48, s99
    v_fma_f32 v73, v73, s31, v12
    v_fma_f32 v74, v74, s31, v12
    v_mfma_f32_16x16x32_bf16 v[64:67], a[244:247], a[20:23], v[64:67]
    s_add_u32 m0, s30, 33792
    v_exp_f32 v73, v73
    v_exp_f32 v74, v74
    v_mfma_f32_16x16x32_bf16 v[64:67], a[248:251], a[24:27], v[64:67]
    s_add_u32 s62, s52, 12288
    buffer_load_dwordx4 v2, s[16:19], s61 offen offset:0 nt lds
    v_mfma_f32_16x16x32_bf16 v[64:67], v[228:231], a[28:31], v[64:67]
    ds_read_b128 v[32:35], v6 offset:8576
    v_cvt_pk_bf16_f32 v192, v72, v73
    v_mfma_f32_16x16x32_bf16 v[68:71], v[228:231], a[60:63], v[252:255]
    v_fma_f32 v75, v75, s31, v12
    v_fma_f32 v76, v76, s31, v13
    v_mfma_f32_16x16x32_bf16 v[68:71], a[248:251], a[56:59], v[68:71]
    v_exp_f32 v75, v75
    v_mfma_f32_16x16x32_bf16 v[68:71], a[244:247], a[52:55], v[68:71]
    buffer_load_dword v9, v248, s[16:19], s62 offen nt
    v_mfma_f32_16x16x32_bf16 v[68:71], a[240:243], a[48:51], v[68:71]
    v_exp_f32 v76, v76
    v_cvt_pk_bf16_f32 v193, v74, v75
    v_mfma_f32_16x16x32_bf16 v[68:71], a[236:239], a[44:47], v[68:71]
    ds_read_b128 v[36:39], v6 offset:8640
    v_fma_f32 v77, v77, s31, v13
    v_mfma_f32_16x16x32_bf16 v[68:71], a[232:235], a[40:43], v[68:71]
    v_exp_f32 v77, v77
    v_mfma_f32_16x16x32_bf16 v[68:71], a[228:231], a[36:39], v[68:71]
    s_add_u32 m0, s30, 33824
    ds_read_b128 a[192:195], v6 offset:8704
    v_fma_f32 v78, v78, s31, v13
    v_mfma_f32_16x16x32_bf16 v[68:71], a[224:227], a[32:35], v[68:71]
    v_exp_f32 v78, v78
    v_cvt_pk_bf16_f32 v200, v76, v77
    v_smfmac_f32_16x16x64_bf16 a[208:211], a[252:255], v[160:167], v10
    v_fma_f32 v79, v79, s31, v13
    v_exp_f32 v79, v79
    v_mfma_f32_16x16x32_bf16 v[72:75], a[224:227], a[64:67], v[252:255]
    buffer_load_dwordx4 v2, s[16:19], s61 offen offset:1024 nt lds
    v_mfma_f32_16x16x32_bf16 v[72:75], a[228:231], a[68:71], v[72:75]
    ds_read_b128 a[196:199], v6 offset:8768
    v_fma_f32 v40, v40, s31, v14
    v_mfma_f32_16x16x32_bf16 v[72:75], a[232:235], a[72:75], v[72:75]
    v_exp_f32 v40, v40
    v_cvt_pk_bf16_f32 v201, v78, v79
    v_mfma_f32_16x16x32_bf16 v[72:75], a[236:239], a[76:79], v[72:75]
    v_fma_f32 v41, v41, s31, v14
    v_fma_f32 v42, v42, s31, v14
    v_exp_f32 v41, v41
    v_mfma_f32_16x16x32_bf16 v[72:75], a[240:243], a[80:83], v[72:75]
    buffer_load_dword v9, v248, s[16:19], s62 offen sc1
    v_mfma_f32_16x16x32_bf16 v[72:75], a[244:247], a[84:87], v[72:75]
    v_exp_f32 v42, v42
    v_mfma_f32_16x16x32_bf16 v[72:75], a[248:251], a[88:91], v[72:75]
    ds_read_b128 a[200:203], v6 offset:8832
    v_cvt_pk_bf16_f32 v208, v40, v41
    v_mfma_f32_16x16x32_bf16 v[72:75], v[228:231], a[92:95], v[72:75]
    s_add_u32 m0, s30, 33856
    v_fma_f32 v43, v43, s31, v14
    v_fma_f32 v44, v44, s31, v15
    v_mfma_f32_16x16x32_bf16 v[76:79], v[228:231], a[124:127], v[252:255]
    v_exp_f32 v43, v43
    v_mfma_f32_16x16x32_bf16 v[76:79], a[248:251], a[120:123], v[76:79]
    buffer_load_dwordx4 v2, s[16:19], s61 offen offset:2048 nt lds
    v_mfma_f32_16x16x32_bf16 v[76:79], a[244:247], a[116:119], v[76:79]
    v_exp_f32 v44, v44
    v_mfma_f32_16x16x32_bf16 v[76:79], a[240:243], a[112:115], v[76:79]
    ds_read_b128 a[204:207], v6 offset:8896
    v_cvt_pk_bf16_f32 v209, v42, v43
    v_mfma_f32_16x16x32_bf16 v[76:79], a[236:239], a[108:111], v[76:79]
    v_fma_f32 v45, v45, s31, v15
    v_fma_f32 v46, v46, s31, v15
    v_mfma_f32_16x16x32_bf16 v[76:79], a[232:235], a[104:107], v[76:79]
    v_exp_f32 v45, v45
    v_mfma_f32_16x16x32_bf16 v[76:79], a[228:231], a[100:103], v[76:79]
    v_exp_f32 v46, v46
    v_mfma_f32_16x16x32_bf16 v[76:79], a[224:227], a[96:99], v[76:79]
    ds_read_b128 a[224:227], v6 offset:16896
    v_cvt_pk_bf16_f32 v216, v44, v45
    v_smfmac_f32_16x16x64_bf16 a[212:215], a[252:255], v[168:175], v10
    s_waitcnt lgkmcnt(5)
    v_fma_f32 v47, v47, s31, v15
    v_mfma_f32_16x16x32_bf16 v[40:43], v[236:239], a[0:3], v[252:255]
    s_add_u32 m0, s30, 33888
    v_exp_f32 v47, v47
    v_mfma_f32_16x16x32_bf16 v[40:43], v[244:247], a[4:7], v[40:43]
    ds_read_b128 a[228:231], v6 offset:16960
    v_fma_f32 v48, v48, s31, v12
    v_exp_f32 v48, v48
    v_mfma_f32_16x16x32_bf16 v[40:43], v[32:35], a[8:11], v[40:43]
    v_cvt_pk_bf16_f32 v217, v46, v47
    v_fma_f32 v49, v49, s31, v12
    v_mfma_f32_16x16x32_bf16 v[40:43], v[36:39], a[12:15], v[40:43]
    s_waitcnt lgkmcnt(2)
    buffer_load_dwordx4 v2, s[16:19], s61 offen offset:3072 nt lds
    v_mfma_f32_16x16x32_bf16 v[40:43], a[192:195], a[16:19], v[40:43]
    v_exp_f32 v49, v49
    v_mfma_f32_16x16x32_bf16 v[40:43], a[196:199], a[20:23], v[40:43]
    ds_read_b128 a[232:235], v6 offset:17024
    v_fma_f32 v50, v50, s31, v12
    v_mfma_f32_16x16x32_bf16 v[40:43], a[200:203], a[24:27], v[40:43]
    v_exp_f32 v50, v50
    v_mfma_f32_16x16x32_bf16 v[40:43], a[204:207], a[28:31], v[40:43]
    v_cvt_pk_bf16_f32 v194, v48, v49
    v_fma_f32 v51, v51, s31, v12
    v_mfma_f32_16x16x32_bf16 v[44:47], a[204:207], a[60:63], v[252:255]
    v_exp_f32 v51, v51
    v_mfma_f32_16x16x32_bf16 v[44:47], a[200:203], a[56:59], v[44:47]
    s_add_u32 s61, s49, s99
    ds_read_b128 a[236:239], v6 offset:17088
    v_fma_f32 v52, v52, s31, v13
    v_mfma_f32_16x16x32_bf16 v[44:47], a[196:199], a[52:55], v[44:47]
    s_add_u32 m0, s30, 50688
    v_exp_f32 v52, v52
    v_mfma_f32_16x16x32_bf16 v[44:47], a[192:195], a[48:51], v[44:47]
    v_cvt_pk_bf16_f32 v195, v50, v51
    v_fma_f32 v53, v53, s31, v13
    v_exp_f32 v53, v53
    v_mfma_f32_16x16x32_bf16 v[44:47], v[36:39], a[44:47], v[44:47]
    buffer_load_dwordx4 v2, s[16:19], s61 offen offset:0 nt lds
    v_mfma_f32_16x16x32_bf16 v[44:47], v[32:35], a[40:43], v[44:47]
    ds_read_b128 a[240:243], v6 offset:17152
    v_fma_f32 v54, v54, s31, v13
    v_mfma_f32_16x16x32_bf16 v[44:47], v[244:247], a[36:39], v[44:47]
    v_exp_f32 v54, v54
    v_mfma_f32_16x16x32_bf16 v[44:47], v[236:239], a[32:35], v[44:47]
    v_cvt_pk_bf16_f32 v202, v52, v53
    v_fma_f32 v55, v55, s31, v13
    v_smfmac_f32_16x16x64_bf16 a[216:219], a[252:255], v[176:183], v10
    v_fma_f32 v56, v56, s31, v14
    v_mfma_f32_16x16x32_bf16 v[48:51], v[236:239], a[64:67], v[252:255]
    v_exp_f32 v55, v55
    v_mfma_f32_16x16x32_bf16 v[48:51], v[244:247], a[68:71], v[48:51]
    v_exp_f32 v56, v56
    v_mfma_f32_16x16x32_bf16 v[48:51], v[32:35], a[72:75], v[48:51]
    ds_read_b128 a[244:247], v6 offset:17216
    v_cvt_pk_bf16_f32 v203, v54, v55
    v_mfma_f32_16x16x32_bf16 v[48:51], v[36:39], a[76:79], v[48:51]
    s_add_u32 m0, s30, 50720
    v_fma_f32 v57, v57, s31, v14
    v_fma_f32 v58, v58, s31, v14
    v_mfma_f32_16x16x32_bf16 v[48:51], a[192:195], a[80:83], v[48:51]
    v_exp_f32 v57, v57
    v_mfma_f32_16x16x32_bf16 v[48:51], a[196:199], a[84:87], v[48:51]
    buffer_load_dwordx4 v2, s[16:19], s61 offen offset:1024 nt lds
    v_mfma_f32_16x16x32_bf16 v[48:51], a[200:203], a[88:91], v[48:51]
    v_exp_f32 v58, v58
    v_mfma_f32_16x16x32_bf16 v[48:51], a[204:207], a[92:95], v[48:51]
    ds_read_b128 a[248:251], v6 offset:17280
    v_cvt_pk_bf16_f32 v210, v56, v57
    v_mfma_f32_16x16x32_bf16 v[52:55], a[204:207], a[124:127], v[252:255]
    ds_read_b128 v[228:231], v6 offset:17344
    v_fma_f32 v59, v59, s31, v14
    v_mfma_f32_16x16x32_bf16 v[52:55], a[200:203], a[120:123], v[52:55]
    v_exp_f32 v59, v59
    v_mfma_f32_16x16x32_bf16 v[52:55], a[196:199], a[116:119], v[52:55]
    v_fma_f32 v60, v60, s31, v15
    v_cvt_pk_bf16_f32 v211, v58, v59
    v_mfma_f32_16x16x32_bf16 v[52:55], a[192:195], a[112:115], v[52:55]
    v_exp_f32 v60, v60
    v_mfma_f32_16x16x32_bf16 v[52:55], v[36:39], a[108:111], v[52:55]
    v_fma_f32 v61, v61, s31, v15
    v_fma_f32 v62, v62, s31, v15
    v_mfma_f32_16x16x32_bf16 v[52:55], v[32:35], a[104:107], v[52:55]
    s_add_u32 m0, s30, 50752
    v_exp_f32 v61, v61
    v_mfma_f32_16x16x32_bf16 v[52:55], v[244:247], a[100:103], v[52:55]
    v_exp_f32 v62, v62
    v_mfma_f32_16x16x32_bf16 v[52:55], v[236:239], a[96:99], v[52:55]
    ds_read_b128 v[236:239], v6 offset:25344
    v_cvt_pk_bf16_f32 v218, v60, v61
    v_smfmac_f32_16x16x64_bf16 a[220:223], a[252:255], v[184:191], v10
    s_waitcnt lgkmcnt(5)
    ds_read_b128 v[244:247], v6 offset:25408
    buffer_load_dwordx4 v2, s[16:19], s61 offen offset:2048 nt lds
    v_mfma_f32_16x16x32_bf16 v[56:59], a[224:227], a[0:3], v[252:255]
    v_fma_f32 v63, v63, s31, v15
    v_fma_f32 v64, v64, s31, v12
    v_mfma_f32_16x16x32_bf16 v[56:59], a[228:231], a[4:7], v[56:59]
    v_exp_f32 v63, v63
    v_mfma_f32_16x16x32_bf16 v[56:59], a[232:235], a[8:11], v[56:59]
    v_exp_f32 v64, v64
    v_mfma_f32_16x16x32_bf16 v[56:59], a[236:239], a[12:15], v[56:59]
    s_waitcnt lgkmcnt(2)
    ds_read_b128 v[32:35], v6 offset:25472
    v_cvt_pk_bf16_f32 v219, v62, v63
    v_mfma_f32_16x16x32_bf16 v[56:59], a[240:243], a[16:19], v[56:59]
    v_fma_f32 v65, v65, s31, v12
    v_fma_f32 v66, v66, s31, v12
    v_mfma_f32_16x16x32_bf16 v[56:59], a[244:247], a[20:23], v[56:59]
    v_exp_f32 v65, v65
    v_mfma_f32_16x16x32_bf16 v[56:59], a[248:251], a[24:27], v[56:59]
    s_add_u32 m0, s30, 50784
    v_exp_f32 v66, v66
    v_mfma_f32_16x16x32_bf16 v[56:59], v[228:231], a[28:31], v[56:59]
    ds_read_b128 v[36:39], v6 offset:25536
    v_cvt_pk_bf16_f32 v196, v64, v65
    v_fma_f32 v67, v67, s31, v12
    v_exp_f32 v67, v67
    v_mfma_f32_16x16x32_bf16 v[60:63], v[228:231], a[60:63], v[252:255]
L_pg5:
    s_cbranch_execz L_pg9
    buffer_load_dwordx4 v2, s[16:19], s61 offen offset:3072 nt lds
    v_mfma_f32_16x16x32_bf16 v[60:63], a[248:251], a[56:59], v[60:63]
    v_fma_f32 v68, v68, s31, v13
    v_cvt_pk_bf16_f32 v197, v66, v67
    v_mfma_f32_16x16x32_bf16 v[60:63], a[244:247], a[52:55], v[60:63]
    v_exp_f32 v68, v68
    v_mfma_f32_16x16x32_bf16 v[60:63], a[240:243], a[48:51], v[60:63]
    ds_read_b128 a[192:195], v6 offset:25600
    v_fma_f32 v69, v69, s31, v13
    v_mfma_f32_16x16x32_bf16 v[60:63], a[236:239], a[44:47], v[60:63]
    v_exp_f32 v69, v69
    v_mfma_f32_16x16x32_bf16 v[60:63], a[232:235], a[40:43], v[60:63]
    v_fma_f32 v70, v70, s31, v13
    v_cvt_pk_bf16_f32 v204, v68, v69
    v_mfma_f32_16x16x32_bf16 v[60:63], a[228:231], a[36:39], v[60:63]
    v_exp_f32 v70, v70
    v_mfma_f32_16x16x32_bf16 v[60:63], a[224:227], a[32:35], v[60:63]
    ds_read_b128 a[196:199], v6 offset:25664
    v_fma_f32 v71, v71, s31, v13
    v_mfma_f32_16x16x32_bf16 v[64:67], a[224:227], a[64:67], v[252:255]
    v_exp_f32 v71, v71
    v_mfma_f32_16x16x32_bf16 v[64:67], a[228:231], a[68:71], v[64:67]
    v_fma_f32 v72, v72, s31, v14
    v_cvt_pk_bf16_f32 v205, v70, v71
    v_mfma_f32_16x16x32_bf16 v[64:67], a[232:235], a[72:75], v[64:67]
    v_exp_f32 v72, v72
    v_mfma_f32_16x16x32_bf16 v[64:67], a[236:239], a[76:79], v[64:67]
    ds_read_b128 a[200:203], v6 offset:25728
    v_fma_f32 v73, v73, s31, v14
    v_mfma_f32_16x16x32_bf16 v[64:67], a[240:243], a[80:83], v[64:67]
    v_exp_f32 v73, v73
    v_mfma_f32_16x16x32_bf16 v[64:67], a[244:247], a[84:87], v[64:67]
    v_fma_f32 v74, v74, s31, v14
    v_cvt_pk_bf16_f32 v212, v72, v73
    v_mfma_f32_16x16x32_bf16 v[64:67], a[248:251], a[88:91], v[64:67]
    v_exp_f32 v74, v74
    v_mfma_f32_16x16x32_bf16 v[64:67], v[228:231], a[92:95], v[64:67]
    ds_read_b128 a[204:207], v6 offset:25792
    v_fma_f32 v75, v75, s31, v14
    v_mfma_f32_16x16x32_bf16 v[68:71], v[228:231], a[124:127], v[252:255]
    v_exp_f32 v75, v75
    v_mfma_f32_16x16x32_bf16 v[68:71], a[248:251], a[120:123], v[68:71]
    v_fma_f32 v76, v76, s31, v15
    v_cvt_pk_bf16_f32 v213, v74, v75
    v_mfma_f32_16x16x32_bf16 v[68:71], a[244:247], a[116:119], v[68:71]
    v_exp_f32 v76, v76
    v_mfma_f32_16x16x32_bf16 v[68:71], a[240:243], a[112:115], v[68:71]
    v_fma_f32 v77, v77, s31, v15
    v_fma_f32 v78, v78, s31, v15
    v_mfma_f32_16x16x32_bf16 v[68:71], a[236:239], a[108:111], v[68:71]
    v_exp_f32 v77, v77
    v_mfma_f32_16x16x32_bf16 v[68:71], a[232:235], a[104:107], v[68:71]
    v_exp_f32 v78, v78
    v_mfma_f32_16x16x32_bf16 v[68:71], a[228:231], a[100:103], v[68:71]
    v_cvt_pk_bf16_f32 v220, v76, v77
    v_fma_f32 v79, v79, s31, v15
    v_mfma_f32_16x16x32_bf16 v[68:71], a[224:227], a[96:99], v[68:71]
    s_waitcnt lgkmcnt(4)
    ds_read_b128 a[224:227], v6 offset:33792
    v_fma_f32 v40, v40, s31, v12
    v_mfma_f32_16x16x32_bf16 v[72:75], v[236:239], a[0:3], v[252:255]
    v_exp_f32 v79, v79
    v_mfma_f32_16x16x32_bf16 v[72:75], v[244:247], a[4:7], v[72:75]
    v_exp_f32 v40, v40
    v_mfma_f32_16x16x32_bf16 v[72:75], v[32:35], a[8:11], v[72:75]
    ds_read_b128 a[228:231], v6 offset:33856
    v_cvt_pk_bf16_f32 v221, v78, v79
    v_mfma_f32_16x16x32_bf16 v[72:75], v[36:39], a[12:15], v[72:75]
    s_waitcnt lgkmcnt(2)
    ds_read_b128 a[232:235], v6 offset:33920
    v_fma_f32 v41, v41, s31, v12
    v_mfma_f32_16x16x32_bf16 v[72:75], a[192:195], a[16:19], v[72:75]
    v_exp_f32 v41, v41
    v_mfma_f32_16x16x32_bf16 v[72:75], a[196:199], a[20:23], v[72:75]
    v_fma_f32 v42, v42, s31, v12
    v_cvt_pk_bf16_f32 v198, v40, v41
    v_mfma_f32_16x16x32_bf16 v[72:75], a[200:203], a[24:27], v[72:75]
    v_exp_f32 v42, v42
    v_mfma_f32_16x16x32_bf16 v[72:75], a[204:207], a[28:31], v[72:75]
    ds_read_b128 a[236:239], v6 offset:33984
    v_fma_f32 v43, v43, s31, v12
    v_mfma_f32_16x16x32_bf16 v[76:79], a[204:207], a[60:63], v[252:255]
    v_exp_f32 v43, v43
    v_mfma_f32_16x16x32_bf16 v[76:79], a[200:203], a[56:59], v[76:79]
    v_fma_f32 v44, v44, s31, v13
    v_cvt_pk_bf16_f32 v199, v42, v43
    v_mfma_f32_16x16x32_bf16 v[76:79], a[196:199], a[52:55], v[76:79]
    v_exp_f32 v44, v44
    v_mfma_f32_16x16x32_bf16 v[76:79], a[192:195], a[48:51], v[76:79]
    ds_read_b128 a[240:243], v6 offset:34048
    v_fma_f32 v45, v45, s31, v13
    v_mfma_f32_16x16x32_bf16 v[76:79], v[36:39], a[44:47], v[76:79]
    v_exp_f32 v45, v45
    v_mfma_f32_16x16x32_bf16 v[76:79], v[32:35], a[40:43], v[76:79]
    v_fma_f32 v46, v46, s31, v13
    v_cvt_pk_bf16_f32 v206, v44, v45
    v_mfma_f32_16x16x32_bf16 v[76:79], v[244:247], a[36:39], v[76:79]
    v_exp_f32 v46, v46
    v_mfma_f32_16x16x32_bf16 v[76:79], v[236:239], a[32:35], v[76:79]
    ds_read_b128 a[244:247], v6 offset:34112
    v_fma_f32 v47, v47, s31, v13
    v_mfma_f32_16x16x32_bf16 v[40:43], v[236:239], a[64:67], v[252:255]
    v_exp_f32 v47, v47
    v_mfma_f32_16x16x32_bf16 v[40:43], v[244:247], a[68:71], v[40:43]
    v_fma_f32 v48, v48, s31, v14
    v_cvt_pk_bf16_f32 v207, v46, v47
    v_mfma_f32_16x16x32_bf16 v[40:43], v[32:35], a[72:75], v[40:43]
    v_exp_f32 v48, v48
    v_mfma_f32_16x16x32_bf16 v[40:43], v[36:39], a[76:79], v[40:43]
    ds_read_b128 a[248:251], v6 offset:34176
    v_fma_f32 v49, v49, s31, v14
    v_mfma_f32_16x16x32_bf16 v[40:43], a[192:195], a[80:83], v[40:43]
    v_exp_f32 v49, v49
    v_mfma_f32_16x16x32_bf16 v[40:43], a[196:199], a[84:87], v[40:43]
    v_fma_f32 v50, v50, s31, v14
    v_cvt_pk_bf16_f32 v214, v48, v49
    v_mfma_f32_16x16x32_bf16 v[40:43], a[200:203], a[88:91], v[40:43]
    v_exp_f32 v50, v50
    v_mfma_f32_16x16x32_bf16 v[40:43], a[204:207], a[92:95], v[40:43]
    ds_read_b128 v[228:231], v6 offset:34240
    v_fma_f32 v51, v51, s31, v14
    v_mfma_f32_16x16x32_bf16 v[44:47], a[204:207], a[124:127], v[252:255]
    v_exp_f32 v51, v51
    v_mfma_f32_16x16x32_bf16 v[44:47], a[200:203], a[120:123], v[44:47]
    v_fma_f32 v52, v52, s31, v15
    v_cvt_pk_bf16_f32 v215, v50, v51
    v_mfma_f32_16x16x32_bf16 v[44:47], a[196:199], a[116:119], v[44:47]
    v_exp_f32 v52, v52
    v_mfma_f32_16x16x32_bf16 v[44:47], a[192:195], a[112:115], v[44:47]
    v_fma_f32 v53, v53, s31, v15
    v_fma_f32 v54, v54, s31, v15
    v_mfma_f32_16x16x32_bf16 v[44:47], v[36:39], a[108:111], v[44:47]
    v_exp_f32 v53, v53
    v_mfma_f32_16x16x32_bf16 v[44:47], v[32:35], a[104:107], v[44:47]
    v_exp_f32 v54, v54
    v_mfma_f32_16x16x32_bf16 v[44:47], v[244:247], a[100:103], v[44:47]
    v_cvt_pk_bf16_f32 v222, v52, v53
    v_fma_f32 v55, v55, s31, v15
    v_mfma_f32_16x16x32_bf16 v[44:47], v[236:239], a[96:99], v[44:47]
    s_waitcnt lgkmcnt(4)
    v_exp_f32 v55, v55
    v_mfma_f32_16x16x32_bf16 v[48:51], a[224:227], a[0:3], v[252:255]
    ds_read_b128 v[236:239], v6 offset:42240
    v_fma_f32 v56, v56, s31, v12
    v_mfma_f32_16x16x32_bf16 v[48:51], a[228:231], a[4:7], v[48:51]
    v_exp_f32 v56, v56
    v_mfma_f32_16x16x32_bf16 v[48:51], a[232:235], a[8:11], v[48:51]
    s_waitcnt vmcnt(10)
    s_barrier
    ds_read_b128 v[244:247], v6 offset:42304
    v_mfma_f32_16x16x32_bf16 v[48:51], a[236:239], a[12:15], v[48:51]
    s_waitcnt lgkmcnt(2)
    v_cvt_pk_bf16_f32 v223, v54, v55
    v_fma_f32 v57, v57, s31, v12
    v_mfma_f32_16x16x32_bf16 v[48:51], a[240:243], a[16:19], v[48:51]
    v_exp_f32 v57, v57
    v_mfma_f32_16x16x32_bf16 v[48:51], a[244:247], a[20:23], v[48:51]
    ds_read_b128 v[32:35], v6 offset:42368
    v_fma_f32 v58, v58, s31, v12
    v_mfma_f32_16x16x32_bf16 v[48:51], a[248:251], a[24:27], v[48:51]
    v_exp_f32 v58, v58
    v_mfma_f32_16x16x32_bf16 v[48:51], v[228:231], a[28:31], v[48:51]
    v_cvt_pk_bf16_f32 v224, v56, v57
    v_fma_f32 v59, v59, s31, v12
    v_mfma_f32_16x16x32_bf16 v[52:55], v[228:231], a[60:63], v[252:255]
    v_exp_f32 v59, v59
    v_mfma_f32_16x16x32_bf16 v[52:55], a[248:251], a[56:59], v[52:55]
    ds_read_b128 v[36:39], v6 offset:42432
    v_fma_f32 v60, v60, s31, v13
    v_mfma_f32_16x16x32_bf16 v[52:55], a[244:247], a[52:55], v[52:55]
    v_exp_f32 v60, v60
    v_mfma_f32_16x16x32_bf16 v[52:55], a[240:243], a[48:51], v[52:55]
    v_cvt_pk_bf16_f32 v225, v58, v59
    v_fma_f32 v61, v61, s31, v13
    v_mfma_f32_16x16x32_bf16 v[52:55], a[236:239], a[44:47], v[52:55]
    v_exp_f32 v61, v61
    v_mfma_f32_16x16x32_bf16 v[52:55], a[232:235], a[40:43], v[52:55]
    ds_read_b128 a[192:195], v6 offset:42496
    v_fma_f32 v62, v62, s31, v13
    v_mfma_f32_16x16x32_bf16 v[52:55], a[228:231], a[36:39], v[52:55]
    v_exp_f32 v62, v62
    v_mfma_f32_16x16x32_bf16 v[52:55], a[224:227], a[32:35], v[52:55]
    v_cvt_pk_bf16_f32 v232, v60, v61
    v_fma_f32 v63, v63, s31, v13
    v_smfmac_f32_16x16x64_bf16 a[208:211], a[252:255], v[192:199], v10
    v_fma_f32 v64, v64, s31, v14
    v_mfma_f32_16x16x32_bf16 v[56:59], a[224:227], a[64:67], v[252:255]
    v_exp_f32 v63, v63
    v_mfma_f32_16x16x32_bf16 v[56:59], a[228:231], a[68:71], v[56:59]
    v_exp_f32 v64, v64
    v_mfma_f32_16x16x32_bf16 v[56:59], a[232:235], a[72:75], v[56:59]
    ds_read_b128 a[196:199], v6 offset:42560
    v_cvt_pk_bf16_f32 v233, v62, v63
    v_mfma_f32_16x16x32_bf16 v[56:59], a[236:239], a[76:79], v[56:59]
    v_fma_f32 v65, v65, s31, v14
    v_fma_f32 v66, v66, s31, v14
    v_mfma_f32_16x16x32_bf16 v[56:59], a[240:243], a[80:83], v[56:59]
    v_exp_f32 v65, v65
    v_mfma_f32_16x16x32_bf16 v[56:59], a[244:247], a[84:87], v[56:59]
    v_exp_f32 v66, v66
    v_mfma_f32_16x16x32_bf16 v[56:59], a[248:251], a[88:91], v[56:59]
    ds_read_b128 a[200:203], v6 offset:42624
    v_cvt_pk_bf16_f32 v240, v64, v65
    v_mfma_f32_16x16x32_bf16 v[56:59], v[228:231], a[92:95], v[56:59]
    v_fma_f32 v67, v67, s31, v14
    v_fma_f32 v68, v68, s31, v15
    v_mfma_f32_16x16x32_bf16 v[60:63], v[228:231], a[124:127], v[252:255]
    v_exp_f32 v67, v67
    v_mfma_f32_16x16x32_bf16 v[60:63], a[248:251], a[120:123], v[60:63]
    v_exp_f32 v68, v68
    v_mfma_f32_16x16x32_bf16 v[60:63], a[244:247], a[116:119], v[60:63]
    ds_read_b128 a[204:207], v6 offset:42688
    v_cvt_pk_bf16_f32 v241, v66, v67
    v_mfma_f32_16x16x32_bf16 v[60:63], a[240:243], a[112:115], v[60:63]
    v_fma_f32 v69, v69, s31, v15
    v_fma_f32 v70, v70, s31, v15
    v_mfma_f32_16x16x32_bf16 v[60:63], a[236:239], a[108:111], v[60:63]
    v_exp_f32 v69, v69
    v_mfma_f32_16x16x32_bf16 v[60:63], a[232:235], a[104:107], v[60:63]
    v_exp_f32 v70, v70
    v_mfma_f32_16x16x32_bf16 v[60:63], a[228:231], a[100:103], v[60:63]
    v_cvt_pk_bf16_f32 v248, v68, v69
    v_fma_f32 v71, v71, s31, v15
    v_mfma_f32_16x16x32_bf16 v[60:63], a[224:227], a[96:99], v[60:63]
    v_exp_f32 v71, v71
    v_smfmac_f32_16x16x64_bf16 a[212:215], a[252:255], v[200:207], v10
    s_waitcnt lgkmcnt(4)
    v_fma_f32 v72, v72, s31, v12
    v_mfma_f32_16x16x32_bf16 v[64:67], v[236:239], a[0:3], v[252:255]
    v_exp_f32 v72, v72
    v_mfma_f32_16x16x32_bf16 v[64:67], v[244:247], a[4:7], v[64:67]
    v_cvt_pk_bf16_f32 v249, v70, v71
    v_fma_f32 v73, v73, s31, v12
    v_mfma_f32_16x16x32_bf16 v[64:67], v[32:35], a[8:11], v[64:67]
    v_exp_f32 v73, v73
    v_mfma_f32_16x16x32_bf16 v[64:67], v[36:39], a[12:15], v[64:67]
    s_waitcnt lgkmcnt(0)
    ds_read_b64_tr_b16 a[0:1], v11 offset:50688
    v_fma_f32 v74, v74, s31, v12
    v_mfma_f32_16x16x32_bf16 v[64:67], a[192:195], a[16:19], v[64:67]
    v_exp_f32 v74, v74
    v_mfma_f32_16x16x32_bf16 v[64:67], a[196:199], a[20:23], v[64:67]
    ds_read_b64_tr_b16 a[2:3], v11 offset:51200
    v_cvt_pk_bf16_f32 v226, v72, v73
    v_mfma_f32_16x16x32_bf16 v[64:67], a[200:203], a[24:27], v[64:67]
    ds_read_b64_tr_b16 a[4:5], v11 offset:54912
    v_fma_f32 v75, v75, s31, v12
    v_mfma_f32_16x16x32_bf16 v[64:67], a[204:207], a[28:31], v[64:67]
    v_exp_f32 v75, v75
    v_mfma_f32_16x16x32_bf16 v[68:71], a[204:207], a[60:63], v[252:255]
    ds_read_b64_tr_b16 a[6:7], v11 offset:55424
    v_fma_f32 v76, v76, s31, v13
    v_mfma_f32_16x16x32_bf16 v[68:71], a[200:203], a[56:59], v[68:71]
    v_exp_f32 v76, v76
    v_mfma_f32_16x16x32_bf16 v[68:71], a[196:199], a[52:55], v[68:71]
    ds_read_b64_tr_b16 a[8:9], v11 offset:59136
    v_cvt_pk_bf16_f32 v227, v74, v75
    v_mfma_f32_16x16x32_bf16 v[68:71], a[192:195], a[48:51], v[68:71]
    ds_read_b64_tr_b16 a[10:11], v11 offset:59648
    v_fma_f32 v77, v77, s31, v13
    v_mfma_f32_16x16x32_bf16 v[68:71], v[36:39], a[44:47], v[68:71]
    v_exp_f32 v77, v77
    v_mfma_f32_16x16x32_bf16 v[68:71], v[32:35], a[40:43], v[68:71]
    ds_read_b64_tr_b16 a[12:13], v11 offset:63360
    v_fma_f32 v78, v78, s31, v13
    v_mfma_f32_16x16x32_bf16 v[68:71], v[244:247], a[36:39], v[68:71]
    v_exp_f32 v78, v78
    v_mfma_f32_16x16x32_bf16 v[68:71], v[236:239], a[32:35], v[68:71]
    ds_read_b64_tr_b16 a[14:15], v11 offset:63872
    v_cvt_pk_bf16_f32 v234, v76, v77
    v_smfmac_f32_16x16x64_bf16 a[216:219], a[252:255], v[208:215], v10
    ds_read_b64_tr_b16 a[16:17], v0 offset:0
    v_mfma_f32_16x16x32_bf16 v[72:75], v[236:239], a[64:67], v[252:255]
    ds_read_b64_tr_b16 a[18:19], v0 offset:512
    v_fma_f32 v79, v79, s31, v13
    v_mfma_f32_16x16x32_bf16 v[72:75], v[244:247], a[68:71], v[72:75]
    v_exp_f32 v79, v79
    v_fma_f32 v40, v40, s31, v14
    v_mfma_f32_16x16x32_bf16 v[72:75], v[32:35], a[72:75], v[72:75]
    v_exp_f32 v40, v40
    v_mfma_f32_16x16x32_bf16 v[72:75], v[36:39], a[76:79], v[72:75]
    ds_read_b64_tr_b16 a[20:21], v0 offset:4224
    v_cvt_pk_bf16_f32 v235, v78, v79
    v_mfma_f32_16x16x32_bf16 v[72:75], a[192:195], a[80:83], v[72:75]
    ds_read_b64_tr_b16 a[22:23], v0 offset:4736
    v_fma_f32 v41, v41, s31, v14
    v_mfma_f32_16x16x32_bf16 v[72:75], a[196:199], a[84:87], v[72:75]
    v_exp_f32 v41, v41
    v_mfma_f32_16x16x32_bf16 v[72:75], a[200:203], a[88:91], v[72:75]
    ds_read_b64_tr_b16 a[24:25], v0 offset:8448
    v_fma_f32 v42, v42, s31, v14
    v_mfma_f32_16x16x32_bf16 v[72:75], a[204:207], a[92:95], v[72:75]
    v_exp_f32 v42, v42
    v_cvt_pk_bf16_f32 v242, v40, v41
    v_mfma_f32_16x16x32_bf16 v[76:79], a[204:207], a[124:127], v[252:255]
    ds_read_b64_tr_b16 a[26:27], v0 offset:8960
    v_fma_f32 v43, v43, s31, v14
    v_mfma_f32_16x16x32_bf16 v[76:79], a[200:203], a[120:123], v[76:79]
    v_exp_f32 v43, v43
    v_mfma_f32_16x16x32_bf16 v[76:79], a[196:199], a[116:119], v[76:79]
    ds_read_b64_tr_b16 a[28:29], v0 offset:12672
    v_fma_f32 v44, v44, s31, v15
    v_mfma_f32_16x16x32_bf16 v[76:79], a[192:195], a[112:115], v[76:79]
    v_exp_f32 v44, v44
    v_cvt_pk_bf16_f32 v243, v42, v43
    v_mfma_f32_16x16x32_bf16 v[76:79], v[36:39], a[108:111], v[76:79]
    ds_read_b64_tr_b16 a[30:31], v0 offset:13184
    v_fma_f32 v45, v45, s31, v15
    v_mfma_f32_16x16x32_bf16 v[76:79], v[32:35], a[104:107], v[76:79]
    v_exp_f32 v45, v45
    v_mfma_f32_16x16x32_bf16 v[76:79], v[244:247], a[100:103], v[76:79]
    v_fma_f32 v46, v46, s31, v15
    v_cvt_pk_bf16_f32 v250, v44, v45
    v_mfma_f32_16x16x32_bf16 v[76:79], v[236:239], a[96:99], v[76:79]
    v_exp_f32 v46, v46
    v_smfmac_f32_16x16x64_bf16 a[220:223], a[252:255], v[216:223], v10
    s_waitcnt lgkmcnt(8)
    v_fma_f32 v47, v47, s31, v15
    v_mfma_f32_16x16x32_bf16 v[32:35], a[0:3], a[128:131], 0
    v_exp_f32 v47, v47
    v_mfma_f32_16x16x32_bf16 v[32:35], a[4:7], a[132:135], v[32:35]
    ds_read_b64_tr_b16 a[32:33], v11 offset:50720
    v_fma_f32 v48, v48, s31, v12
    v_mfma_f32_16x16x32_bf16 v[32:35], a[8:11], a[160:163], v[32:35]
    v_exp_f32 v48, v48
    v_mfma_f32_16x16x32_bf16 v[32:35], a[12:15], a[164:167], v[32:35]
    s_waitcnt lgkmcnt(1)
    ds_read_b64_tr_b16 a[34:35], v11 offset:51232
    v_cvt_pk_bf16_f32 v251, v46, v47
    v_mfma_f32_16x16x32_bf16 v[32:35], a[16:19], v[80:83], v[32:35]
    ds_read_b64_tr_b16 a[36:37], v11 offset:54944
    v_fma_f32 v49, v49, s31, v12
    v_mfma_f32_16x16x32_bf16 v[32:35], a[20:23], v[84:87], v[32:35]
    v_exp_f32 v49, v49
    v_mfma_f32_16x16x32_bf16 v[32:35], a[24:27], v[96:99], v[32:35]
    ds_read_b64_tr_b16 a[38:39], v11 offset:55456
    v_fma_f32 v50, v50, s31, v12
    v_mfma_f32_16x16x32_bf16 v[32:35], a[28:31], v[100:103], v[32:35]
    ds_read_b64_tr_b16 a[40:41], v11 offset:59168
    v_cvt_pk_bf16_f32 v228, v48, v49
    v_mfma_f32_16x16x32_bf16 v[36:39], a[28:31], v[108:111], 0
    v_exp_f32 v50, v50
    v_mfma_f32_16x16x32_bf16 v[36:39], a[24:27], v[104:107], v[36:39]
    ds_read_b64_tr_b16 a[42:43], v11 offset:59680
    v_fma_f32 v51, v51, s31, v12
    v_mfma_f32_16x16x32_bf16 v[36:39], a[20:23], v[92:95], v[36:39]
    v_exp_f32 v51, v51
    v_mfma_f32_16x16x32_bf16 v[36:39], a[16:19], v[88:91], v[36:39]
    ds_read_b64_tr_b16 a[44:45], v11 offset:63392
    v_fma_f32 v52, v52, s31, v13
    v_mfma_f32_16x16x32_bf16 v[36:39], a[12:15], a[172:175], v[36:39]
    ds_read_b64_tr_b16 a[46:47], v11 offset:63904
    v_cvt_pk_bf16_f32 v229, v50, v51
    v_mfma_f32_16x16x32_bf16 v[36:39], a[8:11], a[168:171], v[36:39]
    v_exp_f32 v52, v52
    v_mfma_f32_16x16x32_bf16 v[36:39], a[4:7], a[140:143], v[36:39]
    ds_read_b64_tr_b16 a[48:49], v0 offset:32
    v_fma_f32 v53, v53, s31, v13
    v_mfma_f32_16x16x32_bf16 v[36:39], a[0:3], a[136:139], v[36:39]
    v_exp_f32 v53, v53
    v_mfma_f32_16x16x32_bf16 v[40:43], a[0:3], a[144:147], 0
    ds_read_b64_tr_b16 a[50:51], v0 offset:544
    v_fma_f32 v54, v54, s31, v13
    v_mfma_f32_16x16x32_bf16 v[40:43], a[4:7], a[148:151], v[40:43]
    ds_read_b64_tr_b16 a[52:53], v0 offset:4256
    v_cvt_pk_bf16_f32 v236, v52, v53
    v_mfma_f32_16x16x32_bf16 v[40:43], a[8:11], a[176:179], v[40:43]
    v_exp_f32 v54, v54
    v_mfma_f32_16x16x32_bf16 v[40:43], a[12:15], a[180:183], v[40:43]
    ds_read_b64_tr_b16 a[54:55], v0 offset:4768
    v_fma_f32 v55, v55, s31, v13
    v_mfma_f32_16x16x32_bf16 v[40:43], a[16:19], v[16:19], v[40:43]
    v_exp_f32 v55, v55
    v_mfma_f32_16x16x32_bf16 v[40:43], a[20:23], v[20:23], v[40:43]
    ds_read_b64_tr_b16 a[56:57], v0 offset:8480
    v_fma_f32 v56, v56, s31, v14
    v_mfma_f32_16x16x32_bf16 v[40:43], a[24:27], v[112:115], v[40:43]
    ds_read_b64_tr_b16 a[58:59], v0 offset:8992
    v_cvt_pk_bf16_f32 v237, v54, v55
    v_mfma_f32_16x16x32_bf16 v[40:43], a[28:31], v[116:119], v[40:43]
    v_exp_f32 v56, v56
    v_mfma_f32_16x16x32_bf16 v[44:47], a[28:31], v[124:127], 0
    ds_read_b64_tr_b16 a[60:61], v0 offset:12704
    v_fma_f32 v57, v57, s31, v14
    v_mfma_f32_16x16x32_bf16 v[44:47], a[24:27], v[120:123], v[44:47]
    v_exp_f32 v57, v57
    v_mfma_f32_16x16x32_bf16 v[44:47], a[20:23], v[28:31], v[44:47]
    ds_read_b64_tr_b16 a[62:63], v0 offset:13216
    v_fma_f32 v58, v58, s31, v14
    v_mfma_f32_16x16x32_bf16 v[44:47], a[16:19], v[24:27], v[44:47]
    v_cvt_pk_bf16_f32 v244, v56, v57
    v_fma_f32 v59, v59, s31, v14
    v_mfma_f32_16x16x32_bf16 v[44:47], a[12:15], a[188:191], v[44:47]
    v_exp_f32 v58, v58
    v_mfma_f32_16x16x32_bf16 v[44:47], a[8:11], a[184:187], v[44:47]
    v_exp_f32 v59, v59
    v_mfma_f32_16x16x32_bf16 v[44:47], a[4:7], a[156:159], v[44:47]
    v_fma_f32 v60, v60, s31, v15
    v_cvt_pk_bf16_f32 v245, v58, v59
    v_mfma_f32_16x16x32_bf16 v[44:47], a[0:3], a[152:155], v[44:47]
    s_waitcnt lgkmcnt(8)
    v_exp_f32 v60, v60
    v_mfma_f32_16x16x32_bf16 v[48:51], a[32:35], a[128:131], 0
    v_fma_f32 v61, v61, s31, v15
    v_mfma_f32_16x16x32_bf16 v[48:51], a[36:39], a[132:135], v[48:51]
    v_exp_f32 v61, v61
    v_mfma_f32_16x16x32_bf16 v[48:51], a[40:43], a[160:163], v[48:51]
    ds_read_b64_tr_b16 a[64:65], v8 offset:0
    v_fma_f32 v62, v62, s31, v15
    v_mfma_f32_16x16x32_bf16 v[48:51], a[44:47], a[164:167], v[48:51]
    s_waitcnt lgkmcnt(1)
    ds_read_b64_tr_b16 a[66:67], v8 offset:512
    v_cvt_pk_bf16_f32 v252, v60, v61
    v_mfma_f32_16x16x32_bf16 v[48:51], a[48:51], v[80:83], v[48:51]
    v_exp_f32 v62, v62
    v_mfma_f32_16x16x32_bf16 v[48:51], a[52:55], v[84:87], v[48:51]
    ds_read_b64_tr_b16 a[68:69], v8 offset:4224
    v_fma_f32 v63, v63, s31, v15
    v_mfma_f32_16x16x32_bf16 v[48:51], a[56:59], v[96:99], v[48:51]
    v_exp_f32 v63, v63
    v_mfma_f32_16x16x32_bf16 v[48:51], a[60:63], v[100:103], v[48:51]
    ds_read_b64_tr_b16 a[70:71], v8 offset:4736
    v_fma_f32 v64, v64, s31, v12
    v_mfma_f32_16x16x32_bf16 v[52:55], a[60:63], v[108:111], 0
    ds_read_b64_tr_b16 a[72:73], v8 offset:8448
    v_cvt_pk_bf16_f32 v253, v62, v63
    v_mfma_f32_16x16x32_bf16 v[52:55], a[56:59], v[104:107], v[52:55]
    v_exp_f32 v64, v64
    v_mfma_f32_16x16x32_bf16 v[52:55], a[52:55], v[92:95], v[52:55]
    ds_read_b64_tr_b16 a[74:75], v8 offset:8960
    v_fma_f32 v65, v65, s31, v12
    v_mfma_f32_16x16x32_bf16 v[52:55], a[48:51], v[88:91], v[52:55]
    v_exp_f32 v65, v65
    v_mfma_f32_16x16x32_bf16 v[52:55], a[44:47], a[172:175], v[52:55]
    ds_read_b64_tr_b16 a[76:77], v8 offset:12672
    v_mfma_f32_16x16x32_bf16 v[52:55], a[40:43], a[168:171], v[52:55]
    ds_read_b64_tr_b16 a[78:79], v8 offset:13184
    v_fma_f32 v66, v66, s31, v12
    v_mfma_f32_16x16x32_bf16 v[52:55], a[36:39], a[140:143], v[52:55]
    ds_read_b64_tr_b16 a[80:81], v8 offset:16896
    v_cvt_pk_bf16_f32 v230, v64, v65
    v_mfma_f32_16x16x32_bf16 v[52:55], a[32:35], a[136:139], v[52:55]
    v_exp_f32 v66, v66
    v_mfma_f32_16x16x32_bf16 v[56:59], a[32:35], a[144:147], 0
    ds_read_b64_tr_b16 a[82:83], v8 offset:17408
    v_fma_f32 v67, v67, s31, v12
    v_mfma_f32_16x16x32_bf16 v[56:59], a[36:39], a[148:151], v[56:59]
    v_exp_f32 v67, v67
    v_mfma_f32_16x16x32_bf16 v[56:59], a[40:43], a[176:179], v[56:59]
    ds_read_b64_tr_b16 a[84:85], v8 offset:21120
    v_fma_f32 v68, v68, s31, v13
    v_mfma_f32_16x16x32_bf16 v[56:59], a[44:47], a[180:183], v[56:59]
    ds_read_b64_tr_b16 a[86:87], v8 offset:21632
    v_cvt_pk_bf16_f32 v231, v66, v67
    v_mfma_f32_16x16x32_bf16 v[56:59], a[48:51], v[16:19], v[56:59]
    v_exp_f32 v68, v68
    v_mfma_f32_16x16x32_bf16 v[56:59], a[52:55], v[20:23], v[56:59]
    ds_read_b64_tr_b16 a[88:89], v8 offset:25344
    v_fma_f32 v69, v69, s31, v13
    v_mfma_f32_16x16x32_bf16 v[56:59], a[56:59], v[112:115], v[56:59]
    v_exp_f32 v69, v69
    v_mfma_f32_16x16x32_bf16 v[56:59], a[60:63], v[116:119], v[56:59]
    ds_read_b64_tr_b16 a[90:91], v8 offset:25856
    v_fma_f32 v70, v70, s31, v13
    v_mfma_f32_16x16x32_bf16 v[60:63], a[60:63], v[124:127], 0
    ds_read_b64_tr_b16 a[92:93], v8 offset:29568
    v_cvt_pk_bf16_f32 v238, v68, v69
    v_mfma_f32_16x16x32_bf16 v[60:63], a[56:59], v[120:123], v[60:63]
    v_exp_f32 v70, v70
    v_mfma_f32_16x16x32_bf16 v[60:63], a[52:55], v[28:31], v[60:63]
    ds_read_b64_tr_b16 a[94:95], v8 offset:30080
    v_fma_f32 v71, v71, s31, v13
    v_mfma_f32_16x16x32_bf16 v[60:63], a[48:51], v[24:27], v[60:63]
    v_exp_f32 v71, v71
    v_mfma_f32_16x16x32_bf16 v[60:63], a[44:47], a[188:191], v[60:63]
    v_fma_f32 v72, v72, s31, v14
    v_mfma_f32_16x16x32_bf16 v[60:63], a[40:43], a[184:187], v[60:63]
    ds_read_b64_tr_b16 a[96:97], v8 offset:32
    v_cvt_pk_bf16_f32 v239, v70, v71
    v_mfma_f32_16x16x32_bf16 v[60:63], a[36:39], a[156:159], v[60:63]
    v_exp_f32 v72, v72
    v_mfma_f32_16x16x32_bf16 v[60:63], a[32:35], a[152:155], v[60:63]
    s_waitcnt lgkmcnt(9)
    ds_read_b64_tr_b16 a[98:99], v8 offset:544
    v_fma_f32 v73, v73, s31, v14
    v_mfma_f32_16x16x32_bf16 v[32:35], a[64:67], v[128:131], v[32:35]
    v_exp_f32 v73, v73
    v_mfma_f32_16x16x32_bf16 v[32:35], a[68:71], v[132:135], v[32:35]
    ds_read_b64_tr_b16 a[100:101], v8 offset:4256
    v_mfma_f32_16x16x32_bf16 v[32:35], a[72:75], v[160:163], v[32:35]
    ds_read_b64_tr_b16 a[102:103], v8 offset:4768
    v_fma_f32 v74, v74, s31, v14
    v_mfma_f32_16x16x32_bf16 v[32:35], a[76:79], v[164:167], v[32:35]
    s_waitcnt lgkmcnt(4)
    ds_read_b64_tr_b16 a[104:105], v8 offset:8480
    v_cvt_pk_bf16_f32 v246, v72, v73
    v_mfma_f32_16x16x32_bf16 v[32:35], a[80:83], v[192:195], v[32:35]
    v_exp_f32 v74, v74
    v_mfma_f32_16x16x32_bf16 v[32:35], a[84:87], v[196:199], v[32:35]
    ds_read_b64_tr_b16 a[106:107], v8 offset:8992
    v_fma_f32 v75, v75, s31, v14
    v_mfma_f32_16x16x32_bf16 v[32:35], a[88:91], v[224:227], v[32:35]
    v_exp_f32 v75, v75
    v_mfma_f32_16x16x32_bf16 v[32:35], a[92:95], v[228:231], v[32:35]
    ds_read_b64_tr_b16 a[108:109], v8 offset:12704
    v_fma_f32 v76, v76, s31, v15
    v_mfma_f32_16x16x32_bf16 v[36:39], a[92:95], v[236:239], v[36:39]
    ds_read_b64_tr_b16 a[110:111], v8 offset:13216
    v_cvt_pk_bf16_f32 v247, v74, v75
    v_mfma_f32_16x16x32_bf16 v[36:39], a[88:91], v[232:235], v[36:39]
    v_exp_f32 v76, v76
    v_mfma_f32_16x16x32_bf16 v[36:39], a[84:87], v[204:207], v[36:39]
    ds_read_b64_tr_b16 a[112:113], v8 offset:16928
    v_fma_f32 v77, v77, s31, v15
    v_mfma_f32_16x16x32_bf16 v[36:39], a[80:83], v[200:203], v[36:39]
    v_exp_f32 v77, v77
    v_mfma_f32_16x16x32_bf16 v[36:39], a[76:79], v[172:175], v[36:39]
    ds_read_b64_tr_b16 a[114:115], v8 offset:17440
    v_fma_f32 v78, v78, s31, v15
    v_mfma_f32_16x16x32_bf16 v[36:39], a[72:75], v[168:171], v[36:39]
    ds_read_b64_tr_b16 a[116:117], v8 offset:21152
    v_cvt_pk_bf16_f32 v254, v76, v77
    v_mfma_f32_16x16x32_bf16 v[36:39], a[68:71], v[140:143], v[36:39]
    v_exp_f32 v78, v78
    v_mfma_f32_16x16x32_bf16 v[36:39], a[64:67], v[136:139], v[36:39]
    ds_read_b64_tr_b16 a[118:119], v8 offset:21664
    v_fma_f32 v79, v79, s31, v15
    v_mfma_f32_16x16x32_bf16 v[40:43], a[64:67], v[144:147], v[40:43]
    v_exp_f32 v79, v79
    v_mfma_f32_16x16x32_bf16 v[40:43], a[68:71], v[148:151], v[40:43]
    ds_read_b64_tr_b16 a[120:121], v8 offset:25376
    v_mfma_f32_16x16x32_bf16 v[40:43], a[72:75], v[176:179], v[40:43]
    ds_read_b64_tr_b16 a[122:123], v8 offset:25888
    v_cvt_pk_bf16_f32 v255, v78, v79
    v_mfma_f32_16x16x32_bf16 v[40:43], a[76:79], v[180:183], v[40:43]
    ds_read_b64_tr_b16 a[124:125], v8 offset:29600
    v_mfma_f32_16x16x32_bf16 v[40:43], a[80:83], v[208:211], v[40:43]
    ds_read_b64_tr_b16 a[126:127], v8 offset:30112
    v_mfma_f32_16x16x32_bf16 v[40:43], a[84:87], v[212:215], v[40:43]
    ds_read_b64_tr_b16 a[224:225], v11 offset:50752
    v_mfma_f32_16x16x32_bf16 v[40:43], a[88:91], v[240:243], v[40:43]
    s_add_u32 s61, s50, s99
    v_mfma_f32_16x16x32_bf16 v[40:43], a[92:95], v[244:247], v[40:43]
    s_add_u32 m0, s30, 67584
    ds_read_b64_tr_b16 a[226:227], v11 offset:51264
    v_mfma_f32_16x16x32_bf16 v[44:47], a[92:95], v[252:255], v[44:47]
    buffer_load_dwordx4 v2, s[16:19], s61 offen offset:0  lds
    v_mfma_f32_16x16x32_bf16 v[44:47], a[88:91], v[248:251], v[44:47]
    ds_read_b64_tr_b16 a[228:229], v11 offset:54976
    v_mfma_f32_16x16x32_bf16 v[44:47], a[84:87], v[220:223], v[44:47]
    ds_read_b64_tr_b16 a[230:231], v11 offset:55488
    v_mfma_f32_16x16x32_bf16 v[44:47], a[80:83], v[216:219], v[44:47]
    ds_read_b64_tr_b16 a[232:233], v11 offset:59200
    v_mfma_f32_16x16x32_bf16 v[44:47], a[76:79], v[188:191], v[44:47]
    s_add_u32 m0, s30, 67616
    v_mfma_f32_16x16x32_bf16 v[44:47], a[72:75], v[184:187], v[44:47]
    buffer_load_dwordx4 v2, s[16:19], s61 offen offset:1024  lds
    v_mfma_f32_16x16x32_bf16 v[44:47], a[68:71], v[156:159], v[44:47]
    ds_read_b64_tr_b16 a[234:235], v11 offset:59712
    v_mfma_f32_16x16x32_bf16 v[44:47], a[64:67], v[152:155], v[44:47]
    ds_read_b64_tr_b16 a[236:237], v11 offset:63424
    v_smfmac_f32_16x16x64_bf16 a[208:211], a[252:255], v[224:231], v10
    s_waitcnt lgkmcnt(15)
    ds_read_b64_tr_b16 a[238:239], v11 offset:63936
    v_mfma_f32_16x16x32_bf16 v[48:51], a[96:99], v[128:131], v[48:51]
    s_add_u32 m0, s30, 67648
    ds_read_b64_tr_b16 a[240:241], v0 offset:64
    v_mfma_f32_16x16x32_bf16 v[48:51], a[100:103], v[132:135], v[48:51]
L_pg6:
    s_cbranch_execz L_warm_done
    buffer_load_dwordx4 v2, s[16:19], s61 offen offset:2048  lds
    v_mfma_f32_16x16x32_bf16 v[48:51], a[104:107], v[160:163], v[48:51]
    ds_read_b64_tr_b16 a[242:243], v0 offset:576
    v_mfma_f32_16x16x32_bf16 v[48:51], a[108:111], v[164:167], v[48:51]
    s_waitcnt lgkmcnt(10)
    ds_read_b64_tr_b16 a[244:245], v0 offset:4288
    v_mfma_f32_16x16x32_bf16 v[48:51], a[112:115], v[192:195], v[48:51]
    v_mfma_f32_16x16x32_bf16 v[48:51], a[116:119], v[196:199], v[48:51]
    s_add_u32 m0, s30, 67680
    ds_read_b64_tr_b16 a[246:247], v0 offset:4800
    v_mfma_f32_16x16x32_bf16 v[48:51], a[120:123], v[224:227], v[48:51]
    buffer_load_dwordx4 v2, s[16:19], s61 offen offset:3072  lds
    v_mfma_f32_16x16x32_bf16 v[48:51], a[124:127], v[228:231], v[48:51]
    ds_read_b64_tr_b16 a[248:249], v0 offset:8512
    v_smfmac_f32_16x16x64_bf16 a[212:215], a[252:255], v[232:239], v10
    ds_read_b64_tr_b16 a[250:251], v0 offset:9024
    v_mfma_f32_16x16x32_bf16 v[52:55], a[124:127], v[236:239], v[52:55]
    s_add_u32 s61, s51, s99
    ds_read_b64_tr_b16 a[0:1], v0 offset:12736
    v_mfma_f32_16x16x32_bf16 v[52:55], a[120:123], v[232:235], v[52:55]
    s_add_u32 m0, s30, 84480
    v_mfma_f32_16x16x32_bf16 v[52:55], a[116:119], v[204:207], v[52:55]
    buffer_load_dwordx4 v2, s[16:19], s61 offen offset:0  lds
    v_mfma_f32_16x16x32_bf16 v[52:55], a[112:115], v[200:203], v[52:55]
    ds_read_b64_tr_b16 a[2:3], v0 offset:13248
    v_mfma_f32_16x16x32_bf16 v[52:55], a[108:111], v[172:175], v[52:55]
    ds_read_b64_tr_b16 a[4:5], v8 offset:64
    v_mfma_f32_16x16x32_bf16 v[52:55], a[104:107], v[168:171], v[52:55]
    ds_read_b64_tr_b16 a[6:7], v8 offset:576
    v_mfma_f32_16x16x32_bf16 v[52:55], a[100:103], v[140:143], v[52:55]
    s_add_u32 m0, s30, 84512
    ds_read_b64_tr_b16 a[8:9], v8 offset:4288
    v_mfma_f32_16x16x32_bf16 v[52:55], a[96:99], v[136:139], v[52:55]
    buffer_load_dwordx4 v2, s[16:19], s61 offen offset:1024  lds
    v_smfmac_f32_16x16x64_bf16 a[216:219], a[252:255], v[240:247], v10
    ds_read_b64_tr_b16 a[10:11], v8 offset:4800
    v_mfma_f32_16x16x32_bf16 v[56:59], a[96:99], v[144:147], v[56:59]
    ds_read_b64_tr_b16 a[12:13], v8 offset:8512
    v_mfma_f32_16x16x32_bf16 v[56:59], a[100:103], v[148:151], v[56:59]
    v_mfma_f32_16x16x32_bf16 v[56:59], a[104:107], v[176:179], v[56:59]
    s_add_u32 m0, s30, 84544
    ds_read_b64_tr_b16 a[14:15], v8 offset:9024
    v_mfma_f32_16x16x32_bf16 v[56:59], a[108:111], v[180:183], v[56:59]
    buffer_load_dwordx4 v2, s[16:19], s61 offen offset:2048  lds
    v_mfma_f32_16x16x32_bf16 v[56:59], a[112:115], v[208:211], v[56:59]
    ds_read_b64_tr_b16 a[16:17], v8 offset:12736
    v_mfma_f32_16x16x32_bf16 v[56:59], a[116:119], v[212:215], v[56:59]
    ds_read_b64_tr_b16 a[18:19], v8 offset:13248
    v_mfma_f32_16x16x32_bf16 v[56:59], a[120:123], v[240:243], v[56:59]
    ds_read_b64_tr_b16 a[20:21], v8 offset:16960
    v_mfma_f32_16x16x32_bf16 v[56:59], a[124:127], v[244:247], v[56:59]
    s_add_u32 m0, s30, 84576
    v_smfmac_f32_16x16x64_bf16 a[220:223], a[252:255], v[248:255], v10
    ds_read_b64_tr_b16 a[22:23], v8 offset:17472
    v_mfma_f32_16x16x32_bf16 v[60:63], a[124:127], v[252:255], v[60:63]
    buffer_load_dwordx4 v2, s[16:19], s61 offen offset:3072  lds
    v_mfma_f32_16x16x32_bf16 v[60:63], a[120:123], v[248:251], v[60:63]
    ds_read_b64_tr_b16 a[24:25], v8 offset:21184
    v_mfma_f32_16x16x32_bf16 v[60:63], a[116:119], v[220:223], v[60:63]
    ds_read_b64_tr_b16 a[26:27], v8 offset:21696
    v_accvgpr_read_b32 v12, a208
    v_mfma_f32_16x16x32_bf16 v[60:63], a[112:115], v[216:219], v[60:63]
    ds_read_b64_tr_b16 a[28:29], v8 offset:25408
    s_waitcnt vmcnt(14)
    v_accvgpr_read_b32 v9, a209
    v_mfma_f32_16x16x32_bf16 v[60:63], a[108:111], v[188:191], v[60:63]
    v_add_f32 v12, v12, v9
    v_accvgpr_read_b32 v13, a212
    v_mfma_f32_16x16x32_bf16 v[60:63], a[104:107], v[184:187], v[60:63]
    ds_read_b64_tr_b16 a[30:31], v8 offset:25920
    v_accvgpr_read_b32 v9, a213
    v_mfma_f32_16x16x32_bf16 v[60:63], a[100:103], v[156:159], v[60:63]
    ds_read_b64_tr_b16 a[32:33], v8 offset:29632
    v_add_f32 v13, v13, v9
    v_mfma_f32_16x16x32_bf16 v[60:63], a[96:99], v[152:155], v[60:63]
    s_waitcnt lgkmcnt(15)
    v_accvgpr_read_b32 v14, a216
    v_accvgpr_read_b32 v9, a217
    v_mfma_f32_16x16x32_bf16 v[64:67], a[224:227], a[128:131], 0
    ds_read_b64_tr_b16 a[34:35], v8 offset:30144
    v_add_f32 v14, v14, v9
    v_mfma_f32_16x16x32_bf16 v[64:67], a[228:231], a[132:135], v[64:67]
    v_accvgpr_read_b32 v15, a220
    v_accvgpr_read_b32 v9, a221
    v_mfma_f32_16x16x32_bf16 v[64:67], a[232:235], a[160:163], v[64:67]
    v_add_f32 v15, v15, v9
    v_add_f32 v9, v12, v13
    v_mfma_f32_16x16x32_bf16 v[64:67], a[236:239], a[164:167], v[64:67]
    v_add_f32 v10, v14, v15
    v_add_f32 v9, v9, v10
    v_mfma_f32_16x16x32_bf16 v[64:67], a[240:243], v[80:83], v[64:67]
    v_cmp_nge_f32 vcc, 0x58800000, v9
    v_mov_b32 v10, s3
    v_mfma_f32_16x16x32_bf16 v[64:67], a[244:247], v[84:87], v[64:67]
    v_lshlrev_b32 v10, 3, v10
    v_mfma_f32_16x16x32_bf16 v[64:67], a[248:251], v[96:99], v[64:67]
    s_cmp_lg_u64 vcc, 0
    s_cselect_b32 s63, 1, 0
    v_mov_b32 v9, s63
    v_mfma_f32_16x16x32_bf16 v[64:67], a[0:3], v[100:103], v[64:67]
    s_waitcnt lgkmcnt(8)
    v_add_u32 v10, 152064, v10
    v_mfma_f32_16x16x32_bf16 v[64:67], a[4:7], v[128:131], v[64:67]
    v_rcp_f32 v12, v12
    v_mfma_f32_16x16x32_bf16 v[64:67], a[8:11], v[132:135], v[64:67]
    v_rcp_f32 v13, v13
    v_mfma_f32_16x16x32_bf16 v[64:67], a[12:15], v[160:163], v[64:67]
    v_mfma_f32_16x16x32_bf16 v[64:67], a[16:19], v[164:167], v[64:67]
    s_waitcnt lgkmcnt(0)
    v_rcp_f32 v14, v14
    v_mfma_f32_16x16x32_bf16 v[64:67], a[20:23], v[192:195], v[64:67]
    v_mfma_f32_16x16x32_bf16 v[64:67], a[24:27], v[196:199], v[64:67]
    v_rcp_f32 v15, v15
    v_mfma_f32_16x16x32_bf16 v[64:67], a[28:31], v[224:227], v[64:67]
    v_mfma_f32_16x16x32_bf16 v[64:67], a[32:35], v[228:231], v[64:67]
    v_mfma_f32_16x16x32_bf16 v[68:71], a[32:35], v[236:239], 0
    v_mfma_f32_16x16x32_bf16 v[68:71], a[28:31], v[232:235], v[68:71]
    v_mfma_f32_16x16x32_bf16 v[68:71], a[24:27], v[204:207], v[68:71]
    v_mfma_f32_16x16x32_bf16 v[68:71], a[20:23], v[200:203], v[68:71]
    ds_write_b32 v10, v9
    v_mfma_f32_16x16x32_bf16 v[68:71], a[16:19], v[172:175], v[68:71]
    ds_read_b64_tr_b16 a[36:37], v11 offset:50784
    v_mfma_f32_16x16x32_bf16 v[68:71], a[12:15], v[168:171], v[68:71]
    ds_read_b64_tr_b16 a[38:39], v11 offset:51296
    v_mfma_f32_16x16x32_bf16 v[68:71], a[8:11], v[140:143], v[68:71]
    ds_read_b64_tr_b16 a[40:41], v11 offset:55008
    v_mfma_f32_16x16x32_bf16 v[68:71], a[4:7], v[136:139], v[68:71]
    ds_read_b64_tr_b16 a[42:43], v11 offset:55520
    v_mfma_f32_16x16x32_bf16 v[68:71], a[0:3], v[108:111], v[68:71]
    ds_read_b64_tr_b16 a[44:45], v11 offset:59232
    v_mfma_f32_16x16x32_bf16 v[68:71], a[248:251], v[104:107], v[68:71]
    ds_read_b64_tr_b16 a[46:47], v11 offset:59744
    v_mfma_f32_16x16x32_bf16 v[68:71], a[244:247], v[92:95], v[68:71]
    ds_read_b64_tr_b16 a[48:49], v11 offset:63456
    v_mfma_f32_16x16x32_bf16 v[68:71], a[240:243], v[88:91], v[68:71]
    v_mfma_f32_16x16x32_bf16 v[68:71], a[236:239], a[172:175], v[68:71]
    ds_read_b64_tr_b16 a[50:51], v11 offset:63968
    v_mfma_f32_16x16x32_bf16 v[68:71], a[232:235], a[168:171], v[68:71]
    ds_read_b64_tr_b16 a[52:53], v0 offset:96
    v_mfma_f32_16x16x32_bf16 v[68:71], a[228:231], a[140:143], v[68:71]
    v_mfma_f32_16x16x32_bf16 v[68:71], a[224:227], a[136:139], v[68:71]
    ds_read_b64_tr_b16 a[54:55], v0 offset:608
    v_mul_f32 v32, v32, v12
    v_mfma_f32_16x16x32_bf16 v[72:75], a[224:227], a[144:147], 0
    ds_read_b64_tr_b16 a[56:57], v0 offset:4320
    v_mul_f32 v33, v33, v12
    v_mfma_f32_16x16x32_bf16 v[72:75], a[228:231], a[148:151], v[72:75]
    v_mul_f32 v34, v34, v12
    v_mfma_f32_16x16x32_bf16 v[72:75], a[232:235], a[176:179], v[72:75]
    ds_read_b64_tr_b16 a[58:59], v0 offset:4832
    v_mul_f32 v35, v35, v12
    v_mfma_f32_16x16x32_bf16 v[72:75], a[236:239], a[180:183], v[72:75]
    ds_read_b64_tr_b16 a[60:61], v0 offset:8544
    v_mul_f32 v48, v48, v12
    v_mfma_f32_16x16x32_bf16 v[72:75], a[240:243], v[16:19], v[72:75]
    v_mul_f32 v49, v49, v12
    v_mul_f32 v50, v50, v12
    v_mfma_f32_16x16x32_bf16 v[72:75], a[244:247], v[20:23], v[72:75]
    ds_read_b64_tr_b16 a[62:63], v0 offset:9056
    v_mul_f32 v51, v51, v12
    v_mfma_f32_16x16x32_bf16 v[72:75], a[248:251], v[112:115], v[72:75]
    ds_read_b64_tr_b16 a[64:65], v0 offset:12768
    v_cvt_pk_bf16_f32 v32, v32, v33
    v_mfma_f32_16x16x32_bf16 v[72:75], a[0:3], v[116:119], v[72:75]
    v_cvt_pk_bf16_f32 v33, v34, v35
    v_cvt_pk_bf16_f32 v34, v48, v49
    v_mfma_f32_16x16x32_bf16 v[72:75], a[4:7], v[144:147], v[72:75]
    ds_read_b64_tr_b16 a[66:67], v0 offset:13280
    v_cvt_pk_bf16_f32 v35, v50, v51
    v_mfma_f32_16x16x32_bf16 v[72:75], a[8:11], v[148:151], v[72:75]
    v_permlane16_swap_b32 v32, v34
    v_mfma_f32_16x16x32_bf16 v[72:75], a[12:15], v[176:179], v[72:75]
    ds_read_b64_tr_b16 a[68:69], v8 offset:96
    v_mfma_f32_16x16x32_bf16 v[72:75], a[16:19], v[180:183], v[72:75]
    v_permlane16_swap_b32 v33, v35
    v_mfma_f32_16x16x32_bf16 v[72:75], a[20:23], v[208:211], v[72:75]
    s_add_u32 s62, s53, s98
    ds_read_b64_tr_b16 a[70:71], v8 offset:608
    v_mfma_f32_16x16x32_bf16 v[72:75], a[24:27], v[212:215], v[72:75]
    ds_read_b64_tr_b16 a[72:73], v8 offset:4320
    v_mfma_f32_16x16x32_bf16 v[72:75], a[28:31], v[240:243], v[72:75]
    ds_read_b64_tr_b16 a[74:75], v8 offset:4832
    v_mfma_f32_16x16x32_bf16 v[72:75], a[32:35], v[244:247], v[72:75]
    buffer_store_dwordx4 v[32:35], v4, s[20:23], s62 offen offset:0 nt sc1
    ds_read_b64_tr_b16 a[76:77], v8 offset:8544
    v_mfma_f32_16x16x32_bf16 v[76:79], a[32:35], v[252:255], 0
    v_mfma_f32_16x16x32_bf16 v[76:79], a[28:31], v[248:251], v[76:79]
    ds_read_b64_tr_b16 a[78:79], v8 offset:9056
    v_mul_f32 v36, v36, v13
    v_mfma_f32_16x16x32_bf16 v[76:79], a[24:27], v[220:223], v[76:79]
    ds_read_b64_tr_b16 a[80:81], v8 offset:12768
    v_mul_f32 v37, v37, v13
    v_mfma_f32_16x16x32_bf16 v[76:79], a[20:23], v[216:219], v[76:79]
    v_mul_f32 v38, v38, v13
    v_mul_f32 v39, v39, v13
    v_mfma_f32_16x16x32_bf16 v[76:79], a[16:19], v[188:191], v[76:79]
    ds_read_b64_tr_b16 a[82:83], v8 offset:13280
    v_mul_f32 v52, v52, v13
    v_mfma_f32_16x16x32_bf16 v[76:79], a[12:15], v[184:187], v[76:79]
    ds_read_b64_tr_b16 a[84:85], v8 offset:16992
    v_mul_f32 v53, v53, v13
    v_mfma_f32_16x16x32_bf16 v[76:79], a[8:11], v[156:159], v[76:79]
    v_mul_f32 v54, v54, v13
    v_mfma_f32_16x16x32_bf16 v[76:79], a[4:7], v[152:155], v[76:79]
    ds_read_b64_tr_b16 a[86:87], v8 offset:17504
    v_mul_f32 v55, v55, v13
    v_mfma_f32_16x16x32_bf16 v[76:79], a[0:3], v[124:127], v[76:79]
    ds_read_b64_tr_b16 a[88:89], v8 offset:21216
    v_cvt_pk_bf16_f32 v36, v36, v37
    v_mfma_f32_16x16x32_bf16 v[76:79], a[248:251], v[120:123], v[76:79]
    v_cvt_pk_bf16_f32 v37, v38, v39
    v_cvt_pk_bf16_f32 v38, v52, v53
    v_mfma_f32_16x16x32_bf16 v[76:79], a[244:247], v[28:31], v[76:79]
    ds_read_b64_tr_b16 a[90:91], v8 offset:21728
    v_cvt_pk_bf16_f32 v39, v54, v55
    v_mfma_f32_16x16x32_bf16 v[76:79], a[240:243], v[24:27], v[76:79]
    v_permlane16_swap_b32 v36, v38
    v_mfma_f32_16x16x32_bf16 v[76:79], a[236:239], a[188:191], v[76:79]
    ds_read_b64_tr_b16 a[92:93], v8 offset:25440
    v_mfma_f32_16x16x32_bf16 v[76:79], a[232:235], a[184:187], v[76:79]
    v_permlane16_swap_b32 v37, v39
    v_mfma_f32_16x16x32_bf16 v[76:79], a[228:231], a[156:159], v[76:79]
    s_add_u32 s62, s54, s98
    ds_read_b64_tr_b16 a[94:95], v8 offset:25952
    v_mfma_f32_16x16x32_bf16 v[76:79], a[224:227], a[152:155], v[76:79]
    s_waitcnt lgkmcnt(15)
    ds_read_b64_tr_b16 a[96:97], v8 offset:29664
    v_mfma_f32_16x16x32_bf16 v[48:51], a[36:39], a[128:131], 0
    ds_read_b64_tr_b16 a[98:99], v8 offset:30176
    v_mfma_f32_16x16x32_bf16 v[48:51], a[40:43], a[132:135], v[48:51]
    buffer_store_dwordx4 v[36:39], v4, s[20:23], s62 offen offset:0 nt sc1
    v_mfma_f32_16x16x32_bf16 v[48:51], a[44:47], a[160:163], v[48:51]
    v_mul_f32 v40, v40, v14
    v_mfma_f32_16x16x32_bf16 v[48:51], a[48:51], a[164:167], v[48:51]
    v_mul_f32 v41, v41, v14
    v_mfma_f32_16x16x32_bf16 v[48:51], a[52:55], v[80:83], v[48:51]
    v_mul_f32 v42, v42, v14
    v_mfma_f32_16x16x32_bf16 v[48:51], a[56:59], v[84:87], v[48:51]
    v_mul_f32 v43, v43, v14
    v_mfma_f32_16x16x32_bf16 v[48:51], a[60:63], v[96:99], v[48:51]
    s_waitcnt lgkmcnt(10)
    v_mul_f32 v56, v56, v14
    v_mul_f32 v57, v57, v14
    v_mfma_f32_16x16x32_bf16 v[48:51], a[64:67], v[100:103], v[48:51]
    v_mul_f32 v58, v58, v14
    v_mfma_f32_16x16x32_bf16 v[48:51], a[68:71], v[128:131], v[48:51]
    v_mul_f32 v59, v59, v14
    v_mfma_f32_16x16x32_bf16 v[48:51], a[72:75], v[132:135], v[48:51]
    v_cvt_pk_bf16_f32 v40, v40, v41
    v_mfma_f32_16x16x32_bf16 v[48:51], a[76:79], v[160:163], v[48:51]
    s_waitcnt lgkmcnt(2)
    v_cvt_pk_bf16_f32 v41, v42, v43
    v_cvt_pk_bf16_f32 v42, v56, v57
    v_mfma_f32_16x16x32_bf16 v[48:51], a[80:83], v[164:167], v[48:51]
    v_cvt_pk_bf16_f32 v43, v58, v59
    v_mfma_f32_16x16x32_bf16 v[48:51], a[84:87], v[192:195], v[48:51]
    v_permlane16_swap_b32 v40, v42
    v_mfma_f32_16x16x32_bf16 v[48:51], a[88:91], v[196:199], v[48:51]
    v_mfma_f32_16x16x32_bf16 v[48:51], a[92:95], v[224:227], v[48:51]
    s_waitcnt lgkmcnt(0)
    v_permlane16_swap_b32 v41, v43
    v_mfma_f32_16x16x32_bf16 v[48:51], a[96:99], v[228:231], v[48:51]
    s_add_u32 s62, s55, s98
    v_mfma_f32_16x16x32_bf16 v[52:55], a[96:99], v[236:239], 0
    v_mfma_f32_16x16x32_bf16 v[52:55], a[92:95], v[232:235], v[52:55]
    v_mfma_f32_16x16x32_bf16 v[52:55], a[88:91], v[204:207], v[52:55]
    buffer_store_dwordx4 v[40:43], v4, s[20:23], s62 offen offset:0 nt sc1
    v_mfma_f32_16x16x32_bf16 v[52:55], a[84:87], v[200:203], v[52:55]
    s_waitcnt vmcnt(3)
    s_barrier
    ds_read_b64_tr_b16 a[100:101], v8 offset:33792
    v_mfma_f32_16x16x32_bf16 v[52:55], a[80:83], v[172:175], v[52:55]
    ds_read_b64_tr_b16 a[102:103], v8 offset:34304
    v_mul_f32 v44, v44, v15
    v_mfma_f32_16x16x32_bf16 v[52:55], a[76:79], v[168:171], v[52:55]
    ds_read_b64_tr_b16 a[104:105], v8 offset:38016
    v_mul_f32 v45, v45, v15
    v_mfma_f32_16x16x32_bf16 v[52:55], a[72:75], v[140:143], v[52:55]
    ds_read_b64_tr_b16 a[106:107], v8 offset:38528
    v_mul_f32 v46, v46, v15
    v_mfma_f32_16x16x32_bf16 v[52:55], a[68:71], v[136:139], v[52:55]
    ds_read_b64_tr_b16 a[108:109], v8 offset:42240
    v_mul_f32 v47, v47, v15
    v_mfma_f32_16x16x32_bf16 v[52:55], a[64:67], v[108:111], v[52:55]
    v_mul_f32 v60, v60, v15
    v_mul_f32 v61, v61, v15
    v_mfma_f32_16x16x32_bf16 v[52:55], a[60:63], v[104:107], v[52:55]
    ds_read_b64_tr_b16 a[110:111], v8 offset:42752
    v_mul_f32 v62, v62, v15
    v_mfma_f32_16x16x32_bf16 v[52:55], a[56:59], v[92:95], v[52:55]
    ds_read_b64_tr_b16 a[112:113], v8 offset:46464
    v_mul_f32 v63, v63, v15
    v_mfma_f32_16x16x32_bf16 v[52:55], a[52:55], v[88:91], v[52:55]
    v_cvt_pk_bf16_f32 v44, v44, v45
    v_cvt_pk_bf16_f32 v45, v46, v47
    v_mfma_f32_16x16x32_bf16 v[52:55], a[48:51], a[172:175], v[52:55]
    ds_read_b64_tr_b16 a[114:115], v8 offset:46976
    v_cvt_pk_bf16_f32 v46, v60, v61
    v_mfma_f32_16x16x32_bf16 v[52:55], a[44:47], a[168:171], v[52:55]
    ds_read_b64_tr_b16 a[116:117], v8 offset:50688
    v_cvt_pk_bf16_f32 v47, v62, v63
    v_mfma_f32_16x16x32_bf16 v[52:55], a[40:43], a[140:143], v[52:55]
    v_permlane16_swap_b32 v44, v46
    v_mfma_f32_16x16x32_bf16 v[52:55], a[36:39], a[136:139], v[52:55]
    ds_read_b64_tr_b16 a[118:119], v8 offset:51200
    v_mfma_f32_16x16x32_bf16 v[56:59], a[36:39], a[144:147], 0
    v_permlane16_swap_b32 v45, v47
    v_mfma_f32_16x16x32_bf16 v[56:59], a[40:43], a[148:151], v[56:59]
    s_add_u32 s62, s56, s98
    ds_read_b64_tr_b16 a[120:121], v8 offset:54912
    v_mfma_f32_16x16x32_bf16 v[56:59], a[44:47], a[176:179], v[56:59]
    ds_read_b64_tr_b16 a[122:123], v8 offset:55424
    v_mfma_f32_16x16x32_bf16 v[56:59], a[48:51], a[180:183], v[56:59]
    ds_read_b64_tr_b16 a[124:125], v8 offset:59136
    v_mfma_f32_16x16x32_bf16 v[56:59], a[52:55], v[16:19], v[56:59]
    buffer_store_dwordx4 v[44:47], v4, s[20:23], s62 offen offset:0 nt sc1
    v_mfma_f32_16x16x32_bf16 v[56:59], a[56:59], v[20:23], v[56:59]
    ds_read_b64_tr_b16 a[126:127], v8 offset:59648
    v_mfma_f32_16x16x32_bf16 v[56:59], a[60:63], v[112:115], v[56:59]
    ds_read_b64_tr_b16 a[224:225], v8 offset:63360
    v_mfma_f32_16x16x32_bf16 v[56:59], a[64:67], v[116:119], v[56:59]
    v_mfma_f32_16x16x32_bf16 v[56:59], a[68:71], v[144:147], v[56:59]
    ds_read_b64_tr_b16 a[226:227], v8 offset:63872
    v_mfma_f32_16x16x32_bf16 v[56:59], a[72:75], v[148:151], v[56:59]
    ds_read_b64_tr_b16 a[228:229], v11 offset:0
    v_mfma_f32_16x16x32_bf16 v[56:59], a[76:79], v[176:179], v[56:59]
    v_mfma_f32_16x16x32_bf16 v[56:59], a[80:83], v[180:183], v[56:59]
    ds_read_b64_tr_b16 a[230:231], v11 offset:512
    v_mfma_f32_16x16x32_bf16 v[56:59], a[84:87], v[208:211], v[56:59]
    ds_read_b64_tr_b16 a[232:233], v11 offset:4224
    v_mfma_f32_16x16x32_bf16 v[56:59], a[88:91], v[212:215], v[56:59]
    v_mfma_f32_16x16x32_bf16 v[56:59], a[92:95], v[240:243], v[56:59]
    ds_read_b64_tr_b16 a[234:235], v11 offset:4736
    v_mfma_f32_16x16x32_bf16 v[56:59], a[96:99], v[244:247], v[56:59]
    ds_read_b64_tr_b16 a[236:237], v11 offset:8448
    v_mfma_f32_16x16x32_bf16 v[60:63], a[96:99], v[252:255], 0
    v_mfma_f32_16x16x32_bf16 v[60:63], a[92:95], v[248:251], v[60:63]
    ds_read_b64_tr_b16 a[238:239], v11 offset:8960
    v_mfma_f32_16x16x32_bf16 v[60:63], a[88:91], v[220:223], v[60:63]
    ds_read_b64_tr_b16 a[240:241], v11 offset:12672
    v_mfma_f32_16x16x32_bf16 v[60:63], a[84:87], v[216:219], v[60:63]
    v_mfma_f32_16x16x32_bf16 v[60:63], a[80:83], v[188:191], v[60:63]
    ds_read_b64_tr_b16 a[242:243], v11 offset:13184
    v_mfma_f32_16x16x32_bf16 v[60:63], a[76:79], v[184:187], v[60:63]
    s_add_u32 s61, s48, s100
    ds_read_b64_tr_b16 a[244:245], v11 offset:16896
    v_mfma_f32_16x16x32_bf16 v[60:63], a[72:75], v[156:159], v[60:63]
    s_add_u32 m0, s30, 101376
    v_mfma_f32_16x16x32_bf16 v[60:63], a[68:71], v[152:155], v[60:63]
    ds_read_b64_tr_b16 a[246:247], v11 offset:17408
    v_mfma_f32_16x16x32_bf16 v[60:63], a[64:67], v[124:127], v[60:63]
    buffer_load_dwordx4 v2, s[16:19], s61 offen offset:0  lds
    v_mfma_f32_16x16x32_bf16 v[60:63], a[60:63], v[120:123], v[60:63]
    ds_read_b64_tr_b16 a[248:249], v11 offset:21120
    v_mfma_f32_16x16x32_bf16 v[60:63], a[56:59], v[28:31], v[60:63]
    s_add_u32 m0, s30, 101408
    ds_read_b64_tr_b16 a[250:251], v11 offset:21632
    v_mfma_f32_16x16x32_bf16 v[60:63], a[52:55], v[24:27], v[60:63]
    ds_read_b64_tr_b16 a[0:1], v11 offset:25344
    v_mfma_f32_16x16x32_bf16 v[60:63], a[48:51], a[188:191], v[60:63]
    buffer_load_dwordx4 v2, s[16:19], s61 offen offset:1024  lds
    v_mfma_f32_16x16x32_bf16 v[60:63], a[44:47], a[184:187], v[60:63]
    ds_read_b64_tr_b16 a[2:3], v11 offset:25856
    v_mfma_f32_16x16x32_bf16 v[60:63], a[40:43], a[156:159], v[60:63]
    ds_read_b64_tr_b16 a[4:5], v11 offset:29568
    v_mfma_f32_16x16x32_bf16 v[60:63], a[36:39], a[152:155], v[60:63]
    s_waitcnt lgkmcnt(15)
    v_mfma_f32_16x16x32_bf16 v[32:35], a[100:103], a[128:131], 0
    s_add_u32 m0, s30, 101440
    ds_read_b64_tr_b16 a[6:7], v11 offset:30080
    v_mfma_f32_16x16x32_bf16 v[32:35], a[104:107], a[132:135], v[32:35]
    buffer_load_dwordx4 v2, s[16:19], s61 offen offset:2048  lds
    v_mfma_f32_16x16x32_bf16 v[32:35], a[108:111], a[160:163], v[32:35]
    v_mul_f32 v64, v64, v12
    v_mfma_f32_16x16x32_bf16 v[32:35], a[112:115], a[164:167], v[32:35]
    s_add_u32 m0, s30, 101472
    v_mul_f32 v65, v65, v12
    v_mfma_f32_16x16x32_bf16 v[32:35], a[116:119], v[80:83], v[32:35]
    buffer_load_dwordx4 v2, s[16:19], s61 offen offset:3072  lds
    v_mfma_f32_16x16x32_bf16 v[32:35], a[120:123], v[84:87], v[32:35]
    v_mul_f32 v66, v66, v12
    v_mul_f32 v67, v67, v12
    v_mfma_f32_16x16x32_bf16 v[32:35], a[124:127], v[96:99], v[32:35]
    s_add_u32 s61, s49, s100
    v_mul_f32 v48, v48, v12
    v_mfma_f32_16x16x32_bf16 v[32:35], a[224:227], v[100:103], v[32:35]
    s_waitcnt lgkmcnt(8)
    v_mul_f32 v49, v49, v12
    v_mfma_f32_16x16x32_bf16 v[32:35], a[228:231], v[128:131], v[32:35]
    s_add_u32 m0, s30, 118272
    v_mul_f32 v50, v50, v12
    v_mfma_f32_16x16x32_bf16 v[32:35], a[232:235], v[132:135], v[32:35]
    buffer_load_dwordx4 v2, s[16:19], s61 offen offset:0  lds
    v_mfma_f32_16x16x32_bf16 v[32:35], a[236:239], v[160:163], v[32:35]
    v_mul_f32 v51, v51, v12
    v_mfma_f32_16x16x32_bf16 v[32:35], a[240:243], v[164:167], v[32:35]
    s_waitcnt lgkmcnt(0)
    v_cvt_pk_bf16_f32 v64, v64, v65
    v_mfma_f32_16x16x32_bf16 v[32:35], a[244:247], v[192:195], v[32:35]
    s_add_u32 m0, s30, 118304
    v_cvt_pk_bf16_f32 v65, v66, v67
    v_mfma_f32_16x16x32_bf16 v[32:35], a[248:251], v[196:199], v[32:35]
    buffer_load_dwordx4 v2, s[16:19], s61 offen offset:1024  lds
    v_mfma_f32_16x16x32_bf16 v[32:35], a[0:3], v[224:227], v[32:35]
    v_cvt_pk_bf16_f32 v66, v48, v49
    v_and_b32 v9, 24, v8
    v_mfma_f32_16x16x32_bf16 v[32:35], a[4:7], v[228:231], v[32:35]
    v_cvt_pk_bf16_f32 v67, v50, v51
    v_add_u32 v9, 152064, v9
    v_mfma_f32_16x16x32_bf16 v[36:39], a[4:7], v[236:239], 0
    s_add_u32 m0, s30, 118336
    v_permlane16_swap_b32 v64, v66
    v_mfma_f32_16x16x32_bf16 v[36:39], a[0:3], v[232:235], v[36:39]
    buffer_load_dwordx4 v2, s[16:19], s61 offen offset:2048  lds
    v_mfma_f32_16x16x32_bf16 v[36:39], a[248:251], v[204:207], v[36:39]
    ds_read_b32 v9, v9
    v_mfma_f32_16x16x32_bf16 v[36:39], a[244:247], v[200:203], v[36:39]
    v_permlane16_swap_b32 v65, v67
    v_mfma_f32_16x16x32_bf16 v[36:39], a[240:243], v[172:175], v[36:39]
    s_add_u32 s62, s53, s98
    ds_read_b64_tr_b16 a[8:9], v8 offset:33824
    v_mfma_f32_16x16x32_bf16 v[36:39], a[236:239], v[168:171], v[36:39]
    ds_read_b64_tr_b16 a[10:11], v8 offset:34336
    v_mfma_f32_16x16x32_bf16 v[36:39], a[232:235], v[140:143], v[36:39]
    ds_read_b64_tr_b16 a[12:13], v8 offset:38048
    v_mfma_f32_16x16x32_bf16 v[36:39], a[228:231], v[136:139], v[36:39]
    buffer_store_dwordx4 v[64:67], v4, s[20:23], s62 offen offset:64 nt sc1
    ds_read_b64_tr_b16 a[14:15], v8 offset:38560
    v_mfma_f32_16x16x32_bf16 v[36:39], a[224:227], v[108:111], v[36:39]
    ds_read_b64_tr_b16 a[16:17], v8 offset:42272
    v_mfma_f32_16x16x32_bf16 v[36:39], a[124:127], v[104:107], v[36:39]
    ds_read_b64_tr_b16 a[18:19], v8 offset:42784
    v_mfma_f32_16x16x32_bf16 v[36:39], a[120:123], v[92:95], v[36:39]
    ds_read_b64_tr_b16 a[20:21], v8 offset:46496
    v_mul_f32 v68, v68, v13
    v_mfma_f32_16x16x32_bf16 v[36:39], a[116:119], v[88:91], v[36:39]
    v_mfma_f32_16x16x32_bf16 v[36:39], a[112:115], a[172:175], v[36:39]
    ds_read_b64_tr_b16 a[22:23], v8 offset:47008
    v_mul_f32 v69, v69, v13
    v_mfma_f32_16x16x32_bf16 v[36:39], a[108:111], a[168:171], v[36:39]
    ds_read_b64_tr_b16 a[24:25], v8 offset:50720
    v_mul_f32 v70, v70, v13
    v_mfma_f32_16x16x32_bf16 v[36:39], a[104:107], a[140:143], v[36:39]
    v_mul_f32 v71, v71, v13
    v_mfma_f32_16x16x32_bf16 v[36:39], a[100:103], a[136:139], v[36:39]
    ds_read_b64_tr_b16 a[26:27], v8 offset:51232
    v_mul_f32 v52, v52, v13
    v_mfma_f32_16x16x32_bf16 v[40:43], a[100:103], a[144:147], 0
    ds_read_b64_tr_b16 a[28:29], v8 offset:54944
    v_mul_f32 v53, v53, v13
    v_mfma_f32_16x16x32_bf16 v[40:43], a[104:107], a[148:151], v[40:43]
    v_mul_f32 v54, v54, v13
    v_mfma_f32_16x16x32_bf16 v[40:43], a[108:111], a[176:179], v[40:43]
    ds_read_b64_tr_b16 a[30:31], v8 offset:55456
    v_mul_f32 v55, v55, v13
    v_mfma_f32_16x16x32_bf16 v[40:43], a[112:115], a[180:183], v[40:43]
    ds_read_b64_tr_b16 a[32:33], v8 offset:59168
    v_mfma_f32_16x16x32_bf16 v[40:43], a[116:119], v[16:19], v[40:43]
    v_cvt_pk_bf16_f32 v68, v68, v69
    v_mfma_f32_16x16x32_bf16 v[40:43], a[120:123], v[20:23], v[40:43]
    ds_read_b64_tr_b16 a[34:35], v8 offset:59680
    v_cvt_pk_bf16_f32 v69, v70, v71
    v_mfma_f32_16x16x32_bf16 v[40:43], a[124:127], v[112:115], v[40:43]
    ds_read_b64_tr_b16 a[36:37], v8 offset:63392
    v_cvt_pk_bf16_f32 v70, v52, v53
    v_mfma_f32_16x16x32_bf16 v[40:43], a[224:227], v[116:119], v[40:43]
    v_cvt_pk_bf16_f32 v71, v54, v55
    v_mfma_f32_16x16x32_bf16 v[40:43], a[228:231], v[144:147], v[40:43]
    ds_read_b64_tr_b16 a[38:39], v8 offset:63904
    v_mfma_f32_16x16x32_bf16 v[40:43], a[232:235], v[148:151], v[40:43]
    s_add_u32 m0, s30, 118368
    v_permlane16_swap_b32 v68, v70
    v_mfma_f32_16x16x32_bf16 v[40:43], a[236:239], v[176:179], v[40:43]
    ds_read_b64_tr_b16 a[40:41], v11 offset:32
    v_mfma_f32_16x16x32_bf16 v[40:43], a[240:243], v[180:183], v[40:43]
    buffer_load_dwordx4 v2, s[16:19], s61 offen offset:3072  lds
    v_mfma_f32_16x16x32_bf16 v[40:43], a[244:247], v[208:211], v[40:43]
    v_permlane16_swap_b32 v69, v71
    v_mfma_f32_16x16x32_bf16 v[40:43], a[248:251], v[212:215], v[40:43]
    s_add_u32 s62, s54, s98
    ds_read_b64_tr_b16 a[42:43], v11 offset:544
    v_mfma_f32_16x16x32_bf16 v[40:43], a[0:3], v[240:243], v[40:43]
    ds_read_b64_tr_b16 a[44:45], v11 offset:4256
    v_mfma_f32_16x16x32_bf16 v[40:43], a[4:7], v[244:247], v[40:43]
    ds_read_b64_tr_b16 a[46:47], v11 offset:4768
    v_mfma_f32_16x16x32_bf16 v[44:47], a[4:7], v[252:255], 0
    buffer_store_dwordx4 v[68:71], v4, s[20:23], s62 offen offset:64 nt sc1
    ds_read_b64_tr_b16 a[48:49], v11 offset:8480
    v_mfma_f32_16x16x32_bf16 v[44:47], a[0:3], v[248:251], v[44:47]
    ds_read_b64_tr_b16 a[50:51], v11 offset:8992
    v_mfma_f32_16x16x32_bf16 v[44:47], a[248:251], v[220:223], v[44:47]
    ds_read_b64_tr_b16 a[52:53], v11 offset:12704
    v_mfma_f32_16x16x32_bf16 v[44:47], a[244:247], v[216:219], v[44:47]
    v_mul_f32 v72, v72, v14
    v_mfma_f32_16x16x32_bf16 v[44:47], a[240:243], v[188:191], v[44:47]
    ds_read_b64_tr_b16 a[54:55], v11 offset:13216
    v_mfma_f32_16x16x32_bf16 v[44:47], a[236:239], v[184:187], v[44:47]
    ds_read_b64_tr_b16 a[56:57], v11 offset:16928
    v_mul_f32 v73, v73, v14
    v_mfma_f32_16x16x32_bf16 v[44:47], a[232:235], v[156:159], v[44:47]
    v_mul_f32 v74, v74, v14
    v_mfma_f32_16x16x32_bf16 v[44:47], a[228:231], v[152:155], v[44:47]
    ds_read_b64_tr_b16 a[58:59], v11 offset:17440
    v_mul_f32 v75, v75, v14
    v_mfma_f32_16x16x32_bf16 v[44:47], a[224:227], v[124:127], v[44:47]
    ds_read_b64_tr_b16 a[60:61], v11 offset:21152
    v_mul_f32 v56, v56, v14
    v_mfma_f32_16x16x32_bf16 v[44:47], a[124:127], v[120:123], v[44:47]
    v_mul_f32 v57, v57, v14
    v_mfma_f32_16x16x32_bf16 v[44:47], a[120:123], v[28:31], v[44:47]
    ds_read_b64_tr_b16 a[62:63], v11 offset:21664
    v_mul_f32 v58, v58, v14
    v_mfma_f32_16x16x32_bf16 v[44:47], a[116:119], v[24:27], v[44:47]
    ds_read_b64_tr_b16 a[64:65], v11 offset:25376
    v_mul_f32 v59, v59, v14
    v_mfma_f32_16x16x32_bf16 v[44:47], a[112:115], a[188:191], v[44:47]
    v_mfma_f32_16x16x32_bf16 v[44:47], a[108:111], a[184:187], v[44:47]
    ds_read_b64_tr_b16 a[66:67], v11 offset:25888
    v_cvt_pk_bf16_f32 v72, v72, v73
    v_mfma_f32_16x16x32_bf16 v[44:47], a[104:107], a[156:159], v[44:47]
    ds_read_b64_tr_b16 a[68:69], v11 offset:29600
    v_cvt_pk_bf16_f32 v73, v74, v75
    v_mfma_f32_16x16x32_bf16 v[44:47], a[100:103], a[152:155], v[44:47]
    s_waitcnt lgkmcnt(15)
    v_cvt_pk_bf16_f32 v74, v56, v57
    v_mfma_f32_16x16x32_bf16 v[48:51], a[8:11], a[128:131], 0
    ds_read_b64_tr_b16 a[70:71], v11 offset:30112
    v_cvt_pk_bf16_f32 v75, v58, v59
    v_mfma_f32_16x16x32_bf16 v[48:51], a[12:15], a[132:135], v[48:51]
    s_add_u32 s61, s50, s100
    v_permlane16_swap_b32 v72, v74
    v_mfma_f32_16x16x32_bf16 v[48:51], a[16:19], a[160:163], v[48:51]
    s_add_u32 m0, s30, 135168
    v_mfma_f32_16x16x32_bf16 v[48:51], a[20:23], a[164:167], v[48:51]
    v_permlane16_swap_b32 v73, v75
    v_mfma_f32_16x16x32_bf16 v[48:51], a[24:27], v[80:83], v[48:51]
    buffer_load_dwordx4 v2, s[16:19], s61 offen offset:0  lds
    v_mfma_f32_16x16x32_bf16 v[48:51], a[28:31], v[84:87], v[48:51]
    v_cmp_lt_u32 vcc, s59, v9
    v_mfma_f32_16x16x32_bf16 v[48:51], a[32:35], v[96:99], v[48:51]
    s_add_u32 s62, s55, s98
    v_mfma_f32_16x16x32_bf16 v[48:51], a[36:39], v[100:103], v[48:51]
    s_waitcnt lgkmcnt(8)
    v_mfma_f32_16x16x32_bf16 v[48:51], a[40:43], v[128:131], v[48:51]
    s_cmp_lg_u64 vcc, 0
    s_cbranch_scc1 L_fallback
    v_mfma_f32_16x16x32_bf16 v[48:51], a[44:47], v[132:135], v[48:51]
    buffer_store_dwordx4 v[72:75], v4, s[20:23], s62 offen offset:64 nt sc1
    v_mfma_f32_16x16x32_bf16 v[48:51], a[48:51], v[160:163], v[48:51]
    v_mfma_f32_16x16x32_bf16 v[48:51], a[52:55], v[164:167], v[48:51]
    s_waitcnt lgkmcnt(0)
    v_mfma_f32_16x16x32_bf16 v[48:51], a[56:59], v[192:195], v[48:51]
    v_mul_f32 v76, v76, v15
    v_mfma_f32_16x16x32_bf16 v[48:51], a[60:63], v[196:199], v[48:51]
    v_mfma_f32_16x16x32_bf16 v[48:51], a[64:67], v[224:227], v[48:51]
    v_mul_f32 v77, v77, v15
    v_mfma_f32_16x16x32_bf16 v[48:51], a[68:71], v[228:231], v[48:51]
    v_mul_f32 v78, v78, v15
    v_mfma_f32_16x16x32_bf16 v[52:55], a[68:71], v[236:239], 0
    v_mul_f32 v79, v79, v15
    v_mfma_f32_16x16x32_bf16 v[52:55], a[64:67], v[232:235], v[52:55]
    ds_read_b64_tr_b16 a[72:73], v8 offset:33856
    v_mul_f32 v60, v60, v15
    v_mfma_f32_16x16x32_bf16 v[52:55], a[60:63], v[204:207], v[52:55]
    v_mul_f32 v61, v61, v15
    v_mfma_f32_16x16x32_bf16 v[52:55], a[56:59], v[200:203], v[52:55]
    ds_read_b64_tr_b16 a[74:75], v8 offset:34368
    v_mul_f32 v62, v62, v15
    v_mfma_f32_16x16x32_bf16 v[52:55], a[52:55], v[172:175], v[52:55]
    ds_read_b64_tr_b16 a[76:77], v8 offset:38080
    v_mul_f32 v63, v63, v15
    v_mfma_f32_16x16x32_bf16 v[52:55], a[48:51], v[168:171], v[52:55]
L_pg7:
    s_cbranch_execz L_warm_done
    v_mfma_f32_16x16x32_bf16 v[52:55], a[44:47], v[140:143], v[52:55]
    ds_read_b64_tr_b16 a[78:79], v8 offset:38592
    v_cvt_pk_bf16_f32 v76, v76, v77
    v_mfma_f32_16x16x32_bf16 v[52:55], a[40:43], v[136:139], v[52:55]
    ds_read_b64_tr_b16 a[80:81], v8 offset:42304
    v_cvt_pk_bf16_f32 v77, v78, v79
    v_mfma_f32_16x16x32_bf16 v[52:55], a[36:39], v[108:111], v[52:55]
    v_cvt_pk_bf16_f32 v78, v60, v61
    v_mfma_f32_16x16x32_bf16 v[52:55], a[32:35], v[104:107], v[52:55]
    ds_read_b64_tr_b16 a[82:83], v8 offset:42816
    v_cvt_pk_bf16_f32 v79, v62, v63
    v_mfma_f32_16x16x32_bf16 v[52:55], a[28:31], v[92:95], v[52:55]
    v_permlane16_swap_b32 v76, v78
    v_mfma_f32_16x16x32_bf16 v[52:55], a[24:27], v[88:91], v[52:55]
    s_add_u32 m0, s30, 135200
    ds_read_b64_tr_b16 a[84:85], v8 offset:46528
    v_mfma_f32_16x16x32_bf16 v[52:55], a[20:23], a[172:175], v[52:55]
    ds_read_b64_tr_b16 a[86:87], v8 offset:47040
    v_mfma_f32_16x16x32_bf16 v[52:55], a[16:19], a[168:171], v[52:55]
    buffer_load_dwordx4 v2, s[16:19], s61 offen offset:1024  lds
    v_mfma_f32_16x16x32_bf16 v[52:55], a[12:15], a[140:143], v[52:55]
    v_permlane16_swap_b32 v77, v79
    v_mfma_f32_16x16x32_bf16 v[52:55], a[8:11], a[136:139], v[52:55]
    s_add_u32 s62, s56, s98
    ds_read_b64_tr_b16 a[88:89], v8 offset:50752
    v_mfma_f32_16x16x32_bf16 v[56:59], a[8:11], a[144:147], 0
    ds_read_b64_tr_b16 a[90:91], v8 offset:51264
    v_mfma_f32_16x16x32_bf16 v[56:59], a[12:15], a[148:151], v[56:59]
    ds_read_b64_tr_b16 a[92:93], v8 offset:54976
    v_mfma_f32_16x16x32_bf16 v[56:59], a[16:19], a[176:179], v[56:59]
    buffer_store_dwordx4 v[76:79], v4, s[20:23], s62 offen offset:64 nt sc1
    ds_read_b64_tr_b16 a[94:95], v8 offset:55488
    v_mfma_f32_16x16x32_bf16 v[56:59], a[20:23], a[180:183], v[56:59]
    ds_read_b64_tr_b16 a[96:97], v8 offset:59200
    v_mfma_f32_16x16x32_bf16 v[56:59], a[24:27], v[16:19], v[56:59]
    v_mfma_f32_16x16x32_bf16 v[56:59], a[28:31], v[20:23], v[56:59]
    ds_read_b64_tr_b16 a[98:99], v8 offset:59712
    v_mfma_f32_16x16x32_bf16 v[56:59], a[32:35], v[112:115], v[56:59]
    ds_read_b64_tr_b16 a[100:101], v8 offset:63424
    v_mfma_f32_16x16x32_bf16 v[56:59], a[36:39], v[116:119], v[56:59]
    v_mfma_f32_16x16x32_bf16 v[56:59], a[40:43], v[144:147], v[56:59]
    ds_read_b64_tr_b16 a[102:103], v8 offset:63936
    v_mfma_f32_16x16x32_bf16 v[56:59], a[44:47], v[148:151], v[56:59]
    ds_read_b64_tr_b16 a[104:105], v11 offset:64
    v_mfma_f32_16x16x32_bf16 v[56:59], a[48:51], v[176:179], v[56:59]
    v_mfma_f32_16x16x32_bf16 v[56:59], a[52:55], v[180:183], v[56:59]
    ds_read_b64_tr_b16 a[106:107], v11 offset:576
    v_mfma_f32_16x16x32_bf16 v[56:59], a[56:59], v[208:211], v[56:59]
    ds_read_b64_tr_b16 a[108:109], v11 offset:4288
    v_mfma_f32_16x16x32_bf16 v[56:59], a[60:63], v[212:215], v[56:59]
    v_mfma_f32_16x16x32_bf16 v[56:59], a[64:67], v[240:243], v[56:59]
    ds_read_b64_tr_b16 a[110:111], v11 offset:4800
    v_mfma_f32_16x16x32_bf16 v[56:59], a[68:71], v[244:247], v[56:59]
    ds_read_b64_tr_b16 a[112:113], v11 offset:8512
    v_mfma_f32_16x16x32_bf16 v[60:63], a[68:71], v[252:255], 0
    v_mfma_f32_16x16x32_bf16 v[60:63], a[64:67], v[248:251], v[60:63]
    ds_read_b64_tr_b16 a[114:115], v11 offset:9024
    v_mfma_f32_16x16x32_bf16 v[60:63], a[60:63], v[220:223], v[60:63]
    ds_read_b64_tr_b16 a[116:117], v11 offset:12736
    v_mfma_f32_16x16x32_bf16 v[60:63], a[56:59], v[216:219], v[60:63]
    v_mfma_f32_16x16x32_bf16 v[60:63], a[52:55], v[188:191], v[60:63]
    s_add_u32 m0, s30, 135232
    ds_read_b64_tr_b16 a[118:119], v11 offset:13248
    v_mfma_f32_16x16x32_bf16 v[60:63], a[48:51], v[184:187], v[60:63]
    ds_read_b64_tr_b16 a[120:121], v11 offset:16960
    v_mfma_f32_16x16x32_bf16 v[60:63], a[44:47], v[156:159], v[60:63]
    buffer_load_dwordx4 v2, s[16:19], s61 offen offset:2048  lds
    v_mfma_f32_16x16x32_bf16 v[60:63], a[40:43], v[152:155], v[60:63]
    ds_read_b64_tr_b16 a[122:123], v11 offset:17472
    v_mfma_f32_16x16x32_bf16 v[60:63], a[36:39], v[124:127], v[60:63]
    s_add_u32 m0, s30, 135264
    ds_read_b64_tr_b16 a[124:125], v11 offset:21184
    v_mfma_f32_16x16x32_bf16 v[60:63], a[32:35], v[120:123], v[60:63]
    v_mfma_f32_16x16x32_bf16 v[60:63], a[28:31], v[28:31], v[60:63]
    buffer_load_dwordx4 v2, s[16:19], s61 offen offset:3072  lds
    v_mfma_f32_16x16x32_bf16 v[60:63], a[24:27], v[24:27], v[60:63]
    ds_read_b64_tr_b16 a[126:127], v11 offset:21696
    v_mfma_f32_16x16x32_bf16 v[60:63], a[20:23], a[188:191], v[60:63]
    s_add_u32 s61, s51, s100
    ds_read_b64_tr_b16 a[224:225], v11 offset:25408
    v_mfma_f32_16x16x32_bf16 v[60:63], a[16:19], a[184:187], v[60:63]
    s_add_u32 m0, s30, 0
    ds_read_b64_tr_b16 a[226:227], v11 offset:25920
    v_mfma_f32_16x16x32_bf16 v[60:63], a[12:15], a[156:159], v[60:63]
    buffer_load_dwordx4 v2, s[16:19], s61 offen offset:0  lds
    v_mfma_f32_16x16x32_bf16 v[60:63], a[8:11], a[152:155], v[60:63]
    s_waitcnt lgkmcnt(15)
    ds_read_b64_tr_b16 a[228:229], v11 offset:29632
    v_mfma_f32_16x16x32_bf16 v[64:67], a[72:75], a[128:131], 0
    ds_read_b64_tr_b16 a[230:231], v11 offset:30144
    v_mfma_f32_16x16x32_bf16 v[64:67], a[76:79], a[132:135], v[64:67]
    s_add_u32 m0, s30, 32
    v_mul_f32 v32, v32, v12
    v_mfma_f32_16x16x32_bf16 v[64:67], a[80:83], a[160:163], v[64:67]
    buffer_load_dwordx4 v2, s[16:19], s61 offen offset:1024  lds
    v_mfma_f32_16x16x32_bf16 v[64:67], a[84:87], a[164:167], v[64:67]
    v_mul_f32 v33, v33, v12
    v_mfma_f32_16x16x32_bf16 v[64:67], a[88:91], v[80:83], v[64:67]
    v_mul_f32 v34, v34, v12
    v_mfma_f32_16x16x32_bf16 v[64:67], a[92:95], v[84:87], v[64:67]
    s_add_u32 m0, s30, 64
    v_mul_f32 v35, v35, v12
    v_mfma_f32_16x16x32_bf16 v[64:67], a[96:99], v[96:99], v[64:67]
    s_waitcnt lgkmcnt(10)
    v_mul_f32 v48, v48, v12
    v_mfma_f32_16x16x32_bf16 v[64:67], a[100:103], v[100:103], v[64:67]
    buffer_load_dwordx4 v2, s[16:19], s61 offen offset:2048  lds
    v_mfma_f32_16x16x32_bf16 v[64:67], a[104:107], v[128:131], v[64:67]
    v_mul_f32 v49, v49, v12
    v_mul_f32 v50, v50, v12
    v_mfma_f32_16x16x32_bf16 v[64:67], a[108:111], v[132:135], v[64:67]
    s_add_u32 m0, s30, 96
    v_mul_f32 v51, v51, v12
    v_mfma_f32_16x16x32_bf16 v[64:67], a[112:115], v[160:163], v[64:67]
    s_waitcnt lgkmcnt(2)
    v_mfma_f32_16x16x32_bf16 v[64:67], a[116:119], v[164:167], v[64:67]
    buffer_load_dwordx4 v2, s[16:19], s61 offen offset:3072  lds
    v_mfma_f32_16x16x32_bf16 v[64:67], a[120:123], v[192:195], v[64:67]
    v_cvt_pk_bf16_f32 v32, v32, v33
    v_cvt_pk_bf16_f32 v33, v34, v35
    v_mfma_f32_16x16x32_bf16 v[64:67], a[124:127], v[196:199], v[64:67]
    v_cvt_pk_bf16_f32 v34, v48, v49
    v_mfma_f32_16x16x32_bf16 v[64:67], a[224:227], v[224:227], v[64:67]
    s_waitcnt lgkmcnt(0)
    v_cvt_pk_bf16_f32 v35, v50, v51
    v_mfma_f32_16x16x32_bf16 v[64:67], a[228:231], v[228:231], v[64:67]
    v_permlane16_swap_b32 v32, v34
    v_mfma_f32_16x16x32_bf16 v[68:71], a[228:231], v[236:239], 0
    v_mfma_f32_16x16x32_bf16 v[68:71], a[224:227], v[232:235], v[68:71]
    v_permlane16_swap_b32 v33, v35
    v_mfma_f32_16x16x32_bf16 v[68:71], a[124:127], v[204:207], v[68:71]
    ds_read_b64_tr_b16 a[232:233], v8 offset:33888
    v_mfma_f32_16x16x32_bf16 v[68:71], a[120:123], v[200:203], v[68:71]
    ds_read_b64_tr_b16 a[234:235], v8 offset:34400
    v_mfma_f32_16x16x32_bf16 v[68:71], a[116:119], v[172:175], v[68:71]
    s_add_u32 s62, s53, s99
    ds_read_b64_tr_b16 a[236:237], v8 offset:38112
    v_mfma_f32_16x16x32_bf16 v[68:71], a[112:115], v[168:171], v[68:71]
    v_mfma_f32_16x16x32_bf16 v[68:71], a[108:111], v[140:143], v[68:71]
    ds_read_b64_tr_b16 a[238:239], v8 offset:38624
    v_mfma_f32_16x16x32_bf16 v[68:71], a[104:107], v[136:139], v[68:71]
    buffer_store_dwordx4 v[32:35], v4, s[20:23], s62 offen offset:0 nt sc1
    ds_read_b64_tr_b16 a[240:241], v8 offset:42336
    v_mfma_f32_16x16x32_bf16 v[68:71], a[100:103], v[108:111], v[68:71]
    v_mfma_f32_16x16x32_bf16 v[68:71], a[96:99], v[104:107], v[68:71]
    ds_read_b64_tr_b16 a[242:243], v8 offset:42848
    v_mfma_f32_16x16x32_bf16 v[68:71], a[92:95], v[92:95], v[68:71]
    ds_read_b64_tr_b16 a[244:245], v8 offset:46560
    v_mul_f32 v36, v36, v13
    v_mfma_f32_16x16x32_bf16 v[68:71], a[88:91], v[88:91], v[68:71]
    v_mfma_f32_16x16x32_bf16 v[68:71], a[84:87], a[172:175], v[68:71]
    ds_read_b64_tr_b16 a[246:247], v8 offset:47072
    v_mul_f32 v37, v37, v13
    v_mfma_f32_16x16x32_bf16 v[68:71], a[80:83], a[168:171], v[68:71]
    ds_read_b64_tr_b16 a[248:249], v8 offset:50784
    v_mul_f32 v38, v38, v13
    v_mfma_f32_16x16x32_bf16 v[68:71], a[76:79], a[140:143], v[68:71]
    v_mul_f32 v39, v39, v13
    v_mfma_f32_16x16x32_bf16 v[68:71], a[72:75], a[136:139], v[68:71]
    ds_read_b64_tr_b16 a[250:251], v8 offset:51296
    v_mul_f32 v52, v52, v13
    v_mfma_f32_16x16x32_bf16 v[72:75], a[72:75], a[144:147], 0
    ds_read_b64_tr_b16 a[0:1], v8 offset:55008
    v_mul_f32 v53, v53, v13
    v_mfma_f32_16x16x32_bf16 v[72:75], a[76:79], a[148:151], v[72:75]
    v_mul_f32 v54, v54, v13
    v_mfma_f32_16x16x32_bf16 v[72:75], a[80:83], a[176:179], v[72:75]
    ds_read_b64_tr_b16 a[2:3], v8 offset:55520
    v_mul_f32 v55, v55, v13
    v_mfma_f32_16x16x32_bf16 v[72:75], a[84:87], a[180:183], v[72:75]
    ds_read_b64_tr_b16 a[4:5], v8 offset:59232
    v_mfma_f32_16x16x32_bf16 v[72:75], a[88:91], v[16:19], v[72:75]
    v_cvt_pk_bf16_f32 v36, v36, v37
    v_mfma_f32_16x16x32_bf16 v[72:75], a[92:95], v[20:23], v[72:75]
    ds_read_b64_tr_b16 a[6:7], v8 offset:59744
    v_cvt_pk_bf16_f32 v37, v38, v39
    v_mfma_f32_16x16x32_bf16 v[72:75], a[96:99], v[112:115], v[72:75]
    ds_read_b64_tr_b16 a[8:9], v8 offset:63456
    v_cvt_pk_bf16_f32 v38, v52, v53
    v_mfma_f32_16x16x32_bf16 v[72:75], a[100:103], v[116:119], v[72:75]
    v_cvt_pk_bf16_f32 v39, v54, v55
    v_mfma_f32_16x16x32_bf16 v[72:75], a[104:107], v[144:147], v[72:75]
    ds_read_b64_tr_b16 a[10:11], v8 offset:63968
    v_mfma_f32_16x16x32_bf16 v[72:75], a[108:111], v[148:151], v[72:75]
    v_permlane16_swap_b32 v36, v38
    v_mfma_f32_16x16x32_bf16 v[72:75], a[112:115], v[176:179], v[72:75]
    ds_read_b64_tr_b16 a[12:13], v11 offset:96
    v_mfma_f32_16x16x32_bf16 v[72:75], a[116:119], v[180:183], v[72:75]
    v_permlane16_swap_b32 v37, v39
    v_mfma_f32_16x16x32_bf16 v[72:75], a[120:123], v[208:211], v[72:75]
    ds_read_b64_tr_b16 a[14:15], v11 offset:608
    v_mfma_f32_16x16x32_bf16 v[72:75], a[124:127], v[212:215], v[72:75]
    s_add_u32 s62, s54, s99
    ds_read_b64_tr_b16 a[16:17], v11 offset:4320
    v_mfma_f32_16x16x32_bf16 v[72:75], a[224:227], v[240:243], v[72:75]
    ds_read_b64_tr_b16 a[18:19], v11 offset:4832
    v_mfma_f32_16x16x32_bf16 v[72:75], a[228:231], v[244:247], v[72:75]
    ds_read_b64_tr_b16 a[20:21], v11 offset:8544
    v_mfma_f32_16x16x32_bf16 v[76:79], a[228:231], v[252:255], 0
    buffer_store_dwordx4 v[36:39], v4, s[20:23], s62 offen offset:0 nt sc1
    v_mfma_f32_16x16x32_bf16 v[76:79], a[224:227], v[248:251], v[76:79]
    ds_read_b64_tr_b16 a[22:23], v11 offset:9056
    v_mfma_f32_16x16x32_bf16 v[76:79], a[124:127], v[220:223], v[76:79]
    ds_read_b64_tr_b16 a[24:25], v11 offset:12768
    v_mfma_f32_16x16x32_bf16 v[76:79], a[120:123], v[216:219], v[76:79]
    v_mul_f32 v40, v40, v14
    v_mfma_f32_16x16x32_bf16 v[76:79], a[116:119], v[188:191], v[76:79]
    ds_read_b64_tr_b16 a[26:27], v11 offset:13280
    v_mfma_f32_16x16x32_bf16 v[76:79], a[112:115], v[184:187], v[76:79]
    ds_read_b64_tr_b16 a[28:29], v11 offset:16992
    v_mul_f32 v41, v41, v14
    v_mfma_f32_16x16x32_bf16 v[76:79], a[108:111], v[156:159], v[76:79]
    v_mul_f32 v42, v42, v14
    v_mfma_f32_16x16x32_bf16 v[76:79], a[104:107], v[152:155], v[76:79]
    ds_read_b64_tr_b16 a[30:31], v11 offset:17504
    v_mul_f32 v43, v43, v14
    v_mfma_f32_16x16x32_bf16 v[76:79], a[100:103], v[124:127], v[76:79]
    ds_read_b64_tr_b16 a[32:33], v11 offset:21216
    v_mul_f32 v56, v56, v14
    v_mfma_f32_16x16x32_bf16 v[76:79], a[96:99], v[120:123], v[76:79]
    v_mul_f32 v57, v57, v14
    v_mfma_f32_16x16x32_bf16 v[76:79], a[92:95], v[28:31], v[76:79]
    ds_read_b64_tr_b16 a[34:35], v11 offset:21728
    v_mul_f32 v58, v58, v14
    v_mfma_f32_16x16x32_bf16 v[76:79], a[88:91], v[24:27], v[76:79]
    ds_read_b64_tr_b16 a[36:37], v11 offset:25440
    v_mul_f32 v59, v59, v14
    v_mfma_f32_16x16x32_bf16 v[76:79], a[84:87], a[188:191], v[76:79]
    v_mfma_f32_16x16x32_bf16 v[76:79], a[80:83], a[184:187], v[76:79]
    ds_read_b64_tr_b16 a[38:39], v11 offset:25952
    v_cvt_pk_bf16_f32 v40, v40, v41
    v_mfma_f32_16x16x32_bf16 v[76:79], a[76:79], a[156:159], v[76:79]
    ds_read_b64_tr_b16 a[40:41], v11 offset:29664
    v_cvt_pk_bf16_f32 v41, v42, v43
    v_mfma_f32_16x16x32_bf16 v[76:79], a[72:75], a[152:155], v[76:79]
    s_waitcnt lgkmcnt(15)
    v_cvt_pk_bf16_f32 v42, v56, v57
    v_mfma_f32_16x16x32_bf16 v[48:51], a[232:235], a[128:131], 0
    ds_read_b64_tr_b16 a[42:43], v11 offset:30176
    v_cvt_pk_bf16_f32 v43, v58, v59
    v_mfma_f32_16x16x32_bf16 v[48:51], a[236:239], a[132:135], v[48:51]
    v_permlane16_swap_b32 v40, v42
    v_mfma_f32_16x16x32_bf16 v[48:51], a[240:243], a[160:163], v[48:51]
    v_mfma_f32_16x16x32_bf16 v[48:51], a[244:247], a[164:167], v[48:51]
    v_permlane16_swap_b32 v41, v43
    v_mfma_f32_16x16x32_bf16 v[48:51], a[248:251], v[80:83], v[48:51]
    v_mfma_f32_16x16x32_bf16 v[48:51], a[0:3], v[84:87], v[48:51]
    v_mfma_f32_16x16x32_bf16 v[48:51], a[4:7], v[96:99], v[48:51]
    s_add_u32 s62, s55, s99
    v_mfma_f32_16x16x32_bf16 v[48:51], a[8:11], v[100:103], v[48:51]
    s_waitcnt lgkmcnt(8)
    v_mfma_f32_16x16x32_bf16 v[48:51], a[12:15], v[128:131], v[48:51]
    v_mfma_f32_16x16x32_bf16 v[48:51], a[16:19], v[132:135], v[48:51]
    buffer_store_dwordx4 v[40:43], v4, s[20:23], s62 offen offset:0 nt sc1
    v_mfma_f32_16x16x32_bf16 v[48:51], a[20:23], v[160:163], v[48:51]
    v_mfma_f32_16x16x32_bf16 v[48:51], a[24:27], v[164:167], v[48:51]
    s_waitcnt lgkmcnt(0)
    v_mfma_f32_16x16x32_bf16 v[48:51], a[28:31], v[192:195], v[48:51]
    v_mul_f32 v44, v44, v15
    v_mfma_f32_16x16x32_bf16 v[48:51], a[32:35], v[196:199], v[48:51]
    v_mfma_f32_16x16x32_bf16 v[48:51], a[36:39], v[224:227], v[48:51]
    v_mul_f32 v45, v45, v15
    v_mfma_f32_16x16x32_bf16 v[48:51], a[40:43], v[228:231], v[48:51]
    v_mul_f32 v46, v46, v15
    v_mfma_f32_16x16x32_bf16 v[52:55], a[40:43], v[236:239], 0
    v_mul_f32 v47, v47, v15
    v_mfma_f32_16x16x32_bf16 v[52:55], a[36:39], v[232:235], v[52:55]
    v_mul_f32 v60, v60, v15
    v_mfma_f32_16x16x32_bf16 v[52:55], a[32:35], v[204:207], v[52:55]
    v_mul_f32 v61, v61, v15
    v_mfma_f32_16x16x32_bf16 v[52:55], a[28:31], v[200:203], v[52:55]
    s_waitcnt vmcnt(3)
    s_barrier
    ds_read_b64_tr_b16 a[44:45], v11 offset:33792
    v_mfma_f32_16x16x32_bf16 v[52:55], a[24:27], v[172:175], v[52:55]
    ds_read_b64_tr_b16 a[46:47], v11 offset:34304
    v_mul_f32 v62, v62, v15
    v_mfma_f32_16x16x32_bf16 v[52:55], a[20:23], v[168:171], v[52:55]
    ds_read_b64_tr_b16 a[48:49], v11 offset:38016
    v_mul_f32 v63, v63, v15
    v_mfma_f32_16x16x32_bf16 v[52:55], a[16:19], v[140:143], v[52:55]
    ds_read_b64_tr_b16 a[50:51], v11 offset:38528
    v_cvt_pk_bf16_f32 v44, v44, v45
    v_mfma_f32_16x16x32_bf16 v[52:55], a[12:15], v[136:139], v[52:55]
    ds_read_b64_tr_b16 a[52:53], v11 offset:42240
    v_cvt_pk_bf16_f32 v45, v46, v47
    v_mfma_f32_16x16x32_bf16 v[52:55], a[8:11], v[108:111], v[52:55]
    v_cvt_pk_bf16_f32 v46, v60, v61
    v_mfma_f32_16x16x32_bf16 v[52:55], a[4:7], v[104:107], v[52:55]
    ds_read_b64_tr_b16 a[54:55], v11 offset:42752
    v_cvt_pk_bf16_f32 v47, v62, v63
    v_mfma_f32_16x16x32_bf16 v[52:55], a[0:3], v[92:95], v[52:55]
    s_add_u32 s61, s48, s101
    v_permlane16_swap_b32 v44, v46
    v_mfma_f32_16x16x32_bf16 v[52:55], a[248:251], v[88:91], v[52:55]
    s_add_u32 m0, s30, 16896
    ds_read_b64_tr_b16 a[56:57], v11 offset:46464
    v_mfma_f32_16x16x32_bf16 v[52:55], a[244:247], a[172:175], v[52:55]
    ds_read_b64_tr_b16 a[58:59], v11 offset:46976
    v_mfma_f32_16x16x32_bf16 v[52:55], a[240:243], a[168:171], v[52:55]
    buffer_load_dwordx4 v2, s[16:19], s61 offen offset:0  lds
    v_mfma_f32_16x16x32_bf16 v[52:55], a[236:239], a[140:143], v[52:55]
    v_permlane16_swap_b32 v45, v47
    v_mfma_f32_16x16x32_bf16 v[52:55], a[232:235], a[136:139], v[52:55]
    s_add_u32 s62, s56, s99
    ds_read_b64_tr_b16 a[60:61], v11 offset:50688
    v_mfma_f32_16x16x32_bf16 v[56:59], a[232:235], a[144:147], 0
    ds_read_b64_tr_b16 a[62:63], v11 offset:51200
    v_mfma_f32_16x16x32_bf16 v[56:59], a[236:239], a[148:151], v[56:59]
    ds_read_b64_tr_b16 a[64:65], v11 offset:54912
    v_mfma_f32_16x16x32_bf16 v[56:59], a[240:243], a[176:179], v[56:59]
    buffer_store_dwordx4 v[44:47], v4, s[20:23], s62 offen offset:0 nt sc1
    ds_read_b64_tr_b16 a[66:67], v11 offset:55424
    v_mfma_f32_16x16x32_bf16 v[56:59], a[244:247], a[180:183], v[56:59]
    ds_read_b64_tr_b16 a[68:69], v11 offset:59136
    v_mfma_f32_16x16x32_bf16 v[56:59], a[248:251], v[16:19], v[56:59]
    v_mfma_f32_16x16x32_bf16 v[56:59], a[0:3], v[20:23], v[56:59]
    ds_read_b64_tr_b16 a[70:71], v11 offset:59648
    v_mfma_f32_16x16x32_bf16 v[56:59], a[4:7], v[112:115], v[56:59]
    ds_read_b64_tr_b16 a[72:73], v11 offset:63360
    v_mfma_f32_16x16x32_bf16 v[56:59], a[8:11], v[116:119], v[56:59]
    v_mfma_f32_16x16x32_bf16 v[56:59], a[12:15], v[144:147], v[56:59]
    ds_read_b64_tr_b16 a[74:75], v11 offset:63872
    v_mfma_f32_16x16x32_bf16 v[56:59], a[16:19], v[148:151], v[56:59]
    ds_read_b64_tr_b16 a[76:77], v0 offset:0
    v_mfma_f32_16x16x32_bf16 v[56:59], a[20:23], v[176:179], v[56:59]
    v_mfma_f32_16x16x32_bf16 v[56:59], a[24:27], v[180:183], v[56:59]
    ds_read_b64_tr_b16 a[78:79], v0 offset:512
    v_mfma_f32_16x16x32_bf16 v[56:59], a[28:31], v[208:211], v[56:59]
    ds_read_b64_tr_b16 a[80:81], v0 offset:4224
    v_mfma_f32_16x16x32_bf16 v[56:59], a[32:35], v[212:215], v[56:59]
    v_mfma_f32_16x16x32_bf16 v[56:59], a[36:39], v[240:243], v[56:59]
    ds_read_b64_tr_b16 a[82:83], v0 offset:4736
    v_mfma_f32_16x16x32_bf16 v[56:59], a[40:43], v[244:247], v[56:59]
    ds_read_b64_tr_b16 a[84:85], v0 offset:8448
    v_mfma_f32_16x16x32_bf16 v[60:63], a[40:43], v[252:255], 0
    v_mfma_f32_16x16x32_bf16 v[60:63], a[36:39], v[248:251], v[60:63]
    ds_read_b64_tr_b16 a[86:87], v0 offset:8960
    v_mfma_f32_16x16x32_bf16 v[60:63], a[32:35], v[220:223], v[60:63]
    ds_read_b64_tr_b16 a[88:89], v0 offset:12672
    v_mfma_f32_16x16x32_bf16 v[60:63], a[28:31], v[216:219], v[60:63]
    v_mfma_f32_16x16x32_bf16 v[60:63], a[24:27], v[188:191], v[60:63]
    s_add_u32 m0, s30, 16928
    ds_read_b64_tr_b16 a[90:91], v0 offset:13184
    v_mfma_f32_16x16x32_bf16 v[60:63], a[20:23], v[184:187], v[60:63]
    ds_read_b64_tr_b16 a[92:93], v8 offset:0
    v_mfma_f32_16x16x32_bf16 v[60:63], a[16:19], v[156:159], v[60:63]
    buffer_load_dwordx4 v2, s[16:19], s61 offen offset:1024  lds
    v_mfma_f32_16x16x32_bf16 v[60:63], a[12:15], v[152:155], v[60:63]
    ds_read_b64_tr_b16 a[94:95], v8 offset:512
    v_mfma_f32_16x16x32_bf16 v[60:63], a[8:11], v[124:127], v[60:63]
    s_add_u32 m0, s30, 16960
    ds_read_b64_tr_b16 a[96:97], v8 offset:4224
    v_mfma_f32_16x16x32_bf16 v[60:63], a[4:7], v[120:123], v[60:63]
    v_mfma_f32_16x16x32_bf16 v[60:63], a[0:3], v[28:31], v[60:63]
    buffer_load_dwordx4 v2, s[16:19], s61 offen offset:2048  lds
    v_mfma_f32_16x16x32_bf16 v[60:63], a[248:251], v[24:27], v[60:63]
    ds_read_b64_tr_b16 a[98:99], v8 offset:4736
    v_mfma_f32_16x16x32_bf16 v[60:63], a[244:247], a[188:191], v[60:63]
    ds_read_b64_tr_b16 a[100:101], v8 offset:8448
    v_mfma_f32_16x16x32_bf16 v[60:63], a[240:243], a[184:187], v[60:63]
    s_add_u32 m0, s30, 16992
    ds_read_b64_tr_b16 a[102:103], v8 offset:8960
    v_mfma_f32_16x16x32_bf16 v[60:63], a[236:239], a[156:159], v[60:63]
    buffer_load_dwordx4 v2, s[16:19], s61 offen offset:3072  lds
    v_mfma_f32_16x16x32_bf16 v[60:63], a[232:235], a[152:155], v[60:63]
    s_waitcnt lgkmcnt(15)
    ds_read_b64_tr_b16 a[104:105], v8 offset:12672
    v_mfma_f32_16x16x32_bf16 v[32:35], a[44:47], a[128:131], 0
    s_add_u32 s61, s49, s101
    ds_read_b64_tr_b16 a[106:107], v8 offset:13184
    v_mfma_f32_16x16x32_bf16 v[32:35], a[48:51], a[132:135], v[32:35]
    s_add_u32 m0, s30, 33792
    v_mul_f32 v64, v64, v12
    v_mfma_f32_16x16x32_bf16 v[32:35], a[52:55], a[160:163], v[32:35]
    buffer_load_dwordx4 v2, s[16:19], s61 offen offset:0  lds
    v_mfma_f32_16x16x32_bf16 v[32:35], a[56:59], a[164:167], v[32:35]
    v_mul_f32 v65, v65, v12
    v_mfma_f32_16x16x32_bf16 v[32:35], a[60:63], v[80:83], v[32:35]
    v_mul_f32 v66, v66, v12
    v_mfma_f32_16x16x32_bf16 v[32:35], a[64:67], v[84:87], v[32:35]
    s_add_u32 m0, s30, 33824
    v_mul_f32 v67, v67, v12
    v_mfma_f32_16x16x32_bf16 v[32:35], a[68:71], v[96:99], v[32:35]
    s_waitcnt lgkmcnt(10)
    v_mul_f32 v48, v48, v12
    v_mfma_f32_16x16x32_bf16 v[32:35], a[72:75], v[100:103], v[32:35]
    buffer_load_dwordx4 v2, s[16:19], s61 offen offset:1024  lds
    v_mfma_f32_16x16x32_bf16 v[32:35], a[76:79], v[128:131], v[32:35]
    v_mul_f32 v49, v49, v12
    v_mul_f32 v50, v50, v12
    v_mfma_f32_16x16x32_bf16 v[32:35], a[80:83], v[132:135], v[32:35]
    s_add_u32 m0, s30, 33856
    v_mul_f32 v51, v51, v12
    v_mfma_f32_16x16x32_bf16 v[32:35], a[84:87], v[160:163], v[32:35]
    s_waitcnt lgkmcnt(2)
    v_mfma_f32_16x16x32_bf16 v[32:35], a[88:91], v[164:167], v[32:35]
    buffer_load_dwordx4 v2, s[16:19], s61 offen offset:2048  lds
    v_mfma_f32_16x16x32_bf16 v[32:35], a[92:95], v[192:195], v[32:35]
    v_cvt_pk_bf16_f32 v64, v64, v65
    v_cvt_pk_bf16_f32 v65, v66, v67
    v_mfma_f32_16x16x32_bf16 v[32:35], a[96:99], v[196:199], v[32:35]
    v_cvt_pk_bf16_f32 v66, v48, v49
    v_mfma_f32_16x16x32_bf16 v[32:35], a[100:103], v[224:227], v[32:35]
    s_waitcnt lgkmcnt(0)
    v_cvt_pk_bf16_f32 v67, v50, v51
    v_mfma_f32_16x16x32_bf16 v[32:35], a[104:107], v[228:231], v[32:35]
    s_add_u32 m0, s30, 33888
    v_permlane16_swap_b32 v64, v66
    v_mfma_f32_16x16x32_bf16 v[36:39], a[104:107], v[236:239], 0
    buffer_load_dwordx4 v2, s[16:19], s61 offen offset:3072  lds
    v_mfma_f32_16x16x32_bf16 v[36:39], a[100:103], v[232:235], v[36:39]
    s_add_u32 s61, s50, s101
    v_permlane16_swap_b32 v65, v67
    v_mfma_f32_16x16x32_bf16 v[36:39], a[96:99], v[204:207], v[36:39]
    s_add_u32 m0, s30, 50688
    ds_read_b64_tr_b16 a[108:109], v11 offset:33824
    v_mfma_f32_16x16x32_bf16 v[36:39], a[92:95], v[200:203], v[36:39]
    buffer_load_dwordx4 v2, s[16:19], s61 offen offset:0  lds
    v_mfma_f32_16x16x32_bf16 v[36:39], a[88:91], v[172:175], v[36:39]
    s_add_u32 s62, s53, s99
    ds_read_b64_tr_b16 a[110:111], v11 offset:34336
    v_mfma_f32_16x16x32_bf16 v[36:39], a[84:87], v[168:171], v[36:39]
    ds_read_b64_tr_b16 a[112:113], v11 offset:38048
    v_mfma_f32_16x16x32_bf16 v[36:39], a[80:83], v[140:143], v[36:39]
    ds_read_b64_tr_b16 a[114:115], v11 offset:38560
    v_mfma_f32_16x16x32_bf16 v[36:39], a[76:79], v[136:139], v[36:39]
    buffer_store_dwordx4 v[64:67], v4, s[20:23], s62 offen offset:64 nt sc1
    ds_read_b64_tr_b16 a[116:117], v11 offset:42272
    v_mfma_f32_16x16x32_bf16 v[36:39], a[72:75], v[108:111], v[36:39]
    v_mfma_f32_16x16x32_bf16 v[36:39], a[68:71], v[104:107], v[36:39]
    ds_read_b64_tr_b16 a[118:119], v11 offset:42784
    v_mfma_f32_16x16x32_bf16 v[36:39], a[64:67], v[92:95], v[36:39]
    ds_read_b64_tr_b16 a[120:121], v11 offset:46496
    v_mul_f32 v68, v68, v13
    v_mfma_f32_16x16x32_bf16 v[36:39], a[60:63], v[88:91], v[36:39]
    v_mfma_f32_16x16x32_bf16 v[36:39], a[56:59], a[172:175], v[36:39]
    ds_read_b64_tr_b16 a[122:123], v11 offset:47008
    v_mul_f32 v69, v69, v13
    v_mfma_f32_16x16x32_bf16 v[36:39], a[52:55], a[168:171], v[36:39]
    ds_read_b64_tr_b16 a[124:125], v11 offset:50720
    v_mul_f32 v70, v70, v13
    v_mfma_f32_16x16x32_bf16 v[36:39], a[48:51], a[140:143], v[36:39]
    v_mul_f32 v71, v71, v13
    v_mfma_f32_16x16x32_bf16 v[36:39], a[44:47], a[136:139], v[36:39]
    ds_read_b64_tr_b16 a[126:127], v11 offset:51232
    v_mul_f32 v52, v52, v13
    v_mfma_f32_16x16x32_bf16 v[40:43], a[44:47], a[144:147], 0
    ds_read_b64_tr_b16 a[224:225], v11 offset:54944
    v_mul_f32 v53, v53, v13
    v_mfma_f32_16x16x32_bf16 v[40:43], a[48:51], a[148:151], v[40:43]
    v_mul_f32 v54, v54, v13
    v_mfma_f32_16x16x32_bf16 v[40:43], a[52:55], a[176:179], v[40:43]
    ds_read_b64_tr_b16 a[226:227], v11 offset:55456
    v_mul_f32 v55, v55, v13
    v_mfma_f32_16x16x32_bf16 v[40:43], a[56:59], a[180:183], v[40:43]
    ds_read_b64_tr_b16 a[228:229], v11 offset:59168
    v_mfma_f32_16x16x32_bf16 v[40:43], a[60:63], v[16:19], v[40:43]
    v_cvt_pk_bf16_f32 v68, v68, v69
    v_mfma_f32_16x16x32_bf16 v[40:43], a[64:67], v[20:23], v[40:43]
    ds_read_b64_tr_b16 a[230:231], v11 offset:59680
    v_cvt_pk_bf16_f32 v69, v70, v71
    v_mfma_f32_16x16x32_bf16 v[40:43], a[68:71], v[112:115], v[40:43]
    ds_read_b64_tr_b16 a[232:233], v11 offset:63392
    v_cvt_pk_bf16_f32 v70, v52, v53
    v_mfma_f32_16x16x32_bf16 v[40:43], a[72:75], v[116:119], v[40:43]
    v_cvt_pk_bf16_f32 v71, v54, v55
    v_mfma_f32_16x16x32_bf16 v[40:43], a[76:79], v[144:147], v[40:43]
    ds_read_b64_tr_b16 a[234:235], v11 offset:63904
    v_mfma_f32_16x16x32_bf16 v[40:43], a[80:83], v[148:151], v[40:43]
    s_add_u32 m0, s30, 50720
    v_permlane16_swap_b32 v68, v70
    v_mfma_f32_16x16x32_bf16 v[40:43], a[84:87], v[176:179], v[40:43]
    ds_read_b64_tr_b16 a[236:237], v0 offset:32
    v_mfma_f32_16x16x32_bf16 v[40:43], a[88:91], v[180:183], v[40:43]
    buffer_load_dwordx4 v2, s[16:19], s61 offen offset:1024  lds
    v_mfma_f32_16x16x32_bf16 v[40:43], a[92:95], v[208:211], v[40:43]
    v_permlane16_swap_b32 v69, v71
    v_mfma_f32_16x16x32_bf16 v[40:43], a[96:99], v[212:215], v[40:43]
    s_add_u32 s62, s54, s99
    ds_read_b64_tr_b16 a[238:239], v0 offset:544
    v_mfma_f32_16x16x32_bf16 v[40:43], a[100:103], v[240:243], v[40:43]
    ds_read_b64_tr_b16 a[240:241], v0 offset:4256
    v_mfma_f32_16x16x32_bf16 v[40:43], a[104:107], v[244:247], v[40:43]
    ds_read_b64_tr_b16 a[242:243], v0 offset:4768
    v_mfma_f32_16x16x32_bf16 v[44:47], a[104:107], v[252:255], 0
    buffer_store_dwordx4 v[68:71], v4, s[20:23], s62 offen offset:64 nt sc1
    ds_read_b64_tr_b16 a[244:245], v0 offset:8480
    v_mfma_f32_16x16x32_bf16 v[44:47], a[100:103], v[248:251], v[44:47]
    ds_read_b64_tr_b16 a[246:247], v0 offset:8992
    v_mfma_f32_16x16x32_bf16 v[44:47], a[96:99], v[220:223], v[44:47]
    ds_read_b64_tr_b16 a[248:249], v0 offset:12704
    v_mfma_f32_16x16x32_bf16 v[44:47], a[92:95], v[216:219], v[44:47]
    v_mul_f32 v72, v72, v14
    v_mfma_f32_16x16x32_bf16 v[44:47], a[88:91], v[188:191], v[44:47]
    ds_read_b64_tr_b16 a[250:251], v0 offset:13216
    v_mfma_f32_16x16x32_bf16 v[44:47], a[84:87], v[184:187], v[44:47]
    ds_read_b64_tr_b16 a[0:1], v8 offset:32
    v_mul_f32 v73, v73, v14
    v_mfma_f32_16x16x32_bf16 v[44:47], a[80:83], v[156:159], v[44:47]
    v_mul_f32 v74, v74, v14
    v_mfma_f32_16x16x32_bf16 v[44:47], a[76:79], v[152:155], v[44:47]
    ds_read_b64_tr_b16 a[2:3], v8 offset:544
    v_mul_f32 v75, v75, v14
    v_mfma_f32_16x16x32_bf16 v[44:47], a[72:75], v[124:127], v[44:47]
    ds_read_b64_tr_b16 a[4:5], v8 offset:4256
    v_mul_f32 v56, v56, v14
    v_mfma_f32_16x16x32_bf16 v[44:47], a[68:71], v[120:123], v[44:47]
    v_mul_f32 v57, v57, v14
    v_mfma_f32_16x16x32_bf16 v[44:47], a[64:67], v[28:31], v[44:47]
    ds_read_b64_tr_b16 a[6:7], v8 offset:4768
    v_mul_f32 v58, v58, v14
    v_mfma_f32_16x16x32_bf16 v[44:47], a[60:63], v[24:27], v[44:47]
    ds_read_b64_tr_b16 a[8:9], v8 offset:8480
    v_mul_f32 v59, v59, v14
    v_mfma_f32_16x16x32_bf16 v[44:47], a[56:59], a[188:191], v[44:47]
    v_mfma_f32_16x16x32_bf16 v[44:47], a[52:55], a[184:187], v[44:47]
    ds_read_b64_tr_b16 a[10:11], v8 offset:8992
    v_cvt_pk_bf16_f32 v72, v72, v73
    v_mfma_f32_16x16x32_bf16 v[44:47], a[48:51], a[156:159], v[44:47]
    ds_read_b64_tr_b16 a[12:13], v8 offset:12704
    v_cvt_pk_bf16_f32 v73, v74, v75
    v_mfma_f32_16x16x32_bf16 v[44:47], a[44:47], a[152:155], v[44:47]
    s_waitcnt lgkmcnt(15)
    v_cvt_pk_bf16_f32 v74, v56, v57
    v_mfma_f32_16x16x32_bf16 v[48:51], a[108:111], a[128:131], 0
    ds_read_b64_tr_b16 a[14:15], v8 offset:13216
    v_cvt_pk_bf16_f32 v75, v58, v59
    v_mfma_f32_16x16x32_bf16 v[48:51], a[112:115], a[132:135], v[48:51]
    v_permlane16_swap_b32 v72, v74
    v_mfma_f32_16x16x32_bf16 v[48:51], a[116:119], a[160:163], v[48:51]
    s_add_u32 m0, s30, 50752
    v_mfma_f32_16x16x32_bf16 v[48:51], a[120:123], a[164:167], v[48:51]
    v_permlane16_swap_b32 v73, v75
    v_mfma_f32_16x16x32_bf16 v[48:51], a[124:127], v[80:83], v[48:51]
    buffer_load_dwordx4 v2, s[16:19], s61 offen offset:2048  lds
    v_mfma_f32_16x16x32_bf16 v[48:51], a[224:227], v[84:87], v[48:51]
    v_mfma_f32_16x16x32_bf16 v[48:51], a[228:231], v[96:99], v[48:51]
    s_add_u32 s62, s55, s99
    v_mfma_f32_16x16x32_bf16 v[48:51], a[232:235], v[100:103], v[48:51]
    s_waitcnt lgkmcnt(8)
    v_mfma_f32_16x16x32_bf16 v[48:51], a[236:239], v[128:131], v[48:51]
    v_mfma_f32_16x16x32_bf16 v[48:51], a[240:243], v[132:135], v[48:51]
    buffer_store_dwordx4 v[72:75], v4, s[20:23], s62 offen offset:64 nt sc1
    v_mfma_f32_16x16x32_bf16 v[48:51], a[244:247], v[160:163], v[48:51]
    v_mfma_f32_16x16x32_bf16 v[48:51], a[248:251], v[164:167], v[48:51]
    s_waitcnt lgkmcnt(0)
    v_mfma_f32_16x16x32_bf16 v[48:51], a[0:3], v[192:195], v[48:51]
    v_mul_f32 v76, v76, v15
    v_mfma_f32_16x16x32_bf16 v[48:51], a[4:7], v[196:199], v[48:51]
    v_mfma_f32_16x16x32_bf16 v[48:51], a[8:11], v[224:227], v[48:51]
    v_mul_f32 v77, v77, v15
    v_mfma_f32_16x16x32_bf16 v[48:51], a[12:15], v[228:231], v[48:51]
    v_mul_f32 v78, v78, v15
    v_mfma_f32_16x16x32_bf16 v[52:55], a[12:15], v[236:239], 0
    v_mul_f32 v79, v79, v15
    v_mfma_f32_16x16x32_bf16 v[52:55], a[8:11], v[232:235], v[52:55]
    ds_read_b64_tr_b16 a[16:17], v11 offset:33856
    v_mul_f32 v60, v60, v15
    v_mfma_f32_16x16x32_bf16 v[52:55], a[4:7], v[204:207], v[52:55]
    v_mul_f32 v61, v61, v15
    v_mfma_f32_16x16x32_bf16 v[52:55], a[0:3], v[200:203], v[52:55]
    ds_read_b64_tr_b16 a[18:19], v11 offset:34368
    v_mul_f32 v62, v62, v15
    v_mfma_f32_16x16x32_bf16 v[52:55], a[248:251], v[172:175], v[52:55]
    ds_read_b64_tr_b16 a[20:21], v11 offset:38080
    v_mul_f32 v63, v63, v15
    v_mfma_f32_16x16x32_bf16 v[52:55], a[244:247], v[168:171], v[52:55]
L_pg8:
    s_cbranch_execz L_warm_done
    v_mfma_f32_16x16x32_bf16 v[52:55], a[240:243], v[140:143], v[52:55]
    ds_read_b64_tr_b16 a[22:23], v11 offset:38592
    v_cvt_pk_bf16_f32 v76, v76, v77
    v_mfma_f32_16x16x32_bf16 v[52:55], a[236:239], v[136:139], v[52:55]
    ds_read_b64_tr_b16 a[24:25], v11 offset:42304
    v_cvt_pk_bf16_f32 v77, v78, v79
    v_mfma_f32_16x16x32_bf16 v[52:55], a[232:235], v[108:111], v[52:55]
    v_cvt_pk_bf16_f32 v78, v60, v61
    v_mfma_f32_16x16x32_bf16 v[52:55], a[228:231], v[104:107], v[52:55]
    ds_read_b64_tr_b16 a[26:27], v11 offset:42816
    v_cvt_pk_bf16_f32 v79, v62, v63
    v_mfma_f32_16x16x32_bf16 v[52:55], a[224:227], v[92:95], v[52:55]
    v_permlane16_swap_b32 v76, v78
    v_mfma_f32_16x16x32_bf16 v[52:55], a[124:127], v[88:91], v[52:55]
    s_add_u32 m0, s30, 50784
    ds_read_b64_tr_b16 a[28:29], v11 offset:46528
    v_mfma_f32_16x16x32_bf16 v[52:55], a[120:123], a[172:175], v[52:55]
    ds_read_b64_tr_b16 a[30:31], v11 offset:47040
    v_mfma_f32_16x16x32_bf16 v[52:55], a[116:119], a[168:171], v[52:55]
    buffer_load_dwordx4 v2, s[16:19], s61 offen offset:3072  lds
    v_mfma_f32_16x16x32_bf16 v[52:55], a[112:115], a[140:143], v[52:55]
    v_permlane16_swap_b32 v77, v79
    v_mfma_f32_16x16x32_bf16 v[52:55], a[108:111], a[136:139], v[52:55]
    s_add_u32 s62, s56, s99
    ds_read_b64_tr_b16 a[32:33], v11 offset:50752
    v_mfma_f32_16x16x32_bf16 v[56:59], a[108:111], a[144:147], 0
    ds_read_b64_tr_b16 a[34:35], v11 offset:51264
    v_mfma_f32_16x16x32_bf16 v[56:59], a[112:115], a[148:151], v[56:59]
    ds_read_b64_tr_b16 a[36:37], v11 offset:54976
    v_mfma_f32_16x16x32_bf16 v[56:59], a[116:119], a[176:179], v[56:59]
    buffer_store_dwordx4 v[76:79], v4, s[20:23], s62 offen offset:64 nt sc1
    ds_read_b64_tr_b16 a[38:39], v11 offset:55488
    v_mfma_f32_16x16x32_bf16 v[56:59], a[120:123], a[180:183], v[56:59]
    ds_read_b64_tr_b16 a[40:41], v11 offset:59200
    v_mfma_f32_16x16x32_bf16 v[56:59], a[124:127], v[16:19], v[56:59]
    v_mfma_f32_16x16x32_bf16 v[56:59], a[224:227], v[20:23], v[56:59]
    ds_read_b64_tr_b16 a[42:43], v11 offset:59712
    v_mfma_f32_16x16x32_bf16 v[56:59], a[228:231], v[112:115], v[56:59]
    ds_read_b64_tr_b16 a[44:45], v11 offset:63424
    v_mfma_f32_16x16x32_bf16 v[56:59], a[232:235], v[116:119], v[56:59]
    v_mfma_f32_16x16x32_bf16 v[56:59], a[236:239], v[144:147], v[56:59]
    ds_read_b64_tr_b16 a[46:47], v11 offset:63936
    v_mfma_f32_16x16x32_bf16 v[56:59], a[240:243], v[148:151], v[56:59]
    ds_read_b64_tr_b16 a[48:49], v0 offset:64
    v_mfma_f32_16x16x32_bf16 v[56:59], a[244:247], v[176:179], v[56:59]
    v_mfma_f32_16x16x32_bf16 v[56:59], a[248:251], v[180:183], v[56:59]
    ds_read_b64_tr_b16 a[50:51], v0 offset:576
    v_mfma_f32_16x16x32_bf16 v[56:59], a[0:3], v[208:211], v[56:59]
    ds_read_b64_tr_b16 a[52:53], v0 offset:4288
    v_mfma_f32_16x16x32_bf16 v[56:59], a[4:7], v[212:215], v[56:59]
    v_mfma_f32_16x16x32_bf16 v[56:59], a[8:11], v[240:243], v[56:59]
    ds_read_b64_tr_b16 a[54:55], v0 offset:4800
    v_mfma_f32_16x16x32_bf16 v[56:59], a[12:15], v[244:247], v[56:59]
    ds_read_b64_tr_b16 a[56:57], v0 offset:8512
    v_mfma_f32_16x16x32_bf16 v[60:63], a[12:15], v[252:255], 0
    v_mfma_f32_16x16x32_bf16 v[60:63], a[8:11], v[248:251], v[60:63]
    ds_read_b64_tr_b16 a[58:59], v0 offset:9024
    v_mfma_f32_16x16x32_bf16 v[60:63], a[4:7], v[220:223], v[60:63]
    ds_read_b64_tr_b16 a[60:61], v0 offset:12736
    v_mfma_f32_16x16x32_bf16 v[60:63], a[0:3], v[216:219], v[60:63]
    s_add_u32 s61, s51, s101
    v_mfma_f32_16x16x32_bf16 v[60:63], a[248:251], v[188:191], v[60:63]
    s_add_u32 m0, s30, 67584
    ds_read_b64_tr_b16 a[62:63], v0 offset:13248
    v_mfma_f32_16x16x32_bf16 v[60:63], a[244:247], v[184:187], v[60:63]
    ds_read_b64_tr_b16 a[64:65], v8 offset:64
    v_mfma_f32_16x16x32_bf16 v[60:63], a[240:243], v[156:159], v[60:63]
    buffer_load_dwordx4 v2, s[16:19], s61 offen offset:0  lds
    v_mfma_f32_16x16x32_bf16 v[60:63], a[236:239], v[152:155], v[60:63]
    ds_read_b64_tr_b16 a[66:67], v8 offset:576
    v_mfma_f32_16x16x32_bf16 v[60:63], a[232:235], v[124:127], v[60:63]
    s_add_u32 m0, s30, 67616
    ds_read_b64_tr_b16 a[68:69], v8 offset:4288
    v_mfma_f32_16x16x32_bf16 v[60:63], a[228:231], v[120:123], v[60:63]
    v_mfma_f32_16x16x32_bf16 v[60:63], a[224:227], v[28:31], v[60:63]
    buffer_load_dwordx4 v2, s[16:19], s61 offen offset:1024  lds
    v_mfma_f32_16x16x32_bf16 v[60:63], a[124:127], v[24:27], v[60:63]
    ds_read_b64_tr_b16 a[70:71], v8 offset:4800
    v_mfma_f32_16x16x32_bf16 v[60:63], a[120:123], a[188:191], v[60:63]
    ds_read_b64_tr_b16 a[72:73], v8 offset:8512
    v_mfma_f32_16x16x32_bf16 v[60:63], a[116:119], a[184:187], v[60:63]
    s_add_u32 m0, s30, 67648
    ds_read_b64_tr_b16 a[74:75], v8 offset:9024
    v_mfma_f32_16x16x32_bf16 v[60:63], a[112:115], a[156:159], v[60:63]
    buffer_load_dwordx4 v2, s[16:19], s61 offen offset:2048  lds
    v_mfma_f32_16x16x32_bf16 v[60:63], a[108:111], a[152:155], v[60:63]
    s_waitcnt lgkmcnt(15)
    ds_read_b64_tr_b16 a[76:77], v8 offset:12736
    v_mfma_f32_16x16x32_bf16 v[64:67], a[16:19], a[128:131], 0
    ds_read_b64_tr_b16 a[78:79], v8 offset:13248
    v_mfma_f32_16x16x32_bf16 v[64:67], a[20:23], a[132:135], v[64:67]
    s_add_u32 m0, s30, 67680
    v_mul_f32 v32, v32, v12
    v_mfma_f32_16x16x32_bf16 v[64:67], a[24:27], a[160:163], v[64:67]
    buffer_load_dwordx4 v2, s[16:19], s61 offen offset:3072  lds
    v_mfma_f32_16x16x32_bf16 v[64:67], a[28:31], a[164:167], v[64:67]
    v_mul_f32 v33, v33, v12
    v_mfma_f32_16x16x32_bf16 v[64:67], a[32:35], v[80:83], v[64:67]
    v_mul_f32 v34, v34, v12
    v_mfma_f32_16x16x32_bf16 v[64:67], a[36:39], v[84:87], v[64:67]
    v_mul_f32 v35, v35, v12
    v_mfma_f32_16x16x32_bf16 v[64:67], a[40:43], v[96:99], v[64:67]
    s_waitcnt lgkmcnt(10)
    v_mul_f32 v48, v48, v12
    v_mfma_f32_16x16x32_bf16 v[64:67], a[44:47], v[100:103], v[64:67]
    v_mul_f32 v49, v49, v12
    v_mfma_f32_16x16x32_bf16 v[64:67], a[48:51], v[128:131], v[64:67]
    v_mul_f32 v50, v50, v12
    v_mfma_f32_16x16x32_bf16 v[64:67], a[52:55], v[132:135], v[64:67]
    v_mul_f32 v51, v51, v12
    v_mfma_f32_16x16x32_bf16 v[64:67], a[56:59], v[160:163], v[64:67]
    s_waitcnt lgkmcnt(2)
    v_mfma_f32_16x16x32_bf16 v[64:67], a[60:63], v[164:167], v[64:67]
    v_cvt_pk_bf16_f32 v32, v32, v33
    v_mfma_f32_16x16x32_bf16 v[64:67], a[64:67], v[192:195], v[64:67]
    v_cvt_pk_bf16_f32 v33, v34, v35
    v_mfma_f32_16x16x32_bf16 v[64:67], a[68:71], v[196:199], v[64:67]
    v_cvt_pk_bf16_f32 v34, v48, v49
    v_mfma_f32_16x16x32_bf16 v[64:67], a[72:75], v[224:227], v[64:67]
    s_waitcnt lgkmcnt(0)
    v_cvt_pk_bf16_f32 v35, v50, v51
    v_mfma_f32_16x16x32_bf16 v[64:67], a[76:79], v[228:231], v[64:67]
    v_permlane16_swap_b32 v32, v34
    v_mfma_f32_16x16x32_bf16 v[68:71], a[76:79], v[236:239], 0
    v_mfma_f32_16x16x32_bf16 v[68:71], a[72:75], v[232:235], v[68:71]
    v_permlane16_swap_b32 v33, v35
    v_mfma_f32_16x16x32_bf16 v[68:71], a[68:71], v[204:207], v[68:71]
    ds_read_b64_tr_b16 a[80:81], v11 offset:33888
    v_mfma_f32_16x16x32_bf16 v[68:71], a[64:67], v[200:203], v[68:71]
    ds_read_b64_tr_b16 a[82:83], v11 offset:34400
    v_mfma_f32_16x16x32_bf16 v[68:71], a[60:63], v[172:175], v[68:71]
    s_add_u32 s62, s53, s100
    ds_read_b64_tr_b16 a[84:85], v11 offset:38112
    v_mfma_f32_16x16x32_bf16 v[68:71], a[56:59], v[168:171], v[68:71]
    v_mfma_f32_16x16x32_bf16 v[68:71], a[52:55], v[140:143], v[68:71]
    ds_read_b64_tr_b16 a[86:87], v11 offset:38624
    v_mfma_f32_16x16x32_bf16 v[68:71], a[48:51], v[136:139], v[68:71]
    buffer_store_dwordx4 v[32:35], v4, s[20:23], s62 offen offset:0 nt sc1
    ds_read_b64_tr_b16 a[88:89], v11 offset:42336
    v_mfma_f32_16x16x32_bf16 v[68:71], a[44:47], v[108:111], v[68:71]
    v_mfma_f32_16x16x32_bf16 v[68:71], a[40:43], v[104:107], v[68:71]
    ds_read_b64_tr_b16 a[90:91], v11 offset:42848
    v_mfma_f32_16x16x32_bf16 v[68:71], a[36:39], v[92:95], v[68:71]
    ds_read_b64_tr_b16 a[92:93], v11 offset:46560
    v_mul_f32 v36, v36, v13
    v_mfma_f32_16x16x32_bf16 v[68:71], a[32:35], v[88:91], v[68:71]
    v_mfma_f32_16x16x32_bf16 v[68:71], a[28:31], a[172:175], v[68:71]
    ds_read_b64_tr_b16 a[94:95], v11 offset:47072
    v_mul_f32 v37, v37, v13
    v_mfma_f32_16x16x32_bf16 v[68:71], a[24:27], a[168:171], v[68:71]
    ds_read_b64_tr_b16 a[96:97], v11 offset:50784
    v_mul_f32 v38, v38, v13
    v_mfma_f32_16x16x32_bf16 v[68:71], a[20:23], a[140:143], v[68:71]
    v_mul_f32 v39, v39, v13
    v_mfma_f32_16x16x32_bf16 v[68:71], a[16:19], a[136:139], v[68:71]
    ds_read_b64_tr_b16 a[98:99], v11 offset:51296
    v_mul_f32 v52, v52, v13
    v_mfma_f32_16x16x32_bf16 v[72:75], a[16:19], a[144:147], 0
    ds_read_b64_tr_b16 a[100:101], v11 offset:55008
    v_mul_f32 v53, v53, v13
    v_mfma_f32_16x16x32_bf16 v[72:75], a[20:23], a[148:151], v[72:75]
    v_mul_f32 v54, v54, v13
    v_mfma_f32_16x16x32_bf16 v[72:75], a[24:27], a[176:179], v[72:75]
    ds_read_b64_tr_b16 a[102:103], v11 offset:55520
    v_mul_f32 v55, v55, v13
    v_mfma_f32_16x16x32_bf16 v[72:75], a[28:31], a[180:183], v[72:75]
    ds_read_b64_tr_b16 a[104:105], v11 offset:59232
    v_mfma_f32_16x16x32_bf16 v[72:75], a[32:35], v[16:19], v[72:75]
    v_cvt_pk_bf16_f32 v36, v36, v37
    v_mfma_f32_16x16x32_bf16 v[72:75], a[36:39], v[20:23], v[72:75]
    ds_read_b64_tr_b16 a[106:107], v11 offset:59744
    v_cvt_pk_bf16_f32 v37, v38, v39
    v_mfma_f32_16x16x32_bf16 v[72:75], a[40:43], v[112:115], v[72:75]
    ds_read_b64_tr_b16 a[108:109], v11 offset:63456
    v_cvt_pk_bf16_f32 v38, v52, v53
    v_mfma_f32_16x16x32_bf16 v[72:75], a[44:47], v[116:119], v[72:75]
    v_cvt_pk_bf16_f32 v39, v54, v55
    v_mfma_f32_16x16x32_bf16 v[72:75], a[48:51], v[144:147], v[72:75]
    ds_read_b64_tr_b16 a[110:111], v11 offset:63968
    v_mfma_f32_16x16x32_bf16 v[72:75], a[52:55], v[148:151], v[72:75]
    v_permlane16_swap_b32 v36, v38
    v_mfma_f32_16x16x32_bf16 v[72:75], a[56:59], v[176:179], v[72:75]
    ds_read_b64_tr_b16 a[112:113], v0 offset:96
    v_mfma_f32_16x16x32_bf16 v[72:75], a[60:63], v[180:183], v[72:75]
    v_permlane16_swap_b32 v37, v39
    v_mfma_f32_16x16x32_bf16 v[72:75], a[64:67], v[208:211], v[72:75]
    ds_read_b64_tr_b16 a[114:115], v0 offset:608
    v_mfma_f32_16x16x32_bf16 v[72:75], a[68:71], v[212:215], v[72:75]
    s_add_u32 s62, s54, s100
    ds_read_b64_tr_b16 a[116:117], v0 offset:4320
    v_mfma_f32_16x16x32_bf16 v[72:75], a[72:75], v[240:243], v[72:75]
    ds_read_b64_tr_b16 a[118:119], v0 offset:4832
    v_mfma_f32_16x16x32_bf16 v[72:75], a[76:79], v[244:247], v[72:75]
    ds_read_b64_tr_b16 a[120:121], v0 offset:8544
    v_mfma_f32_16x16x32_bf16 v[76:79], a[76:79], v[252:255], 0
    buffer_store_dwordx4 v[36:39], v4, s[20:23], s62 offen offset:0 nt sc1
    v_mfma_f32_16x16x32_bf16 v[76:79], a[72:75], v[248:251], v[76:79]
    ds_read_b64_tr_b16 a[122:123], v0 offset:9056
    v_mfma_f32_16x16x32_bf16 v[76:79], a[68:71], v[220:223], v[76:79]
    ds_read_b64_tr_b16 a[124:125], v0 offset:12768
    v_mfma_f32_16x16x32_bf16 v[76:79], a[64:67], v[216:219], v[76:79]
    v_mul_f32 v40, v40, v14
    v_mfma_f32_16x16x32_bf16 v[76:79], a[60:63], v[188:191], v[76:79]
    ds_read_b64_tr_b16 a[126:127], v0 offset:13280
    v_mfma_f32_16x16x32_bf16 v[76:79], a[56:59], v[184:187], v[76:79]
    ds_read_b64_tr_b16 a[224:225], v8 offset:96
    v_mul_f32 v41, v41, v14
    v_mfma_f32_16x16x32_bf16 v[76:79], a[52:55], v[156:159], v[76:79]
    v_mul_f32 v42, v42, v14
    v_mfma_f32_16x16x32_bf16 v[76:79], a[48:51], v[152:155], v[76:79]
    ds_read_b64_tr_b16 a[226:227], v8 offset:608
    v_mul_f32 v43, v43, v14
    v_mfma_f32_16x16x32_bf16 v[76:79], a[44:47], v[124:127], v[76:79]
    ds_read_b64_tr_b16 a[228:229], v8 offset:4320
    v_mul_f32 v56, v56, v14
    v_mfma_f32_16x16x32_bf16 v[76:79], a[40:43], v[120:123], v[76:79]
    v_mul_f32 v57, v57, v14
    v_mfma_f32_16x16x32_bf16 v[76:79], a[36:39], v[28:31], v[76:79]
    ds_read_b64_tr_b16 a[230:231], v8 offset:4832
    v_mul_f32 v58, v58, v14
    v_mfma_f32_16x16x32_bf16 v[76:79], a[32:35], v[24:27], v[76:79]
    ds_read_b64_tr_b16 a[232:233], v8 offset:8544
    v_mul_f32 v59, v59, v14
    v_mfma_f32_16x16x32_bf16 v[76:79], a[28:31], a[188:191], v[76:79]
    v_mfma_f32_16x16x32_bf16 v[76:79], a[24:27], a[184:187], v[76:79]
    ds_read_b64_tr_b16 a[234:235], v8 offset:9056
    v_cvt_pk_bf16_f32 v40, v40, v41
    v_mfma_f32_16x16x32_bf16 v[76:79], a[20:23], a[156:159], v[76:79]
    ds_read_b64_tr_b16 a[236:237], v8 offset:12768
    v_cvt_pk_bf16_f32 v41, v42, v43
    v_mfma_f32_16x16x32_bf16 v[76:79], a[16:19], a[152:155], v[76:79]
    s_waitcnt lgkmcnt(15)
    v_cvt_pk_bf16_f32 v42, v56, v57
    v_mfma_f32_16x16x32_bf16 v[48:51], a[80:83], a[128:131], 0
    ds_read_b64_tr_b16 a[238:239], v8 offset:13280
    v_cvt_pk_bf16_f32 v43, v58, v59
    v_mfma_f32_16x16x32_bf16 v[48:51], a[84:87], a[132:135], v[48:51]
    v_permlane16_swap_b32 v40, v42
    v_mfma_f32_16x16x32_bf16 v[48:51], a[88:91], a[160:163], v[48:51]
    v_mfma_f32_16x16x32_bf16 v[48:51], a[92:95], a[164:167], v[48:51]
    v_permlane16_swap_b32 v41, v43
    v_mfma_f32_16x16x32_bf16 v[48:51], a[96:99], v[80:83], v[48:51]
    v_mfma_f32_16x16x32_bf16 v[48:51], a[100:103], v[84:87], v[48:51]
    v_mfma_f32_16x16x32_bf16 v[48:51], a[104:107], v[96:99], v[48:51]
    s_add_u32 s62, s55, s100
    v_mfma_f32_16x16x32_bf16 v[48:51], a[108:111], v[100:103], v[48:51]
    s_waitcnt lgkmcnt(8)
    v_mfma_f32_16x16x32_bf16 v[48:51], a[112:115], v[128:131], v[48:51]
    v_mfma_f32_16x16x32_bf16 v[48:51], a[116:119], v[132:135], v[48:51]
    buffer_store_dwordx4 v[40:43], v4, s[20:23], s62 offen offset:0 nt sc1
    v_mfma_f32_16x16x32_bf16 v[48:51], a[120:123], v[160:163], v[48:51]
    v_mfma_f32_16x16x32_bf16 v[48:51], a[124:127], v[164:167], v[48:51]
    s_waitcnt lgkmcnt(0)
    v_mfma_f32_16x16x32_bf16 v[48:51], a[224:227], v[192:195], v[48:51]
    v_mul_f32 v44, v44, v15
    v_mfma_f32_16x16x32_bf16 v[48:51], a[228:231], v[196:199], v[48:51]
    v_mfma_f32_16x16x32_bf16 v[48:51], a[232:235], v[224:227], v[48:51]
    v_mul_f32 v45, v45, v15
    v_mfma_f32_16x16x32_bf16 v[48:51], a[236:239], v[228:231], v[48:51]
    v_mul_f32 v46, v46, v15
    v_mfma_f32_16x16x32_bf16 v[52:55], a[236:239], v[236:239], 0
    v_mul_f32 v47, v47, v15
    v_mfma_f32_16x16x32_bf16 v[52:55], a[232:235], v[232:235], v[52:55]
    v_mul_f32 v60, v60, v15
    v_mfma_f32_16x16x32_bf16 v[52:55], a[228:231], v[204:207], v[52:55]
    v_mul_f32 v61, v61, v15
    v_mfma_f32_16x16x32_bf16 v[52:55], a[224:227], v[200:203], v[52:55]
    s_waitcnt vmcnt(3)
    s_barrier
    ds_read_b64_tr_b16 a[240:241], v8 offset:16896
    v_mfma_f32_16x16x32_bf16 v[52:55], a[124:127], v[172:175], v[52:55]
    ds_read_b64_tr_b16 a[242:243], v8 offset:17408
    v_mul_f32 v62, v62, v15
    v_mfma_f32_16x16x32_bf16 v[52:55], a[120:123], v[168:171], v[52:55]
    ds_read_b64_tr_b16 a[244:245], v8 offset:21120
    v_mul_f32 v63, v63, v15
    v_mfma_f32_16x16x32_bf16 v[52:55], a[116:119], v[140:143], v[52:55]
    ds_read_b64_tr_b16 a[246:247], v8 offset:21632
    v_cvt_pk_bf16_f32 v44, v44, v45
    v_mfma_f32_16x16x32_bf16 v[52:55], a[112:115], v[136:139], v[52:55]
    ds_read_b64_tr_b16 a[248:249], v8 offset:25344
    v_cvt_pk_bf16_f32 v45, v46, v47
    v_mfma_f32_16x16x32_bf16 v[52:55], a[108:111], v[108:111], v[52:55]
    v_cvt_pk_bf16_f32 v46, v60, v61
    v_mfma_f32_16x16x32_bf16 v[52:55], a[104:107], v[104:107], v[52:55]
    ds_read_b64_tr_b16 a[250:251], v8 offset:25856
    v_cvt_pk_bf16_f32 v47, v62, v63
    v_mfma_f32_16x16x32_bf16 v[52:55], a[100:103], v[92:95], v[52:55]
    v_permlane16_swap_b32 v44, v46
    v_mfma_f32_16x16x32_bf16 v[52:55], a[96:99], v[88:91], v[52:55]
    ds_read_b64_tr_b16 a[0:1], v8 offset:29568
    v_mfma_f32_16x16x32_bf16 v[52:55], a[92:95], a[172:175], v[52:55]
    ds_read_b64_tr_b16 a[2:3], v8 offset:30080
    v_mfma_f32_16x16x32_bf16 v[52:55], a[88:91], a[168:171], v[52:55]
    v_permlane16_swap_b32 v45, v47
    v_mfma_f32_16x16x32_bf16 v[52:55], a[84:87], a[140:143], v[52:55]
    ds_read_b64_tr_b16 a[4:5], v8 offset:33792
    v_mfma_f32_16x16x32_bf16 v[52:55], a[80:83], a[136:139], v[52:55]
    s_add_u32 s62, s56, s100
    ds_read_b64_tr_b16 a[6:7], v8 offset:34304
    v_mfma_f32_16x16x32_bf16 v[56:59], a[80:83], a[144:147], 0
    ds_read_b64_tr_b16 a[8:9], v8 offset:38016
    v_mfma_f32_16x16x32_bf16 v[56:59], a[84:87], a[148:151], v[56:59]
    v_mfma_f32_16x16x32_bf16 v[56:59], a[88:91], a[176:179], v[56:59]
    buffer_store_dwordx4 v[44:47], v4, s[20:23], s62 offen offset:0 nt sc1
    ds_read_b64_tr_b16 a[10:11], v8 offset:38528
    v_mfma_f32_16x16x32_bf16 v[56:59], a[92:95], a[180:183], v[56:59]
    ds_read_b64_tr_b16 a[12:13], v8 offset:42240
    v_mfma_f32_16x16x32_bf16 v[56:59], a[96:99], v[16:19], v[56:59]
    v_mfma_f32_16x16x32_bf16 v[56:59], a[100:103], v[20:23], v[56:59]
    ds_read_b64_tr_b16 a[14:15], v8 offset:42752
    v_mfma_f32_16x16x32_bf16 v[56:59], a[104:107], v[112:115], v[56:59]
    ds_read_b64_tr_b16 a[16:17], v8 offset:46464
    v_mfma_f32_16x16x32_bf16 v[56:59], a[108:111], v[116:119], v[56:59]
    v_mfma_f32_16x16x32_bf16 v[56:59], a[112:115], v[144:147], v[56:59]
    ds_read_b64_tr_b16 a[18:19], v8 offset:46976
    v_mfma_f32_16x16x32_bf16 v[56:59], a[116:119], v[148:151], v[56:59]
    ds_read_b64_tr_b16 a[20:21], v8 offset:50688
    v_mfma_f32_16x16x32_bf16 v[56:59], a[120:123], v[176:179], v[56:59]
    v_mfma_f32_16x16x32_bf16 v[56:59], a[124:127], v[180:183], v[56:59]
    ds_read_b64_tr_b16 a[22:23], v8 offset:51200
    v_mfma_f32_16x16x32_bf16 v[56:59], a[224:227], v[208:211], v[56:59]
    ds_read_b64_tr_b16 a[24:25], v8 offset:54912
    v_mfma_f32_16x16x32_bf16 v[56:59], a[228:231], v[212:215], v[56:59]
    v_mfma_f32_16x16x32_bf16 v[56:59], a[232:235], v[240:243], v[56:59]
    ds_read_b64_tr_b16 a[26:27], v8 offset:55424
    v_mfma_f32_16x16x32_bf16 v[56:59], a[236:239], v[244:247], v[56:59]
    ds_read_b64_tr_b16 a[28:29], v8 offset:59136
    v_mfma_f32_16x16x32_bf16 v[60:63], a[236:239], v[252:255], 0
    v_mfma_f32_16x16x32_bf16 v[60:63], a[232:235], v[248:251], v[60:63]
    ds_read_b64_tr_b16 a[30:31], v8 offset:59648
    v_mfma_f32_16x16x32_bf16 v[60:63], a[228:231], v[220:223], v[60:63]
    ds_read_b64_tr_b16 a[32:33], v8 offset:63360
    v_mfma_f32_16x16x32_bf16 v[60:63], a[224:227], v[216:219], v[60:63]
    v_mfma_f32_16x16x32_bf16 v[60:63], a[124:127], v[188:191], v[60:63]
    ds_read_b64_tr_b16 a[34:35], v8 offset:63872
    v_mfma_f32_16x16x32_bf16 v[60:63], a[120:123], v[184:187], v[60:63]
    ds_read_b64_tr_b16 a[36:37], v11 offset:0
    v_mfma_f32_16x16x32_bf16 v[60:63], a[116:119], v[156:159], v[60:63]
    v_mfma_f32_16x16x32_bf16 v[60:63], a[112:115], v[152:155], v[60:63]
    ds_read_b64_tr_b16 a[38:39], v11 offset:512
    v_mfma_f32_16x16x32_bf16 v[60:63], a[108:111], v[124:127], v[60:63]
    ds_read_b64_tr_b16 a[40:41], v11 offset:4224
    v_mfma_f32_16x16x32_bf16 v[60:63], a[104:107], v[120:123], v[60:63]
    v_mfma_f32_16x16x32_bf16 v[60:63], a[100:103], v[28:31], v[60:63]
    ds_read_b64_tr_b16 a[42:43], v11 offset:4736
    v_mfma_f32_16x16x32_bf16 v[60:63], a[96:99], v[24:27], v[60:63]
    ds_read_b64_tr_b16 a[44:45], v11 offset:8448
    v_mfma_f32_16x16x32_bf16 v[60:63], a[92:95], a[188:191], v[60:63]
    v_mfma_f32_16x16x32_bf16 v[60:63], a[88:91], a[184:187], v[60:63]
    ds_read_b64_tr_b16 a[46:47], v11 offset:8960
    v_mfma_f32_16x16x32_bf16 v[60:63], a[84:87], a[156:159], v[60:63]
    ds_read_b64_tr_b16 a[48:49], v11 offset:12672
    v_mfma_f32_16x16x32_bf16 v[60:63], a[80:83], a[152:155], v[60:63]
    s_waitcnt lgkmcnt(15)
    v_mfma_f32_16x16x32_bf16 v[32:35], a[240:243], a[128:131], 0
    ds_read_b64_tr_b16 a[50:51], v11 offset:13184
    v_mfma_f32_16x16x32_bf16 v[32:35], a[244:247], a[132:135], v[32:35]
    v_mul_f32 v64, v64, v12
    v_mfma_f32_16x16x32_bf16 v[32:35], a[248:251], a[160:163], v[32:35]
    v_mfma_f32_16x16x32_bf16 v[32:35], a[0:3], a[164:167], v[32:35]
    v_mul_f32 v65, v65, v12
    v_mfma_f32_16x16x32_bf16 v[32:35], a[4:7], v[80:83], v[32:35]
    v_mul_f32 v66, v66, v12
    v_mfma_f32_16x16x32_bf16 v[32:35], a[8:11], v[84:87], v[32:35]
    v_mul_f32 v67, v67, v12
    v_mfma_f32_16x16x32_bf16 v[32:35], a[12:15], v[96:99], v[32:35]
    v_mul_f32 v48, v48, v12
    v_mfma_f32_16x16x32_bf16 v[32:35], a[16:19], v[100:103], v[32:35]
    s_waitcnt lgkmcnt(8)
    v_mul_f32 v49, v49, v12
    v_mfma_f32_16x16x32_bf16 v[32:35], a[20:23], v[128:131], v[32:35]
    v_mul_f32 v50, v50, v12
    v_mfma_f32_16x16x32_bf16 v[32:35], a[24:27], v[132:135], v[32:35]
    v_mul_f32 v51, v51, v12
    v_mfma_f32_16x16x32_bf16 v[32:35], a[28:31], v[160:163], v[32:35]
    v_mfma_f32_16x16x32_bf16 v[32:35], a[32:35], v[164:167], v[32:35]
    s_waitcnt lgkmcnt(0)
    v_cvt_pk_bf16_f32 v64, v64, v65
    v_mfma_f32_16x16x32_bf16 v[32:35], a[36:39], v[192:195], v[32:35]
    v_cvt_pk_bf16_f32 v65, v66, v67
    v_mfma_f32_16x16x32_bf16 v[32:35], a[40:43], v[196:199], v[32:35]
    v_cvt_pk_bf16_f32 v66, v48, v49
    v_mfma_f32_16x16x32_bf16 v[32:35], a[44:47], v[224:227], v[32:35]
    v_cvt_pk_bf16_f32 v67, v50, v51
    v_mfma_f32_16x16x32_bf16 v[32:35], a[48:51], v[228:231], v[32:35]
    v_permlane16_swap_b32 v64, v66
    v_mfma_f32_16x16x32_bf16 v[36:39], a[48:51], v[236:239], 0
    v_mfma_f32_16x16x32_bf16 v[36:39], a[44:47], v[232:235], v[36:39]
    v_permlane16_swap_b32 v65, v67
    v_mfma_f32_16x16x32_bf16 v[36:39], a[40:43], v[204:207], v[36:39]
    ds_read_b64_tr_b16 a[52:53], v8 offset:16928
    v_mfma_f32_16x16x32_bf16 v[36:39], a[36:39], v[200:203], v[36:39]
    ds_read_b64_tr_b16 a[54:55], v8 offset:17440
    v_mfma_f32_16x16x32_bf16 v[36:39], a[32:35], v[172:175], v[36:39]
    s_add_u32 s62, s53, s100
    ds_read_b64_tr_b16 a[56:57], v8 offset:21152
    v_mfma_f32_16x16x32_bf16 v[36:39], a[28:31], v[168:171], v[36:39]
    v_mfma_f32_16x16x32_bf16 v[36:39], a[24:27], v[140:143], v[36:39]
    ds_read_b64_tr_b16 a[58:59], v8 offset:21664
    v_mfma_f32_16x16x32_bf16 v[36:39], a[20:23], v[136:139], v[36:39]
    buffer_store_dwordx4 v[64:67], v4, s[20:23], s62 offen offset:64 nt sc1
    ds_read_b64_tr_b16 a[60:61], v8 offset:25376
    v_mfma_f32_16x16x32_bf16 v[36:39], a[16:19], v[108:111], v[36:39]
    v_mfma_f32_16x16x32_bf16 v[36:39], a[12:15], v[104:107], v[36:39]
    ds_read_b64_tr_b16 a[62:63], v8 offset:25888
    v_mfma_f32_16x16x32_bf16 v[36:39], a[8:11], v[92:95], v[36:39]
    ds_read_b64_tr_b16 a[64:65], v8 offset:29600
    v_mul_f32 v68, v68, v13
    v_mfma_f32_16x16x32_bf16 v[36:39], a[4:7], v[88:91], v[36:39]
    v_mfma_f32_16x16x32_bf16 v[36:39], a[0:3], a[172:175], v[36:39]
    ds_read_b64_tr_b16 a[66:67], v8 offset:30112
    v_mul_f32 v69, v69, v13
    v_mfma_f32_16x16x32_bf16 v[36:39], a[248:251], a[168:171], v[36:39]
    ds_read_b64_tr_b16 a[68:69], v8 offset:33824
    v_mul_f32 v70, v70, v13
    v_mfma_f32_16x16x32_bf16 v[36:39], a[244:247], a[140:143], v[36:39]
    v_mul_f32 v71, v71, v13
    v_mfma_f32_16x16x32_bf16 v[36:39], a[240:243], a[136:139], v[36:39]
    ds_read_b64_tr_b16 a[70:71], v8 offset:34336
    v_mul_f32 v52, v52, v13
    v_mfma_f32_16x16x32_bf16 v[40:43], a[240:243], a[144:147], 0
    ds_read_b64_tr_b16 a[72:73], v8 offset:38048
    v_mul_f32 v53, v53, v13
    v_mfma_f32_16x16x32_bf16 v[40:43], a[244:247], a[148:151], v[40:43]
    v_mul_f32 v54, v54, v13
    v_mfma_f32_16x16x32_bf16 v[40:43], a[248:251], a[176:179], v[40:43]
    ds_read_b64_tr_b16 a[74:75], v8 offset:38560
    v_mul_f32 v55, v55, v13
    v_mfma_f32_16x16x32_bf16 v[40:43], a[0:3], a[180:183], v[40:43]
    ds_read_b64_tr_b16 a[76:77], v8 offset:42272
    v_mfma_f32_16x16x32_bf16 v[40:43], a[4:7], v[16:19], v[40:43]
    v_cvt_pk_bf16_f32 v68, v68, v69
    v_mfma_f32_16x16x32_bf16 v[40:43], a[8:11], v[20:23], v[40:43]
    ds_read_b64_tr_b16 a[78:79], v8 offset:42784
    v_cvt_pk_bf16_f32 v69, v70, v71
    v_mfma_f32_16x16x32_bf16 v[40:43], a[12:15], v[112:115], v[40:43]
    ds_read_b64_tr_b16 a[80:81], v8 offset:46496
    v_cvt_pk_bf16_f32 v70, v52, v53
    v_mfma_f32_16x16x32_bf16 v[40:43], a[16:19], v[116:119], v[40:43]
    v_cvt_pk_bf16_f32 v71, v54, v55
    v_mfma_f32_16x16x32_bf16 v[40:43], a[20:23], v[144:147], v[40:43]
    ds_read_b64_tr_b16 a[82:83], v8 offset:47008
    v_mfma_f32_16x16x32_bf16 v[40:43], a[24:27], v[148:151], v[40:43]
    v_permlane16_swap_b32 v68, v70
    v_mfma_f32_16x16x32_bf16 v[40:43], a[28:31], v[176:179], v[40:43]
    ds_read_b64_tr_b16 a[84:85], v8 offset:50720
    v_mfma_f32_16x16x32_bf16 v[40:43], a[32:35], v[180:183], v[40:43]
    v_permlane16_swap_b32 v69, v71
    v_mfma_f32_16x16x32_bf16 v[40:43], a[36:39], v[208:211], v[40:43]
    ds_read_b64_tr_b16 a[86:87], v8 offset:51232
    v_mfma_f32_16x16x32_bf16 v[40:43], a[40:43], v[212:215], v[40:43]
    s_add_u32 s62, s54, s100
    ds_read_b64_tr_b16 a[88:89], v8 offset:54944
    v_mfma_f32_16x16x32_bf16 v[40:43], a[44:47], v[240:243], v[40:43]
    ds_read_b64_tr_b16 a[90:91], v8 offset:55456
    v_mfma_f32_16x16x32_bf16 v[40:43], a[48:51], v[244:247], v[40:43]
    ds_read_b64_tr_b16 a[92:93], v8 offset:59168
    v_mfma_f32_16x16x32_bf16 v[44:47], a[48:51], v[252:255], 0
    buffer_store_dwordx4 v[68:71], v4, s[20:23], s62 offen offset:64 nt sc1
    v_mfma_f32_16x16x32_bf16 v[44:47], a[44:47], v[248:251], v[44:47]
    ds_read_b64_tr_b16 a[94:95], v8 offset:59680
    v_mfma_f32_16x16x32_bf16 v[44:47], a[40:43], v[220:223], v[44:47]
    ds_read_b64_tr_b16 a[96:97], v8 offset:63392
    v_mfma_f32_16x16x32_bf16 v[44:47], a[36:39], v[216:219], v[44:47]
    v_mul_f32 v72, v72, v14
    v_mfma_f32_16x16x32_bf16 v[44:47], a[32:35], v[188:191], v[44:47]
    ds_read_b64_tr_b16 a[98:99], v8 offset:63904
    v_mfma_f32_16x16x32_bf16 v[44:47], a[28:31], v[184:187], v[44:47]
    ds_read_b64_tr_b16 a[100:101], v11 offset:32
    v_mul_f32 v73, v73, v14
    v_mfma_f32_16x16x32_bf16 v[44:47], a[24:27], v[156:159], v[44:47]
    v_mul_f32 v74, v74, v14
    v_mfma_f32_16x16x32_bf16 v[44:47], a[20:23], v[152:155], v[44:47]
    ds_read_b64_tr_b16 a[102:103], v11 offset:544
    v_mul_f32 v75, v75, v14
    v_mfma_f32_16x16x32_bf16 v[44:47], a[16:19], v[124:127], v[44:47]
    ds_read_b64_tr_b16 a[104:105], v11 offset:4256
    v_mul_f32 v56, v56, v14
    v_mfma_f32_16x16x32_bf16 v[44:47], a[12:15], v[120:123], v[44:47]
    v_mul_f32 v57, v57, v14
    v_mfma_f32_16x16x32_bf16 v[44:47], a[8:11], v[28:31], v[44:47]
    ds_read_b64_tr_b16 a[106:107], v11 offset:4768
    v_mul_f32 v58, v58, v14
    v_mfma_f32_16x16x32_bf16 v[44:47], a[4:7], v[24:27], v[44:47]
    ds_read_b64_tr_b16 a[108:109], v11 offset:8480
    v_mul_f32 v59, v59, v14
    v_mfma_f32_16x16x32_bf16 v[44:47], a[0:3], a[188:191], v[44:47]
    v_mfma_f32_16x16x32_bf16 v[44:47], a[248:251], a[184:187], v[44:47]
    ds_read_b64_tr_b16 a[110:111], v11 offset:8992
    v_cvt_pk_bf16_f32 v72, v72, v73
    v_mfma_f32_16x16x32_bf16 v[44:47], a[244:247], a[156:159], v[44:47]
    ds_read_b64_tr_b16 a[112:113], v11 offset:12704
    v_cvt_pk_bf16_f32 v73, v74, v75
    v_mfma_f32_16x16x32_bf16 v[44:47], a[240:243], a[152:155], v[44:47]
    s_waitcnt lgkmcnt(15)
    v_cvt_pk_bf16_f32 v74, v56, v57
    v_mfma_f32_16x16x32_bf16 v[48:51], a[52:55], a[128:131], 0
    ds_read_b64_tr_b16 a[114:115], v11 offset:13216
    v_cvt_pk_bf16_f32 v75, v58, v59
    v_mfma_f32_16x16x32_bf16 v[48:51], a[56:59], a[132:135], v[48:51]
    v_permlane16_swap_b32 v72, v74
    v_mfma_f32_16x16x32_bf16 v[48:51], a[60:63], a[160:163], v[48:51]
    v_mfma_f32_16x16x32_bf16 v[48:51], a[64:67], a[164:167], v[48:51]
    v_permlane16_swap_b32 v73, v75
    v_mfma_f32_16x16x32_bf16 v[48:51], a[68:71], v[80:83], v[48:51]
    v_mfma_f32_16x16x32_bf16 v[48:51], a[72:75], v[84:87], v[48:51]
    v_mfma_f32_16x16x32_bf16 v[48:51], a[76:79], v[96:99], v[48:51]
    s_add_u32 s62, s55, s100
    v_mfma_f32_16x16x32_bf16 v[48:51], a[80:83], v[100:103], v[48:51]
    s_waitcnt lgkmcnt(8)
    v_mfma_f32_16x16x32_bf16 v[48:51], a[84:87], v[128:131], v[48:51]
    v_mfma_f32_16x16x32_bf16 v[48:51], a[88:91], v[132:135], v[48:51]
    buffer_store_dwordx4 v[72:75], v4, s[20:23], s62 offen offset:64 nt sc1
    v_mfma_f32_16x16x32_bf16 v[48:51], a[92:95], v[160:163], v[48:51]
    v_mfma_f32_16x16x32_bf16 v[48:51], a[96:99], v[164:167], v[48:51]
    s_waitcnt lgkmcnt(0)
    v_mfma_f32_16x16x32_bf16 v[48:51], a[100:103], v[192:195], v[48:51]
    v_mul_f32 v76, v76, v15
    v_mfma_f32_16x16x32_bf16 v[48:51], a[104:107], v[196:199], v[48:51]
    v_mfma_f32_16x16x32_bf16 v[48:51], a[108:111], v[224:227], v[48:51]
    v_mul_f32 v77, v77, v15
    v_mfma_f32_16x16x32_bf16 v[48:51], a[112:115], v[228:231], v[48:51]
    v_mul_f32 v78, v78, v15
    v_mfma_f32_16x16x32_bf16 v[52:55], a[112:115], v[236:239], 0
    v_mul_f32 v79, v79, v15
    v_mfma_f32_16x16x32_bf16 v[52:55], a[108:111], v[232:235], v[52:55]
    ds_read_b64_tr_b16 a[116:117], v8 offset:16960
    v_mul_f32 v60, v60, v15
    v_mfma_f32_16x16x32_bf16 v[52:55], a[104:107], v[204:207], v[52:55]
    v_mul_f32 v61, v61, v15
    v_mfma_f32_16x16x32_bf16 v[52:55], a[100:103], v[200:203], v[52:55]
    ds_read_b64_tr_b16 a[118:119], v8 offset:17472
    v_mul_f32 v62, v62, v15
    v_mfma_f32_16x16x32_bf16 v[52:55], a[96:99], v[172:175], v[52:55]
    ds_read_b64_tr_b16 a[120:121], v8 offset:21184
    v_mul_f32 v63, v63, v15
    v_mfma_f32_16x16x32_bf16 v[52:55], a[92:95], v[168:171], v[52:55]
    v_mfma_f32_16x16x32_bf16 v[52:55], a[88:91], v[140:143], v[52:55]
    ds_read_b64_tr_b16 a[122:123], v8 offset:21696
    v_cvt_pk_bf16_f32 v76, v76, v77
    v_mfma_f32_16x16x32_bf16 v[52:55], a[84:87], v[136:139], v[52:55]
    ds_read_b64_tr_b16 a[124:125], v8 offset:25408
    v_cvt_pk_bf16_f32 v77, v78, v79
    v_mfma_f32_16x16x32_bf16 v[52:55], a[80:83], v[108:111], v[52:55]
    v_cvt_pk_bf16_f32 v78, v60, v61
    v_mfma_f32_16x16x32_bf16 v[52:55], a[76:79], v[104:107], v[52:55]
    ds_read_b64_tr_b16 a[126:127], v8 offset:25920
    v_cvt_pk_bf16_f32 v79, v62, v63
    v_mfma_f32_16x16x32_bf16 v[52:55], a[72:75], v[92:95], v[52:55]
    v_permlane16_swap_b32 v76, v78
    v_mfma_f32_16x16x32_bf16 v[52:55], a[68:71], v[88:91], v[52:55]
    ds_read_b64_tr_b16 a[224:225], v8 offset:29632
    v_mfma_f32_16x16x32_bf16 v[52:55], a[64:67], a[172:175], v[52:55]
    ds_read_b64_tr_b16 a[226:227], v8 offset:30144
    v_mfma_f32_16x16x32_bf16 v[52:55], a[60:63], a[168:171], v[52:55]
    v_permlane16_swap_b32 v77, v79
    v_mfma_f32_16x16x32_bf16 v[52:55], a[56:59], a[140:143], v[52:55]
    ds_read_b64_tr_b16 a[228:229], v8 offset:33856
    v_mfma_f32_16x16x32_bf16 v[52:55], a[52:55], a[136:139], v[52:55]
    s_add_u32 s62, s56, s100
    ds_read_b64_tr_b16 a[230:231], v8 offset:34368
    v_mfma_f32_16x16x32_bf16 v[56:59], a[52:55], a[144:147], 0
    ds_read_b64_tr_b16 a[232:233], v8 offset:38080
    v_mfma_f32_16x16x32_bf16 v[56:59], a[56:59], a[148:151], v[56:59]
L_pg9:
    s_cbranch_execz L_warm_done
    v_mfma_f32_16x16x32_bf16 v[56:59], a[60:63], a[176:179], v[56:59]
    buffer_store_dwordx4 v[76:79], v4, s[20:23], s62 offen offset:64 nt sc1
    ds_read_b64_tr_b16 a[234:235], v8 offset:38592
    v_mfma_f32_16x16x32_bf16 v[56:59], a[64:67], a[180:183], v[56:59]
    ds_read_b64_tr_b16 a[236:237], v8 offset:42304
    v_mfma_f32_16x16x32_bf16 v[56:59], a[68:71], v[16:19], v[56:59]
    v_mfma_f32_16x16x32_bf16 v[56:59], a[72:75], v[20:23], v[56:59]
    ds_read_b64_tr_b16 a[238:239], v8 offset:42816
    v_mfma_f32_16x16x32_bf16 v[56:59], a[76:79], v[112:115], v[56:59]
    ds_read_b64_tr_b16 a[240:241], v8 offset:46528
    v_mfma_f32_16x16x32_bf16 v[56:59], a[80:83], v[116:119], v[56:59]
    v_mfma_f32_16x16x32_bf16 v[56:59], a[84:87], v[144:147], v[56:59]
    ds_read_b64_tr_b16 a[242:243], v8 offset:47040
    v_mfma_f32_16x16x32_bf16 v[56:59], a[88:91], v[148:151], v[56:59]
    ds_read_b64_tr_b16 a[244:245], v8 offset:50752
    v_mfma_f32_16x16x32_bf16 v[56:59], a[92:95], v[176:179], v[56:59]
    v_mfma_f32_16x16x32_bf16 v[56:59], a[96:99], v[180:183], v[56:59]
    ds_read_b64_tr_b16 a[246:247], v8 offset:51264
    v_mfma_f32_16x16x32_bf16 v[56:59], a[100:103], v[208:211], v[56:59]
    ds_read_b64_tr_b16 a[248:249], v8 offset:54976
    v_mfma_f32_16x16x32_bf16 v[56:59], a[104:107], v[212:215], v[56:59]
    v_mfma_f32_16x16x32_bf16 v[56:59], a[108:111], v[240:243], v[56:59]
    ds_read_b64_tr_b16 a[250:251], v8 offset:55488
    v_mfma_f32_16x16x32_bf16 v[56:59], a[112:115], v[244:247], v[56:59]
    ds_read_b64_tr_b16 a[0:1], v8 offset:59200
    v_mfma_f32_16x16x32_bf16 v[60:63], a[112:115], v[252:255], 0
    v_mfma_f32_16x16x32_bf16 v[60:63], a[108:111], v[248:251], v[60:63]
    ds_read_b64_tr_b16 a[2:3], v8 offset:59712
    v_mfma_f32_16x16x32_bf16 v[60:63], a[104:107], v[220:223], v[60:63]
    ds_read_b64_tr_b16 a[4:5], v8 offset:63424
    v_mfma_f32_16x16x32_bf16 v[60:63], a[100:103], v[216:219], v[60:63]
    v_mfma_f32_16x16x32_bf16 v[60:63], a[96:99], v[188:191], v[60:63]
    ds_read_b64_tr_b16 a[6:7], v8 offset:63936
    v_mfma_f32_16x16x32_bf16 v[60:63], a[92:95], v[184:187], v[60:63]
    ds_read_b64_tr_b16 a[8:9], v11 offset:64
    v_mfma_f32_16x16x32_bf16 v[60:63], a[88:91], v[156:159], v[60:63]
    v_mfma_f32_16x16x32_bf16 v[60:63], a[84:87], v[152:155], v[60:63]
    ds_read_b64_tr_b16 a[10:11], v11 offset:576
    v_mfma_f32_16x16x32_bf16 v[60:63], a[80:83], v[124:127], v[60:63]
    ds_read_b64_tr_b16 a[12:13], v11 offset:4288
    v_mfma_f32_16x16x32_bf16 v[60:63], a[76:79], v[120:123], v[60:63]
    v_mfma_f32_16x16x32_bf16 v[60:63], a[72:75], v[28:31], v[60:63]
    ds_read_b64_tr_b16 a[14:15], v11 offset:4800
    v_mfma_f32_16x16x32_bf16 v[60:63], a[68:71], v[24:27], v[60:63]
    ds_read_b64_tr_b16 a[16:17], v11 offset:8512
    v_mfma_f32_16x16x32_bf16 v[60:63], a[64:67], a[188:191], v[60:63]
    v_mfma_f32_16x16x32_bf16 v[60:63], a[60:63], a[184:187], v[60:63]
    ds_read_b64_tr_b16 a[18:19], v11 offset:9024
    v_mfma_f32_16x16x32_bf16 v[60:63], a[56:59], a[156:159], v[60:63]
    ds_read_b64_tr_b16 a[20:21], v11 offset:12736
    v_mfma_f32_16x16x32_bf16 v[60:63], a[52:55], a[152:155], v[60:63]
    s_waitcnt lgkmcnt(15)
    v_mfma_f32_16x16x32_bf16 v[64:67], a[116:119], a[128:131], 0
    ds_read_b64_tr_b16 a[22:23], v11 offset:13248
    v_mfma_f32_16x16x32_bf16 v[64:67], a[120:123], a[132:135], v[64:67]
    v_mul_f32 v32, v32, v12
    v_mfma_f32_16x16x32_bf16 v[64:67], a[124:127], a[160:163], v[64:67]
    v_mul_f32 v33, v33, v12
    v_mfma_f32_16x16x32_bf16 v[64:67], a[224:227], a[164:167], v[64:67]
    v_mul_f32 v34, v34, v12
    v_mfma_f32_16x16x32_bf16 v[64:67], a[228:231], v[80:83], v[64:67]
    v_mul_f32 v35, v35, v12
    v_mul_f32 v48, v48, v12
    v_mfma_f32_16x16x32_bf16 v[64:67], a[232:235], v[84:87], v[64:67]
    v_mul_f32 v49, v49, v12
    v_mfma_f32_16x16x32_bf16 v[64:67], a[236:239], v[96:99], v[64:67]
    v_mul_f32 v50, v50, v12
    v_mfma_f32_16x16x32_bf16 v[64:67], a[240:243], v[100:103], v[64:67]
    s_waitcnt lgkmcnt(8)
    v_mul_f32 v51, v51, v12
    v_cvt_pk_bf16_f32 v32, v32, v33
    v_mfma_f32_16x16x32_bf16 v[64:67], a[244:247], v[128:131], v[64:67]
    v_cvt_pk_bf16_f32 v33, v34, v35
    v_mfma_f32_16x16x32_bf16 v[64:67], a[248:251], v[132:135], v[64:67]
    v_cvt_pk_bf16_f32 v34, v48, v49
    v_cvt_pk_bf16_f32 v35, v50, v51
    v_mfma_f32_16x16x32_bf16 v[64:67], a[0:3], v[160:163], v[64:67]
    v_permlane16_swap_b32 v32, v34
    v_mfma_f32_16x16x32_bf16 v[64:67], a[4:7], v[164:167], v[64:67]
    s_waitcnt lgkmcnt(0)
    v_mfma_f32_16x16x32_bf16 v[64:67], a[8:11], v[192:195], v[64:67]
    v_permlane16_swap_b32 v33, v35
    v_mfma_f32_16x16x32_bf16 v[64:67], a[12:15], v[196:199], v[64:67]
    s_add_u32 s62, s53, s101
    v_mfma_f32_16x16x32_bf16 v[64:67], a[16:19], v[224:227], v[64:67]
    v_mfma_f32_16x16x32_bf16 v[64:67], a[20:23], v[228:231], v[64:67]
    v_mfma_f32_16x16x32_bf16 v[68:71], a[20:23], v[236:239], 0
    buffer_store_dwordx4 v[32:35], v4, s[20:23], s62 offen offset:0 nt sc1
    v_mfma_f32_16x16x32_bf16 v[68:71], a[16:19], v[232:235], v[68:71]
    ds_read_b64_tr_b16 a[24:25], v8 offset:16992
    v_mul_f32 v36, v36, v13
    v_mfma_f32_16x16x32_bf16 v[68:71], a[12:15], v[204:207], v[68:71]
    v_mul_f32 v37, v37, v13
    v_mfma_f32_16x16x32_bf16 v[68:71], a[8:11], v[200:203], v[68:71]
    ds_read_b64_tr_b16 a[26:27], v8 offset:17504
    v_mul_f32 v38, v38, v13
    v_mfma_f32_16x16x32_bf16 v[68:71], a[4:7], v[172:175], v[68:71]
    ds_read_b64_tr_b16 a[28:29], v8 offset:21216
    v_mul_f32 v39, v39, v13
    v_mfma_f32_16x16x32_bf16 v[68:71], a[0:3], v[168:171], v[68:71]
    v_mul_f32 v52, v52, v13
    v_mul_f32 v53, v53, v13
    v_mfma_f32_16x16x32_bf16 v[68:71], a[248:251], v[140:143], v[68:71]
    ds_read_b64_tr_b16 a[30:31], v8 offset:21728
    v_mul_f32 v54, v54, v13
    v_mfma_f32_16x16x32_bf16 v[68:71], a[244:247], v[136:139], v[68:71]
    ds_read_b64_tr_b16 a[32:33], v8 offset:25440
    v_mul_f32 v55, v55, v13
    v_mfma_f32_16x16x32_bf16 v[68:71], a[240:243], v[108:111], v[68:71]
    v_cvt_pk_bf16_f32 v36, v36, v37
    v_cvt_pk_bf16_f32 v37, v38, v39
    v_mfma_f32_16x16x32_bf16 v[68:71], a[236:239], v[104:107], v[68:71]
    ds_read_b64_tr_b16 a[34:35], v8 offset:25952
    v_cvt_pk_bf16_f32 v38, v52, v53
    v_mfma_f32_16x16x32_bf16 v[68:71], a[232:235], v[92:95], v[68:71]
    ds_read_b64_tr_b16 a[36:37], v8 offset:29664
    v_cvt_pk_bf16_f32 v39, v54, v55
    v_mfma_f32_16x16x32_bf16 v[68:71], a[228:231], v[88:91], v[68:71]
    v_permlane16_swap_b32 v36, v38
    v_mfma_f32_16x16x32_bf16 v[68:71], a[224:227], a[172:175], v[68:71]
    v_permlane16_swap_b32 v37, v39
    v_mfma_f32_16x16x32_bf16 v[68:71], a[124:127], a[168:171], v[68:71]
    s_add_u32 s62, s54, s101
    ds_read_b64_tr_b16 a[38:39], v8 offset:30176
    v_mfma_f32_16x16x32_bf16 v[68:71], a[120:123], a[140:143], v[68:71]
    ds_read_b64_tr_b16 a[40:41], v8 offset:33888
    v_mfma_f32_16x16x32_bf16 v[68:71], a[116:119], a[136:139], v[68:71]
    ds_read_b64_tr_b16 a[42:43], v8 offset:34400
    v_mfma_f32_16x16x32_bf16 v[72:75], a[116:119], a[144:147], 0
    buffer_store_dwordx4 v[36:39], v4, s[20:23], s62 offen offset:0 nt sc1
    ds_read_b64_tr_b16 a[44:45], v8 offset:38112
    v_mfma_f32_16x16x32_bf16 v[72:75], a[120:123], a[148:151], v[72:75]
    v_mul_f32 v40, v40, v14
    v_mfma_f32_16x16x32_bf16 v[72:75], a[124:127], a[176:179], v[72:75]
    ds_read_b64_tr_b16 a[46:47], v8 offset:38624
    v_mul_f32 v41, v41, v14
    v_mfma_f32_16x16x32_bf16 v[72:75], a[224:227], a[180:183], v[72:75]
    ds_read_b64_tr_b16 a[48:49], v8 offset:42336
    v_mul_f32 v42, v42, v14
    v_mfma_f32_16x16x32_bf16 v[72:75], a[228:231], v[16:19], v[72:75]
    v_mul_f32 v43, v43, v14
    v_mul_f32 v56, v56, v14
    v_mfma_f32_16x16x32_bf16 v[72:75], a[232:235], v[20:23], v[72:75]
    ds_read_b64_tr_b16 a[50:51], v8 offset:42848
    v_mul_f32 v57, v57, v14
    v_mfma_f32_16x16x32_bf16 v[72:75], a[236:239], v[112:115], v[72:75]
    ds_read_b64_tr_b16 a[52:53], v8 offset:46560
    v_mul_f32 v58, v58, v14
    v_mfma_f32_16x16x32_bf16 v[72:75], a[240:243], v[116:119], v[72:75]
    v_mul_f32 v59, v59, v14
    v_cvt_pk_bf16_f32 v40, v40, v41
    v_mfma_f32_16x16x32_bf16 v[72:75], a[244:247], v[144:147], v[72:75]
    ds_read_b64_tr_b16 a[54:55], v8 offset:47072
    v_cvt_pk_bf16_f32 v41, v42, v43
    v_mfma_f32_16x16x32_bf16 v[72:75], a[248:251], v[148:151], v[72:75]
    ds_read_b64_tr_b16 a[56:57], v8 offset:50784
    v_cvt_pk_bf16_f32 v42, v56, v57
    v_mfma_f32_16x16x32_bf16 v[72:75], a[0:3], v[176:179], v[72:75]
    v_cvt_pk_bf16_f32 v43, v58, v59
    v_mfma_f32_16x16x32_bf16 v[72:75], a[4:7], v[180:183], v[72:75]
    v_permlane16_swap_b32 v40, v42
    v_mfma_f32_16x16x32_bf16 v[72:75], a[8:11], v[208:211], v[72:75]
    ds_read_b64_tr_b16 a[58:59], v8 offset:51296
    v_mfma_f32_16x16x32_bf16 v[72:75], a[12:15], v[212:215], v[72:75]
    s_add_u32 s62, s55, s101
    v_permlane16_swap_b32 v41, v43
    v_mfma_f32_16x16x32_bf16 v[72:75], a[16:19], v[240:243], v[72:75]
    ds_read_b64_tr_b16 a[60:61], v8 offset:55008
    v_mfma_f32_16x16x32_bf16 v[72:75], a[20:23], v[244:247], v[72:75]
    ds_read_b64_tr_b16 a[62:63], v8 offset:55520
    v_mfma_f32_16x16x32_bf16 v[76:79], a[20:23], v[252:255], 0
    buffer_store_dwordx4 v[40:43], v4, s[20:23], s62 offen offset:0 nt sc1
    ds_read_b64_tr_b16 a[64:65], v8 offset:59232
    v_mfma_f32_16x16x32_bf16 v[76:79], a[16:19], v[248:251], v[76:79]
    ds_read_b64_tr_b16 a[66:67], v8 offset:59744
    v_mul_f32 v44, v44, v15
    v_mfma_f32_16x16x32_bf16 v[76:79], a[12:15], v[220:223], v[76:79]
    ds_read_b64_tr_b16 a[68:69], v8 offset:63456
    v_mul_f32 v45, v45, v15
    v_mfma_f32_16x16x32_bf16 v[76:79], a[8:11], v[216:219], v[76:79]
    v_mul_f32 v46, v46, v15
    v_mfma_f32_16x16x32_bf16 v[76:79], a[4:7], v[188:191], v[76:79]
    ds_read_b64_tr_b16 a[70:71], v8 offset:63968
    v_mul_f32 v47, v47, v15
    v_mfma_f32_16x16x32_bf16 v[76:79], a[0:3], v[184:187], v[76:79]
    ds_read_b64_tr_b16 a[72:73], v11 offset:96
    v_mul_f32 v60, v60, v15
    v_mfma_f32_16x16x32_bf16 v[76:79], a[248:251], v[156:159], v[76:79]
    v_mul_f32 v61, v61, v15
    v_mul_f32 v62, v62, v15
    v_mfma_f32_16x16x32_bf16 v[76:79], a[244:247], v[152:155], v[76:79]
    ds_read_b64_tr_b16 a[74:75], v11 offset:608
    v_mul_f32 v63, v63, v15
    v_mfma_f32_16x16x32_bf16 v[76:79], a[240:243], v[124:127], v[76:79]
    ds_read_b64_tr_b16 a[76:77], v11 offset:4320
    v_cvt_pk_bf16_f32 v44, v44, v45
    v_mfma_f32_16x16x32_bf16 v[76:79], a[236:239], v[120:123], v[76:79]
    v_cvt_pk_bf16_f32 v45, v46, v47
    v_cvt_pk_bf16_f32 v46, v60, v61
    v_mfma_f32_16x16x32_bf16 v[76:79], a[232:235], v[28:31], v[76:79]
    ds_read_b64_tr_b16 a[78:79], v11 offset:4832
    v_cvt_pk_bf16_f32 v47, v62, v63
    v_mfma_f32_16x16x32_bf16 v[76:79], a[228:231], v[24:27], v[76:79]
    v_permlane16_swap_b32 v44, v46
    v_mfma_f32_16x16x32_bf16 v[76:79], a[224:227], a[188:191], v[76:79]
    ds_read_b64_tr_b16 a[80:81], v11 offset:8544
    v_mfma_f32_16x16x32_bf16 v[76:79], a[124:127], a[184:187], v[76:79]
    s_add_u32 s62, s56, s101
    v_permlane16_swap_b32 v45, v47
    v_mfma_f32_16x16x32_bf16 v[76:79], a[120:123], a[156:159], v[76:79]
    ds_read_b64_tr_b16 a[82:83], v11 offset:9056
    v_mfma_f32_16x16x32_bf16 v[76:79], a[116:119], a[152:155], v[76:79]
    s_waitcnt lgkmcnt(15)
    ds_read_b64_tr_b16 a[84:85], v11 offset:12768
    v_mfma_f32_16x16x32_bf16 v[48:51], a[24:27], a[128:131], 0
    buffer_store_dwordx4 v[44:47], v4, s[20:23], s62 offen offset:0 nt sc1
    ds_read_b64_tr_b16 a[86:87], v11 offset:13280
    v_mfma_f32_16x16x32_bf16 v[48:51], a[28:31], a[132:135], v[48:51]
    v_mfma_f32_16x16x32_bf16 v[48:51], a[32:35], a[160:163], v[48:51]
    v_mfma_f32_16x16x32_bf16 v[48:51], a[36:39], a[164:167], v[48:51]
    v_mfma_f32_16x16x32_bf16 v[48:51], a[40:43], v[80:83], v[48:51]
    v_mfma_f32_16x16x32_bf16 v[48:51], a[44:47], v[84:87], v[48:51]
    v_mfma_f32_16x16x32_bf16 v[48:51], a[48:51], v[96:99], v[48:51]
    s_waitcnt lgkmcnt(10)
    v_mfma_f32_16x16x32_bf16 v[48:51], a[52:55], v[100:103], v[48:51]
    v_mfma_f32_16x16x32_bf16 v[48:51], a[56:59], v[128:131], v[48:51]
    v_mfma_f32_16x16x32_bf16 v[48:51], a[60:63], v[132:135], v[48:51]
    v_mfma_f32_16x16x32_bf16 v[48:51], a[64:67], v[160:163], v[48:51]
    s_waitcnt lgkmcnt(2)
    v_mfma_f32_16x16x32_bf16 v[48:51], a[68:71], v[164:167], v[48:51]
    v_mfma_f32_16x16x32_bf16 v[48:51], a[72:75], v[192:195], v[48:51]
    v_mul_f32 v64, v64, v12
    v_mfma_f32_16x16x32_bf16 v[48:51], a[76:79], v[196:199], v[48:51]
    v_mul_f32 v65, v65, v12
    v_mfma_f32_16x16x32_bf16 v[48:51], a[80:83], v[224:227], v[48:51]
    s_waitcnt lgkmcnt(0)
    v_mul_f32 v66, v66, v12
    v_mul_f32 v67, v67, v12
    v_mfma_f32_16x16x32_bf16 v[48:51], a[84:87], v[228:231], v[48:51]
    v_cvt_pk_bf16_f32 v64, v64, v65
    v_cvt_pk_bf16_f32 v65, v66, v67
    v_mfma_f32_16x16x32_bf16 v[52:55], a[84:87], v[236:239], 0
    v_mfma_f32_16x16x32_bf16 v[52:55], a[80:83], v[232:235], v[52:55]
    v_mfma_f32_16x16x32_bf16 v[52:55], a[76:79], v[204:207], v[52:55]
    v_mfma_f32_16x16x32_bf16 v[52:55], a[72:75], v[200:203], v[52:55]
    s_add_u32 s62, s53, s101
    v_mfma_f32_16x16x32_bf16 v[52:55], a[68:71], v[172:175], v[52:55]
    v_mul_f32 v48, v48, v12
    v_mul_f32 v49, v49, v12
    v_mfma_f32_16x16x32_bf16 v[52:55], a[64:67], v[168:171], v[52:55]
    v_mul_f32 v50, v50, v12
    v_mul_f32 v51, v51, v12
    v_mfma_f32_16x16x32_bf16 v[52:55], a[60:63], v[140:143], v[52:55]
    v_cvt_pk_bf16_f32 v66, v48, v49
    v_cvt_pk_bf16_f32 v67, v50, v51
    v_mfma_f32_16x16x32_bf16 v[52:55], a[56:59], v[136:139], v[52:55]
    v_permlane16_swap_b32 v64, v66
    v_mfma_f32_16x16x32_bf16 v[52:55], a[52:55], v[108:111], v[52:55]
    v_permlane16_swap_b32 v65, v67
    v_mfma_f32_16x16x32_bf16 v[52:55], a[48:51], v[104:107], v[52:55]
    v_mfma_f32_16x16x32_bf16 v[52:55], a[44:47], v[92:95], v[52:55]
    buffer_store_dwordx4 v[64:67], v4, s[20:23], s62 offen offset:64 nt sc1
    v_mfma_f32_16x16x32_bf16 v[52:55], a[40:43], v[88:91], v[52:55]
    v_mfma_f32_16x16x32_bf16 v[52:55], a[36:39], a[172:175], v[52:55]
    v_mul_f32 v68, v68, v13
    v_mfma_f32_16x16x32_bf16 v[52:55], a[32:35], a[168:171], v[52:55]
    v_mul_f32 v69, v69, v13
    v_mfma_f32_16x16x32_bf16 v[52:55], a[28:31], a[140:143], v[52:55]
    v_mul_f32 v70, v70, v13
    v_mul_f32 v71, v71, v13
    v_mfma_f32_16x16x32_bf16 v[52:55], a[24:27], a[136:139], v[52:55]
    v_cvt_pk_bf16_f32 v68, v68, v69
    v_cvt_pk_bf16_f32 v69, v70, v71
    v_mfma_f32_16x16x32_bf16 v[56:59], a[24:27], a[144:147], 0
    v_mfma_f32_16x16x32_bf16 v[56:59], a[28:31], a[148:151], v[56:59]
    v_mfma_f32_16x16x32_bf16 v[56:59], a[32:35], a[176:179], v[56:59]
    v_mfma_f32_16x16x32_bf16 v[56:59], a[36:39], a[180:183], v[56:59]
    s_add_u32 s62, s54, s101
    v_mfma_f32_16x16x32_bf16 v[56:59], a[40:43], v[16:19], v[56:59]
    v_mul_f32 v52, v52, v13
    v_mul_f32 v53, v53, v13
    v_mfma_f32_16x16x32_bf16 v[56:59], a[44:47], v[20:23], v[56:59]
    v_mul_f32 v54, v54, v13
    v_mul_f32 v55, v55, v13
    v_mfma_f32_16x16x32_bf16 v[56:59], a[48:51], v[112:115], v[56:59]
    v_cvt_pk_bf16_f32 v70, v52, v53
    v_cvt_pk_bf16_f32 v71, v54, v55
    v_mfma_f32_16x16x32_bf16 v[56:59], a[52:55], v[116:119], v[56:59]
    v_permlane16_swap_b32 v68, v70
    v_mfma_f32_16x16x32_bf16 v[56:59], a[56:59], v[144:147], v[56:59]
    v_permlane16_swap_b32 v69, v71
    v_mfma_f32_16x16x32_bf16 v[56:59], a[60:63], v[148:151], v[56:59]
    v_mfma_f32_16x16x32_bf16 v[56:59], a[64:67], v[176:179], v[56:59]
    buffer_store_dwordx4 v[68:71], v4, s[20:23], s62 offen offset:64 nt sc1
    v_mfma_f32_16x16x32_bf16 v[56:59], a[68:71], v[180:183], v[56:59]
    v_mfma_f32_16x16x32_bf16 v[56:59], a[72:75], v[208:211], v[56:59]
    v_mul_f32 v72, v72, v14
    v_mfma_f32_16x16x32_bf16 v[56:59], a[76:79], v[212:215], v[56:59]
    v_mul_f32 v73, v73, v14
    v_mfma_f32_16x16x32_bf16 v[56:59], a[80:83], v[240:243], v[56:59]
    v_mul_f32 v74, v74, v14
    v_mul_f32 v75, v75, v14
    v_mfma_f32_16x16x32_bf16 v[56:59], a[84:87], v[244:247], v[56:59]
    v_cvt_pk_bf16_f32 v72, v72, v73
    v_cvt_pk_bf16_f32 v73, v74, v75
    v_mfma_f32_16x16x32_bf16 v[60:63], a[84:87], v[252:255], 0
    v_mfma_f32_16x16x32_bf16 v[60:63], a[80:83], v[248:251], v[60:63]
    v_mfma_f32_16x16x32_bf16 v[60:63], a[76:79], v[220:223], v[60:63]
    v_mfma_f32_16x16x32_bf16 v[60:63], a[72:75], v[216:219], v[60:63]
    s_add_u32 s62, s55, s101
    v_mfma_f32_16x16x32_bf16 v[60:63], a[68:71], v[188:191], v[60:63]
    v_mul_f32 v56, v56, v14
    v_mul_f32 v57, v57, v14
    v_mfma_f32_16x16x32_bf16 v[60:63], a[64:67], v[184:187], v[60:63]
    v_mul_f32 v58, v58, v14
    v_mul_f32 v59, v59, v14
    v_mfma_f32_16x16x32_bf16 v[60:63], a[60:63], v[156:159], v[60:63]
    v_cvt_pk_bf16_f32 v74, v56, v57
    v_cvt_pk_bf16_f32 v75, v58, v59
    v_mfma_f32_16x16x32_bf16 v[60:63], a[56:59], v[152:155], v[60:63]
    v_permlane16_swap_b32 v72, v74
    v_mfma_f32_16x16x32_bf16 v[60:63], a[52:55], v[124:127], v[60:63]
    v_permlane16_swap_b32 v73, v75
    v_mfma_f32_16x16x32_bf16 v[60:63], a[48:51], v[120:123], v[60:63]
    v_mfma_f32_16x16x32_bf16 v[60:63], a[44:47], v[28:31], v[60:63]
    buffer_store_dwordx4 v[72:75], v4, s[20:23], s62 offen offset:64 nt sc1
    v_mfma_f32_16x16x32_bf16 v[60:63], a[40:43], v[24:27], v[60:63]
    v_mfma_f32_16x16x32_bf16 v[60:63], a[36:39], a[188:191], v[60:63]
    v_mul_f32 v76, v76, v15
    v_mfma_f32_16x16x32_bf16 v[60:63], a[32:35], a[184:187], v[60:63]
    v_mul_f32 v77, v77, v15
    v_mfma_f32_16x16x32_bf16 v[60:63], a[28:31], a[156:159], v[60:63]
    v_mul_f32 v78, v78, v15
    v_mul_f32 v79, v79, v15
    v_mfma_f32_16x16x32_bf16 v[60:63], a[24:27], a[152:155], v[60:63]
    v_cvt_pk_bf16_f32 v76, v76, v77
    v_cvt_pk_bf16_f32 v77, v78, v79
    s_add_u32 s62, s56, s101
    s_nop 4
    v_mul_f32 v60, v60, v15
    v_mul_f32 v61, v61, v15
    v_mul_f32 v62, v62, v15
    v_mul_f32 v63, v63, v15
    v_cvt_pk_bf16_f32 v78, v60, v61
    v_cvt_pk_bf16_f32 v79, v62, v63
    s_nop 0
    v_permlane16_swap_b32 v76, v78
    v_permlane16_swap_b32 v77, v79
    buffer_store_dwordx4 v[76:79], v4, s[20:23], s62 offen offset:64 nt sc1

L_end:
    s_endpgm
L_fallback:
    s_waitcnt vmcnt(0) lgkmcnt(0)
    s_nop 7
    v_mov_b32 v64, 0xff800000
    v_mov_b32 v65, 0xff800000
    v_mov_b32 v66, 0xff800000
    v_mov_b32 v67, 0xff800000
    v_mbcnt_lo_u32_b32 v9, -1, 0
    v_mbcnt_hi_u32_b32 v9, -1, v9
    v_and_b32 v10, 15, v9
    v_lshlrev_b32 v10, 9, v10
    v_and_b32 v9, 48, v9
    v_add_u32 v9, v9, v10
    buffer_load_dwordx4 a[0:3], v9, s[8:11], s53 offen offset:0
    buffer_load_dwordx4 a[4:7], v9, s[8:11], s53 offen offset:64
    buffer_load_dwordx4 a[8:11], v9, s[8:11], s53 offen offset:128
    buffer_load_dwordx4 a[12:15], v9, s[8:11], s53 offen offset:192
    buffer_load_dwordx4 a[16:19], v9, s[8:11], s53 offen offset:256
    buffer_load_dwordx4 a[20:23], v9, s[8:11], s53 offen offset:320
    buffer_load_dwordx4 a[24:27], v9, s[8:11], s53 offen offset:384
    buffer_load_dwordx4 a[28:31], v9, s[8:11], s53 offen offset:448
    buffer_load_dwordx4 a[32:35], v9, s[8:11], s54 offen offset:0
    buffer_load_dwordx4 a[36:39], v9, s[8:11], s54 offen offset:64
    buffer_load_dwordx4 a[40:43], v9, s[8:11], s54 offen offset:128
    buffer_load_dwordx4 a[44:47], v9, s[8:11], s54 offen offset:192
    buffer_load_dwordx4 a[48:51], v9, s[8:11], s54 offen offset:256
    buffer_load_dwordx4 a[52:55], v9, s[8:11], s54 offen offset:320
    buffer_load_dwordx4 a[56:59], v9, s[8:11], s54 offen offset:384
    buffer_load_dwordx4 a[60:63], v9, s[8:11], s54 offen offset:448
    buffer_load_dwordx4 a[64:67], v9, s[8:11], s55 offen offset:0
    buffer_load_dwordx4 a[68:71], v9, s[8:11], s55 offen offset:64
    buffer_load_dwordx4 a[72:75], v9, s[8:11], s55 offen offset:128
    buffer_load_dwordx4 a[76:79], v9, s[8:11], s55 offen offset:192
    buffer_load_dwordx4 a[80:83], v9, s[8:11], s55 offen offset:256
    buffer_load_dwordx4 a[84:87], v9, s[8:11], s55 offen offset:320
    buffer_load_dwordx4 a[88:91], v9, s[8:11], s55 offen offset:384
    buffer_load_dwordx4 a[92:95], v9, s[8:11], s55 offen offset:448
    buffer_load_dwordx4 a[96:99], v9, s[8:11], s56 offen offset:0
    buffer_load_dwordx4 a[100:103], v9, s[8:11], s56 offen offset:64
    buffer_load_dwordx4 a[104:107], v9, s[8:11], s56 offen offset:128
    buffer_load_dwordx4 a[108:111], v9, s[8:11], s56 offen offset:192
    buffer_load_dwordx4 a[112:115], v9, s[8:11], s56 offen offset:256
    buffer_load_dwordx4 a[116:119], v9, s[8:11], s56 offen offset:320
    buffer_load_dwordx4 a[120:123], v9, s[8:11], s56 offen offset:384
    buffer_load_dwordx4 a[124:127], v9, s[8:11], s56 offen offset:448
    s_and_b32 s61, s32, 0x3fff
L_fb_loop:
    s_barrier
    s_add_u32 m0, s30, 0
    s_nop 0
    buffer_load_dwordx4 v1, s[12:15], s61 offen offset:0 lds
    s_add_u32 m0, s30, 544
    s_nop 0
    buffer_load_dwordx4 v1, s[12:15], s61 offen offset:512 lds
    s_add_u32 m0, s30, 1088
    s_nop 0
    buffer_load_dwordx4 v1, s[12:15], s61 offen offset:1024 lds
    s_add_u32 m0, s30, 1632
    s_nop 0
    buffer_load_dwordx4 v1, s[12:15], s61 offen offset:1536 lds
    s_waitcnt vmcnt(0)
    s_barrier
    ds_read_b128 v[96:99], v5 offset:0
    ds_read_b128 v[100:103], v5 offset:64
    ds_read_b128 v[104:107], v5 offset:128
    ds_read_b128 v[108:111], v5 offset:192
    ds_read_b128 v[112:115], v5 offset:256
    ds_read_b128 v[116:119], v5 offset:320
    ds_read_b128 v[120:123], v5 offset:384
    ds_read_b128 v[124:127], v5 offset:448
    s_waitcnt lgkmcnt(0)
    v_mfma_f32_16x16x32_bf16 v[32:35], v[96:99], a[0:3], 0
    v_mfma_f32_16x16x32_bf16 v[36:39], v[96:99], a[32:35], 0
    v_mfma_f32_16x16x32_bf16 v[40:43], v[96:99], a[64:67], 0
    v_mfma_f32_16x16x32_bf16 v[44:47], v[96:99], a[96:99], 0
    v_mfma_f32_16x16x32_bf16 v[32:35], v[100:103], a[4:7], v[32:35]
    v_mfma_f32_16x16x32_bf16 v[36:39], v[100:103], a[36:39], v[36:39]
    v_mfma_f32_16x16x32_bf16 v[40:43], v[100:103], a[68:71], v[40:43]
    v_mfma_f32_16x16x32_bf16 v[44:47], v[100:103], a[100:103], v[44:47]
    v_mfma_f32_16x16x32_bf16 v[32:35], v[104:107], a[8:11], v[32:35]
    v_mfma_f32_16x16x32_bf16 v[36:39], v[104:107], a[40:43], v[36:39]
    v_mfma_f32_16x16x32_bf16 v[40:43], v[104:107], a[72:75], v[40:43]
    v_mfma_f32_16x16x32_bf16 v[44:47], v[104:107], a[104:107], v[44:47]
    v_mfma_f32_16x16x32_bf16 v[32:35], v[108:111], a[12:15], v[32:35]
    v_mfma_f32_16x16x32_bf16 v[36:39], v[108:111], a[44:47], v[36:39]
    v_mfma_f32_16x16x32_bf16 v[40:43], v[108:111], a[76:79], v[40:43]
    v_mfma_f32_16x16x32_bf16 v[44:47], v[108:111], a[108:111], v[44:47]
    v_mfma_f32_16x16x32_bf16 v[32:35], v[112:115], a[16:19], v[32:35]
    v_mfma_f32_16x16x32_bf16 v[36:39], v[112:115], a[48:51], v[36:39]
    v_mfma_f32_16x16x32_bf16 v[40:43], v[112:115], a[80:83], v[40:43]
    v_mfma_f32_16x16x32_bf16 v[44:47], v[112:115], a[112:115], v[44:47]
    v_mfma_f32_16x16x32_bf16 v[32:35], v[116:119], a[20:23], v[32:35]
    v_mfma_f32_16x16x32_bf16 v[36:39], v[116:119], a[52:55], v[36:39]
    v_mfma_f32_16x16x32_bf16 v[40:43], v[116:119], a[84:87], v[40:43]
    v_mfma_f32_16x16x32_bf16 v[44:47], v[116:119], a[116:119], v[44:47]
    v_mfma_f32_16x16x32_bf16 v[32:35], v[120:123], a[24:27], v[32:35]
    v_mfma_f32_16x16x32_bf16 v[36:39], v[120:123], a[56:59], v[36:39]
    v_mfma_f32_16x16x32_bf16 v[40:43], v[120:123], a[88:91], v[40:43]
    v_mfma_f32_16x16x32_bf16 v[44:47], v[120:123], a[120:123], v[44:47]
    v_mfma_f32_16x16x32_bf16 v[32:35], v[124:127], a[28:31], v[32:35]
    v_mfma_f32_16x16x32_bf16 v[36:39], v[124:127], a[60:63], v[36:39]
    v_mfma_f32_16x16x32_bf16 v[40:43], v[124:127], a[92:95], v[40:43]
    v_mfma_f32_16x16x32_bf16 v[44:47], v[124:127], a[124:127], v[44:47]
    s_nop 7
    v_max3_f32 v64, v64, v32, v33
    v_max3_f32 v64, v64, v34, v35
    v_max3_f32 v65, v65, v36, v37
    v_max3_f32 v65, v65, v38, v39
    v_max3_f32 v66, v66, v40, v41
    v_max3_f32 v66, v66, v42, v43
    v_max3_f32 v67, v67, v44, v45
    v_max3_f32 v67, v67, v46, v47
    ds_read_b128 v[96:99], v5 offset:8448
    ds_read_b128 v[100:103], v5 offset:8512
    ds_read_b128 v[104:107], v5 offset:8576
    ds_read_b128 v[108:111], v5 offset:8640
    ds_read_b128 v[112:115], v5 offset:8704
    ds_read_b128 v[116:119], v5 offset:8768
    ds_read_b128 v[120:123], v5 offset:8832
    ds_read_b128 v[124:127], v5 offset:8896
    s_waitcnt lgkmcnt(0)
    v_mfma_f32_16x16x32_bf16 v[32:35], v[96:99], a[0:3], 0
    v_mfma_f32_16x16x32_bf16 v[36:39], v[96:99], a[32:35], 0
    v_mfma_f32_16x16x32_bf16 v[40:43], v[96:99], a[64:67], 0
    v_mfma_f32_16x16x32_bf16 v[44:47], v[96:99], a[96:99], 0
    v_mfma_f32_16x16x32_bf16 v[32:35], v[100:103], a[4:7], v[32:35]
    v_mfma_f32_16x16x32_bf16 v[36:39], v[100:103], a[36:39], v[36:39]
    v_mfma_f32_16x16x32_bf16 v[40:43], v[100:103], a[68:71], v[40:43]
    v_mfma_f32_16x16x32_bf16 v[44:47], v[100:103], a[100:103], v[44:47]
    v_mfma_f32_16x16x32_bf16 v[32:35], v[104:107], a[8:11], v[32:35]
    v_mfma_f32_16x16x32_bf16 v[36:39], v[104:107], a[40:43], v[36:39]
    v_mfma_f32_16x16x32_bf16 v[40:43], v[104:107], a[72:75], v[40:43]
    v_mfma_f32_16x16x32_bf16 v[44:47], v[104:107], a[104:107], v[44:47]
    v_mfma_f32_16x16x32_bf16 v[32:35], v[108:111], a[12:15], v[32:35]
    v_mfma_f32_16x16x32_bf16 v[36:39], v[108:111], a[44:47], v[36:39]
    v_mfma_f32_16x16x32_bf16 v[40:43], v[108:111], a[76:79], v[40:43]
    v_mfma_f32_16x16x32_bf16 v[44:47], v[108:111], a[108:111], v[44:47]
    v_mfma_f32_16x16x32_bf16 v[32:35], v[112:115], a[16:19], v[32:35]
    v_mfma_f32_16x16x32_bf16 v[36:39], v[112:115], a[48:51], v[36:39]
    v_mfma_f32_16x16x32_bf16 v[40:43], v[112:115], a[80:83], v[40:43]
    v_mfma_f32_16x16x32_bf16 v[44:47], v[112:115], a[112:115], v[44:47]
    v_mfma_f32_16x16x32_bf16 v[32:35], v[116:119], a[20:23], v[32:35]
    v_mfma_f32_16x16x32_bf16 v[36:39], v[116:119], a[52:55], v[36:39]
    v_mfma_f32_16x16x32_bf16 v[40:43], v[116:119], a[84:87], v[40:43]
    v_mfma_f32_16x16x32_bf16 v[44:47], v[116:119], a[116:119], v[44:47]
    v_mfma_f32_16x16x32_bf16 v[32:35], v[120:123], a[24:27], v[32:35]
    v_mfma_f32_16x16x32_bf16 v[36:39], v[120:123], a[56:59], v[36:39]
    v_mfma_f32_16x16x32_bf16 v[40:43], v[120:123], a[88:91], v[40:43]
    v_mfma_f32_16x16x32_bf16 v[44:47], v[120:123], a[120:123], v[44:47]
    v_mfma_f32_16x16x32_bf16 v[32:35], v[124:127], a[28:31], v[32:35]
    v_mfma_f32_16x16x32_bf16 v[36:39], v[124:127], a[60:63], v[36:39]
    v_mfma_f32_16x16x32_bf16 v[40:43], v[124:127], a[92:95], v[40:43]
    v_mfma_f32_16x16x32_bf16 v[44:47], v[124:127], a[124:127], v[44:47]
    s_nop 7
    v_max3_f32 v64, v64, v32, v33
    v_max3_f32 v64, v64, v34, v35
    v_max3_f32 v65, v65, v36, v37
    v_max3_f32 v65, v65, v38, v39
    v_max3_f32 v66, v66, v40, v41
    v_max3_f32 v66, v66, v42, v43
    v_max3_f32 v67, v67, v44, v45
    v_max3_f32 v67, v67, v46, v47
    s_add_u32 s61, s61, 0x4000
    s_cmp_lt_u32 s61, 0x40000
    s_cbranch_scc1 L_fb_loop
    v_mov_b32 v9, v64
    s_nop 1
    v_permlane16_swap_b32 v64, v9
    s_nop 1
    v_max_f32 v64, v64, v9
    v_mov_b32 v9, v64
    s_nop 1
    v_permlane32_swap_b32 v64, v9
    s_nop 1
    v_max_f32 v64, v64, v9
    v_add_f32 v64, 0x44400000, v64
    v_mul_f32 v12, s60, v64
    v_mov_b32 v9, v65
    s_nop 1
    v_permlane16_swap_b32 v65, v9
    s_nop 1
    v_max_f32 v65, v65, v9
    v_mov_b32 v9, v65
    s_nop 1
    v_permlane32_swap_b32 v65, v9
    s_nop 1
    v_max_f32 v65, v65, v9
    v_add_f32 v65, 0x44400000, v65
    v_mul_f32 v13, s60, v65
    v_mov_b32 v9, v66
    s_nop 1
    v_permlane16_swap_b32 v66, v9
    s_nop 1
    v_max_f32 v66, v66, v9
    v_mov_b32 v9, v66
    s_nop 1
    v_permlane32_swap_b32 v66, v9
    s_nop 1
    v_max_f32 v66, v66, v9
    v_add_f32 v66, 0x44400000, v66
    v_mul_f32 v14, s60, v66
    v_mov_b32 v9, v67
    s_nop 1
    v_permlane16_swap_b32 v67, v9
    s_nop 1
    v_max_f32 v67, v67, v9
    v_mov_b32 v9, v67
    s_nop 1
    v_permlane32_swap_b32 v67, v9
    s_nop 1
    v_max_f32 v67, v67, v9
    v_add_f32 v67, 0x44400000, v67
    v_mul_f32 v15, s60, v67
    s_mov_b32 s59, 1
    s_barrier
    s_branch L_restart
L_codeend:
.section .rodata,"a"
.p2align 6
.amdhsa_kernel standalone__gqa_softmax__near_ridge_kernel
  .amdhsa_next_free_vgpr 512
  .amdhsa_next_free_sgpr 102
  .amdhsa_accum_offset 256
  .amdhsa_group_segment_fixed_size 0
  .amdhsa_kernarg_size 48
  .amdhsa_user_sgpr_count 2
  .amdhsa_user_sgpr_kernarg_segment_ptr 1
  .amdhsa_system_sgpr_workgroup_id_x 1
.end_amdhsa_kernel
```
